```python
import torch

def _softmax(x, axis=-1):
    return torch.softmax(x, dim=axis)
def _gelu(x):
    return torch.nn.functional.gelu(x, approximate="tanh")
def _silu(x):
    return torch.nn.functional.silu(x)
def _sigmoid(x):
    return torch.sigmoid(x)
def _layernorm(x, axis=-1, eps=1e-5):
    m = x.mean(dim=axis, keepdim=True)
    v = x.var(dim=axis, keepdim=True, unbiased=False)
    return (x - m) / torch.sqrt(v + eps)
def _scatter_add(tgt, idx, src, axis=0):
    return tgt.clone().index_add_(axis, idx, src)
def _segment_sum(src, seg, n):
    out = torch.zeros((n,) + src.shape[1:], dtype=src.dtype)
    return out.index_add_(0, seg, src)
def _pad(x, pw):
    flat = tuple(v for pair in reversed(pw) for v in pair)
    return torch.nn.functional.pad(x, flat)

kernel_name = 'parallel_sum__linear_kernel_hedgehog__glu_gated_geglu__prompt'

def setup_inputs():

    _w = (lambda a: (lambda t: t.to(torch.bfloat16) if t.is_floating_point() else t)(torch.as_tensor(a)))
    def _A_setup():
        B, S, D, H = 1, 2048, 640, 32
        Dh = D // H
        return {
            "x": _w((lambda *s: torch.randn(*s, dtype=torch.bfloat16) * 0.05)(B, S, D)),
            "wqkv": _w((lambda *s: torch.randn(*s, dtype=torch.bfloat16) * 0.2)(D, 3 * D)),
            "w_phi": _w((lambda *s: torch.randn(*s, dtype=torch.bfloat16) * 0.2)(H, Dh, Dh) * (Dh ** -0.5)),
            "wo": _w((lambda *s: torch.randn(*s, dtype=torch.bfloat16) * 0.05)(D, D)),
        }
    _A_in = _A_setup()

    def _B_setup():
        B, S, Dm, Df = 1, 2048, 640, 1536
        return {
            "x": _w((lambda *s: torch.randn(*s, dtype=torch.bfloat16) * 0.05)(B, S, Dm)),
            "w_gate": _w((lambda *s: torch.randn(*s, dtype=torch.bfloat16) * 0.4)(Dm, Df) * (Dm ** -0.5)),
            "w_up": _w((lambda *s: torch.randn(*s, dtype=torch.bfloat16) * 0.4)(Dm, Df) * (Dm ** -0.5)),
            "w_down": _w((lambda *s: torch.randn(*s, dtype=torch.bfloat16) * 0.4)(Df, Dm) * (Df ** -0.5)),
        }
    _B_in = _B_setup()

    return {
        "A_x": _A_in["x"],
        "A_wqkv": _A_in["wqkv"],
        "A_w_phi": _A_in["w_phi"],
        "A_wo": _A_in["wo"],
        "B_x": _B_in["x"],
        "B_w_gate": _B_in["w_gate"],
        "B_w_up": _B_in["w_up"],
        "B_w_down": _B_in["w_down"],
    }

def reference(A_x, A_wqkv, A_w_phi, A_wo, B_x, B_w_gate, B_w_up, B_w_down):
    def _A_ref(x, wqkv, w_phi, wo):
        B, S, D = x.shape
        H = 32; Dh = D // H
        qkv = (lambda x, *d: x.permute(*d))((x @ wqkv).reshape(B, S, 3, H, Dh), 2, 0, 3, 1, 4)
        q, k, v = qkv[0], qkv[1], qkv[2]
        pq = torch.einsum("bhsd,hdf->bhsf", q, w_phi)
        pk = torch.einsum("bhsd,hdf->bhsf", k, w_phi)
        phi_q = torch.concatenate([_softmax(pq, axis=-1), _softmax(-pq, axis=-1)], axis=-1)
        phi_k = torch.concatenate([_softmax(pk, axis=-1), _softmax(-pk, axis=-1)], axis=-1)
        kv = torch.einsum("bhsf,bhsd->bhfd", phi_k, v)
        z  = torch.einsum("bhsf->bhf", phi_k)
        num = torch.einsum("bhqf,bhfd->bhqd", phi_q, kv)
        den = torch.einsum("bhqf,bhf->bhq", phi_q, z)[..., None] + 1e-6
        o = num / den
        return (lambda x, *d: x.permute(*d))(o, 0, 2, 1, 3).reshape(B, S, D) @ wo

    def _B_ref(x, w_gate, w_up, w_down):
        g = torch.einsum("bsd,df->bsf", x, w_gate)
        u = torch.einsum("bsd,df->bsf", x, w_up)
        h = _gelu(g) * u
        return torch.einsum("bsf,fd->bsd", h, w_down)

    x = A_x
    xn = _layernorm(x, axis=-1)
    return x + _A_ref(xn, A_wqkv, A_w_phi, A_wo) + _B_ref(xn, B_w_gate, B_w_up, B_w_down)
```

```asm
; @launch kernel=k1_kernel grid=(256,1,1) block=(512,1,1) lds=149056
; @launch kernel=k2_kernel grid=(256,1,1) block=(256,1,1) lds=147456
.amdgcn_target "amdgcn-amd-amdhsa--gfx950"
.text
.globl k1_kernel
.p2align 8
.type k1_kernel,@function
k1_kernel:
    s_cmp_ge_u32 s2, 256
    s_cbranch_scc1 L_k1_end
    s_load_dwordx4 s[4:7], s[0:1], 0
    s_load_dwordx2 s[10:11], s[0:1], 40
    s_load_dwordx2 s[12:13], s[0:1], 48
    s_load_dwordx2 s[8:9], s[0:1], 16
    s_load_dwordx2 s[14:15], s[0:1], 80
    s_load_dwordx2 s[58:59], s[0:1], 72
    v_lshrrev_b32 v2, 6, v0
    v_and_b32 v1, 63, v0
    s_nop 0
    v_readfirstlane_b32 s40, v2
    s_and_b32 s42, s2, 7
    s_lshr_b32 s43, s2, 7
    s_lshl_b32 s43, s43, 3
    s_or_b32 s42, s42, s43
    s_bfe_u32 s41, s2, 0x40003
    s_and_b32 s60, s40, 3
    s_lshr_b32 s61, s40, 2
    v_lshrrev_b32 v3, 5, v1
    v_and_b32 v4, 31, v1
    v_lshrrev_b32 v5, 4, v1
    v_bfe_u32 v6, v1, 2, 2
    v_xor_b32 v6, v6, v5
    v_and_b32 v7, 3, v1
    v_lshl_add_u32 v7, v6, 2, v7
    v_min_u32 v7, 14, v7
    v_mul_u32_u24 v8, 13, v7
    v_lshrrev_b32 v8, 6, v8
    v_mul_u32_u24 v9, 5, v8
    v_sub_u32 v9, v7, v9
    v_lshrrev_b32 v10, 1, v8
    v_sub_u32 v10, 1, v10
    v_xor_b32 v8, v8, v10
    v_mul_u32_u24 v8, 1280, v8
    v_lshl_add_u32 v8, v9, 4, v8
    v_mul_u32_u24 v9, 3840, v5
    s_mul_i32 s43, s42, 80
    v_add3_u32 v238, v8, v9, s43
    v_lshrrev_b32 v5, 3, v1
    v_and_b32 v6, 7, v1
    v_lshrrev_b32 v7, 1, v5
    v_xor_b32 v8, v6, v7
    v_mul_u32_u24 v9, 1280, v5
    v_lshl_add_u32 v240, v8, 4, v9
    v_xor_b32 v8, 4, v8
    v_lshl_add_u32 v241, v8, 4, v9
    v_add_u32 v241, 10240, v241
    s_lshl_b32 s45, s41, 7
    s_lshl_b32 s43, s40, 4
    s_add_u32 s45, s45, s43
    s_mul_i32 s45, s45, 1280
    s_lshl_b32 s57, s40, 11
    s_add_u32 s57, s57, 81920
    s_lshl_b32 s46, s60, 11
    s_mov_b32 s48, 0xf7ff7fff
    s_mov_b32 s49, 0xfff7ff7f
    s_mul_i32 s71, s60, 30720
    s_lshl_b32 s43, s60, 1
    s_add_u32 s43, s43, 4
    s_cmp_eq_u32 s61, 0
    s_cselect_b32 s62, s60, s43
    s_add_u32 s43, s41, s42
    s_mul_i32 s44, s43, 26
    s_lshr_b32 s44, s44, 8
    s_mul_i32 s44, s44, 10
    s_sub_u32 s43, s43, s44
    s_mul_i32 s66, s43, 245760
    s_mul_i32 s67, s43, 196608
    s_lshl_b32 s65, s43, 7
    s_waitcnt lgkmcnt(0)
    s_mov_b32 s16, s4
    s_and_b32 s17, s5, 0xffff
    s_mov_b32 s18, 0x280000
    s_mov_b32 s19, 0x00020000
    s_mov_b32 s20, s6
    s_and_b32 s21, s7, 0xffff
    s_mov_b32 s22, 0x258000
    s_mov_b32 s23, 0x00020000
    s_add_u32 s43, s62, 0
    s_cmp_ge_u32 s43, 6
    s_cselect_b32 s24, s12, s10
    s_cselect_b32 s25, s13, s11
    s_cselect_b32 s44, 6, 0
    s_and_b32 s25, s25, 0xffff
    s_mov_b32 s26, 1966080
    s_mov_b32 s27, 0x00020000
    s_sub_u32 s44, s43, s44
    s_lshl_b32 s75, s43, 10
    s_add_u32 s75, s75, 32768
    s_lshl_b32 s44, s44, 6
    v_add_u32 v5, s44, v1
    v_mul_u32_u24 v6, 5462, v5
    v_lshrrev_b32 v6, 16, v6
    v_mul_u32_u24 v7, 12, v6
    v_sub_u32 v7, v5, v7
    v_mul_u32_u24 v6, 3072, v6
    v_lshl_add_u32 v6, v7, 4, v6
    s_mul_i32 s43, s42, 192
    v_add_u32 v239, s43, v6
    s_add_u32 s43, s62, 1
    s_cmp_ge_u32 s43, 6
    s_cselect_b32 s28, s12, s10
    s_cselect_b32 s29, s13, s11
    s_cselect_b32 s44, 6, 0
    s_and_b32 s29, s29, 0xffff
    s_mov_b32 s30, 1966080
    s_mov_b32 s31, 0x00020000
    s_sub_u32 s44, s43, s44
    s_lshl_b32 s76, s43, 10
    s_add_u32 s76, s76, 32768
    s_lshl_b32 s44, s44, 6
    v_add_u32 v5, s44, v1
    v_mul_u32_u24 v6, 5462, v5
    v_lshrrev_b32 v6, 16, v6
    v_mul_u32_u24 v7, 12, v6
    v_sub_u32 v7, v5, v7
    v_mul_u32_u24 v6, 3072, v6
    v_lshl_add_u32 v6, v7, 4, v6
    s_mul_i32 s43, s42, 192
    v_add_u32 v187, s43, v6
    s_cmp_eq_u32 s61, 1
    s_cbranch_scc1 L_k1_roleB
    s_add_u32 s44, s66, s71
    s_mov_b64 exec, s[48:49]
    s_add_u32 m0, s46, 0
    s_nop 0
    buffer_load_dwordx4 v238, s[20:23], s44 offen lds
    s_add_u32 m0, s46, 1024
    s_add_u32 s44, s44, 15360
    buffer_load_dwordx4 v238, s[20:23], s44 offen lds
    s_mov_b64 exec, -1
    s_add_u32 s66, s66, 122880
    s_cmp_ge_u32 s66, 2457600
    s_cselect_b32 s66, 0, s66
    s_add_u32 m0, s75, 0
    s_nop 0
    buffer_load_dwordx4 v239, s[24:27], s67 offen lds
    s_add_u32 s67, s67, 98304
    s_cmp_ge_u32 s67, 1966080
    s_cselect_b32 s67, 0, s67
    s_add_u32 s44, s45, s65
    s_add_u32 m0, s57, 0
    s_nop 0
    buffer_load_dwordx4 v240, s[16:19], s44 offen lds
    s_add_u32 m0, s57, 1024
    s_nop 0
    buffer_load_dwordx4 v241, s[16:19], s44 offen lds
    s_add_u32 s65, s65, 128
    s_cmp_ge_u32 s65, 1280
    s_cselect_b32 s65, 0, s65
    s_add_u32 s44, s66, s71
    s_mov_b64 exec, s[48:49]
    s_add_u32 m0, s46, 8192
    s_nop 0
    buffer_load_dwordx4 v238, s[20:23], s44 offen lds
    s_add_u32 m0, s46, 9216
    s_add_u32 s44, s44, 15360
    buffer_load_dwordx4 v238, s[20:23], s44 offen lds
    s_mov_b64 exec, -1
    s_add_u32 s66, s66, 122880
    s_cmp_ge_u32 s66, 2457600
    s_cselect_b32 s66, 0, s66
    s_add_u32 m0, s75, 12288
    s_nop 0
    buffer_load_dwordx4 v239, s[24:27], s67 offen lds
    s_add_u32 s67, s67, 98304
    s_cmp_ge_u32 s67, 1966080
    s_cselect_b32 s67, 0, s67
    s_mov_b32 s32, s14
    s_and_b32 s33, s15, 0xffff
    s_mov_b32 s34, 0x2000000
    s_mov_b32 s35, 0x00020000
    s_mov_b32 s36, s8
    s_and_b32 s37, s9, 0xffff
    s_mov_b32 s38, 0x6400
    s_mov_b32 s39, 0x00020000
    v_lshlrev_b32 v5, 3, v3
    v_bfe_u32 v6, v1, 2, 2
    v_add_u32 v5, v5, v6
    v_mul_u32_u24 v5, 256, v5
    v_bfe_u32 v7, v1, 4, 1
    v_lshl_add_u32 v5, v7, 5, v5
    v_and_b32 v7, 3, v1
    v_lshl_add_u32 v5, v7, 3, v5
    v_xor_b32 v7, 0, v6
    v_lshl_add_u32 v236, v7, 6, v5
    v_xor_b32 v7, 1, v6
    v_lshl_add_u32 v237, v7, 6, v5
    v_xor_b32 v7, 2, v6
    v_lshl_add_u32 v184, v7, 6, v5
    v_xor_b32 v7, 3, v6
    v_lshl_add_u32 v185, v7, 6, v5
    s_lshl_b32 s43, s60, 5
    v_add_u32 v5, s43, v4
    v_lshlrev_b32 v5, 7, v5
    v_add_u32 v5, 81920, v5
    v_bfe_u32 v6, v4, 1, 3
    v_add_u32 v7, 0, v3
    v_xor_b32 v7, v7, v6
    v_lshl_add_u32 v242, v7, 4, v5
    v_add_u32 v7, 2, v3
    v_xor_b32 v7, v7, v6
    v_lshl_add_u32 v243, v7, 4, v5
    v_add_u32 v7, 4, v3
    v_xor_b32 v7, v7, v6
    v_lshl_add_u32 v244, v7, 4, v5
    v_add_u32 v7, 6, v3
    v_xor_b32 v7, v7, v6
    v_lshl_add_u32 v245, v7, 4, v5
    s_lshl_b32 s63, s60, 2
    s_add_u32 s64, s60, 4
    s_min_u32 s64, s64, 5
    s_lshl_b32 s64, s64, 2
    s_lshl_b32 s43, s42, 12
    s_lshl_b32 s44, s41, 8
    s_add_u32 s43, s43, s44
    s_add_u32 s43, s43, 29360128
    v_mov_b32 v5, 0
    s_mov_b64 exec, 1
    buffer_store_dword v5, v5, s[32:35], s43 offen sc1
    s_mov_b64 exec, -1
    s_mul_i32 s43, s42, 1600
    v_add_u32 v5, 0, v0
    v_min_u32 v5, 1599, v5
    v_mul_u32_u24 v6, 1311, v5
    v_lshrrev_b32 v72, 19, v6
    v_mul_u32_u24 v7, 400, v72
    v_sub_u32 v80, v5, v7
    v_and_b32 v8, 1, v72
    v_mul_u32_u24 v8, 400, v8
    v_add_u32 v8, v8, v80
    v_lshlrev_b32 v8, 1, v8
    buffer_load_ushort v64, v8, s[36:39], s43 offen
    v_add_u32 v5, 256, v0
    v_min_u32 v5, 1599, v5
    v_mul_u32_u24 v6, 1311, v5
    v_lshrrev_b32 v73, 19, v6
    v_mul_u32_u24 v7, 400, v73
    v_sub_u32 v81, v5, v7
    v_and_b32 v8, 1, v73
    v_mul_u32_u24 v8, 400, v8
    v_add_u32 v8, v8, v81
    v_lshlrev_b32 v8, 1, v8
    buffer_load_ushort v65, v8, s[36:39], s43 offen
    v_add_u32 v5, 512, v0
    v_min_u32 v5, 1599, v5
    v_mul_u32_u24 v6, 1311, v5
    v_lshrrev_b32 v74, 19, v6
    v_mul_u32_u24 v7, 400, v74
    v_sub_u32 v82, v5, v7
    v_and_b32 v8, 1, v74
    v_mul_u32_u24 v8, 400, v8
    v_add_u32 v8, v8, v82
    v_lshlrev_b32 v8, 1, v8
    buffer_load_ushort v66, v8, s[36:39], s43 offen
    v_add_u32 v5, 768, v0
    v_min_u32 v5, 1599, v5
    v_mul_u32_u24 v6, 1311, v5
    v_lshrrev_b32 v75, 19, v6
    v_mul_u32_u24 v7, 400, v75
    v_sub_u32 v83, v5, v7
    v_and_b32 v8, 1, v75
    v_mul_u32_u24 v8, 400, v8
    v_add_u32 v8, v8, v83
    v_lshlrev_b32 v8, 1, v8
    buffer_load_ushort v67, v8, s[36:39], s43 offen
    v_add_u32 v5, 1024, v0
    v_min_u32 v5, 1599, v5
    v_mul_u32_u24 v6, 1311, v5
    v_lshrrev_b32 v76, 19, v6
    v_mul_u32_u24 v7, 400, v76
    v_sub_u32 v84, v5, v7
    v_and_b32 v8, 1, v76
    v_mul_u32_u24 v8, 400, v8
    v_add_u32 v8, v8, v84
    v_lshlrev_b32 v8, 1, v8
    buffer_load_ushort v68, v8, s[36:39], s43 offen
    v_add_u32 v5, 1280, v0
    v_min_u32 v5, 1599, v5
    v_mul_u32_u24 v6, 1311, v5
    v_lshrrev_b32 v77, 19, v6
    v_mul_u32_u24 v7, 400, v77
    v_sub_u32 v85, v5, v7
    v_and_b32 v8, 1, v77
    v_mul_u32_u24 v8, 400, v8
    v_add_u32 v8, v8, v85
    v_lshlrev_b32 v8, 1, v8
    buffer_load_ushort v69, v8, s[36:39], s43 offen
    v_add_u32 v5, 1536, v0
    v_min_u32 v5, 1599, v5
    v_mul_u32_u24 v6, 1311, v5
    v_lshrrev_b32 v78, 19, v6
    v_mul_u32_u24 v7, 400, v78
    v_sub_u32 v86, v5, v7
    v_and_b32 v8, 1, v78
    v_mul_u32_u24 v8, 400, v8
    v_add_u32 v8, v8, v86
    v_lshlrev_b32 v8, 1, v8
    buffer_load_ushort v70, v8, s[36:39], s43 offen
    v_mul_u32_u24 v8, 3277, v80
    v_lshrrev_b32 v8, 16, v8
    v_mul_u32_u24 v9, 20, v8
    v_sub_u32 v9, v80, v9
    v_and_b32 v10, 1, v72
    v_mul_u32_u24 v10, 5, v10
    v_lshrrev_b32 v11, 2, v9
    v_add_u32 v10, v10, v11
    v_lshlrev_b32 v10, 3, v10
    v_lshrrev_b32 v11, 1, v72
    v_lshl_add_u32 v10, v11, 2, v10
    v_and_b32 v11, 3, v9
    v_add_u32 v10, v10, v11
    v_mul_u32_u24 v10, 160, v10
    v_mul_u32_u24 v11, 20, v72
    v_add_u32 v11, v11, v8
    v_and_b32 v13, 0x73, v11
    v_bfe_u32 v14, v11, 2, 1
    v_lshl_add_u32 v13, v14, 3, v13
    v_bfe_u32 v14, v11, 3, 1
    v_lshl_add_u32 v13, v14, 2, v13
    v_lshl_add_u32 v10, v13, 1, v10
    v_add_u32 v88, 131072, v10
    v_mul_u32_u24 v8, 3277, v81
    v_lshrrev_b32 v8, 16, v8
    v_mul_u32_u24 v9, 20, v8
    v_sub_u32 v9, v81, v9
    v_and_b32 v10, 1, v73
    v_mul_u32_u24 v10, 5, v10
    v_lshrrev_b32 v11, 2, v9
    v_add_u32 v10, v10, v11
    v_lshlrev_b32 v10, 3, v10
    v_lshrrev_b32 v11, 1, v73
    v_lshl_add_u32 v10, v11, 2, v10
    v_and_b32 v11, 3, v9
    v_add_u32 v10, v10, v11
    v_mul_u32_u24 v10, 160, v10
    v_mul_u32_u24 v11, 20, v73
    v_add_u32 v11, v11, v8
    v_and_b32 v13, 0x73, v11
    v_bfe_u32 v14, v11, 2, 1
    v_lshl_add_u32 v13, v14, 3, v13
    v_bfe_u32 v14, v11, 3, 1
    v_lshl_add_u32 v13, v14, 2, v13
    v_lshl_add_u32 v10, v13, 1, v10
    v_add_u32 v89, 131072, v10
    v_mul_u32_u24 v8, 3277, v82
    v_lshrrev_b32 v8, 16, v8
    v_mul_u32_u24 v9, 20, v8
    v_sub_u32 v9, v82, v9
    v_and_b32 v10, 1, v74
    v_mul_u32_u24 v10, 5, v10
    v_lshrrev_b32 v11, 2, v9
    v_add_u32 v10, v10, v11
    v_lshlrev_b32 v10, 3, v10
    v_lshrrev_b32 v11, 1, v74
    v_lshl_add_u32 v10, v11, 2, v10
    v_and_b32 v11, 3, v9
    v_add_u32 v10, v10, v11
    v_mul_u32_u24 v10, 160, v10
    v_mul_u32_u24 v11, 20, v74
    v_add_u32 v11, v11, v8
    v_and_b32 v13, 0x73, v11
    v_bfe_u32 v14, v11, 2, 1
    v_lshl_add_u32 v13, v14, 3, v13
    v_bfe_u32 v14, v11, 3, 1
    v_lshl_add_u32 v13, v14, 2, v13
    v_lshl_add_u32 v10, v13, 1, v10
    v_add_u32 v90, 131072, v10
    v_mul_u32_u24 v8, 3277, v83
    v_lshrrev_b32 v8, 16, v8
    v_mul_u32_u24 v9, 20, v8
    v_sub_u32 v9, v83, v9
    v_and_b32 v10, 1, v75
    v_mul_u32_u24 v10, 5, v10
    v_lshrrev_b32 v11, 2, v9
    v_add_u32 v10, v10, v11
    v_lshlrev_b32 v10, 3, v10
    v_lshrrev_b32 v11, 1, v75
    v_lshl_add_u32 v10, v11, 2, v10
    v_and_b32 v11, 3, v9
    v_add_u32 v10, v10, v11
    v_mul_u32_u24 v10, 160, v10
    v_mul_u32_u24 v11, 20, v75
    v_add_u32 v11, v11, v8
    v_and_b32 v13, 0x73, v11
    v_bfe_u32 v14, v11, 2, 1
    v_lshl_add_u32 v13, v14, 3, v13
    v_bfe_u32 v14, v11, 3, 1
    v_lshl_add_u32 v13, v14, 2, v13
    v_lshl_add_u32 v10, v13, 1, v10
    v_add_u32 v91, 131072, v10
    v_mul_u32_u24 v8, 3277, v84
    v_lshrrev_b32 v8, 16, v8
    v_mul_u32_u24 v9, 20, v8
    v_sub_u32 v9, v84, v9
    v_and_b32 v10, 1, v76
    v_mul_u32_u24 v10, 5, v10
    v_lshrrev_b32 v11, 2, v9
    v_add_u32 v10, v10, v11
    v_lshlrev_b32 v10, 3, v10
    v_lshrrev_b32 v11, 1, v76
    v_lshl_add_u32 v10, v11, 2, v10
    v_and_b32 v11, 3, v9
    v_add_u32 v10, v10, v11
    v_mul_u32_u24 v10, 160, v10
    v_mul_u32_u24 v11, 20, v76
    v_add_u32 v11, v11, v8
    v_and_b32 v13, 0x73, v11
    v_bfe_u32 v14, v11, 2, 1
    v_lshl_add_u32 v13, v14, 3, v13
    v_bfe_u32 v14, v11, 3, 1
    v_lshl_add_u32 v13, v14, 2, v13
    v_lshl_add_u32 v10, v13, 1, v10
    v_add_u32 v92, 131072, v10
    v_mul_u32_u24 v8, 3277, v85
    v_lshrrev_b32 v8, 16, v8
    v_mul_u32_u24 v9, 20, v8
    v_sub_u32 v9, v85, v9
    v_and_b32 v10, 1, v77
    v_mul_u32_u24 v10, 5, v10
    v_lshrrev_b32 v11, 2, v9
    v_add_u32 v10, v10, v11
    v_lshlrev_b32 v10, 3, v10
    v_lshrrev_b32 v11, 1, v77
    v_lshl_add_u32 v10, v11, 2, v10
    v_and_b32 v11, 3, v9
    v_add_u32 v10, v10, v11
    v_mul_u32_u24 v10, 160, v10
    v_mul_u32_u24 v11, 20, v77
    v_add_u32 v11, v11, v8
    v_and_b32 v13, 0x73, v11
    v_bfe_u32 v14, v11, 2, 1
    v_lshl_add_u32 v13, v14, 3, v13
    v_bfe_u32 v14, v11, 3, 1
    v_lshl_add_u32 v13, v14, 2, v13
    v_lshl_add_u32 v10, v13, 1, v10
    v_add_u32 v93, 131072, v10
    v_mul_u32_u24 v8, 3277, v86
    v_lshrrev_b32 v8, 16, v8
    v_mul_u32_u24 v9, 20, v8
    v_sub_u32 v9, v86, v9
    v_and_b32 v10, 1, v78
    v_mul_u32_u24 v10, 5, v10
    v_lshrrev_b32 v11, 2, v9
    v_add_u32 v10, v10, v11
    v_lshlrev_b32 v10, 3, v10
    v_lshrrev_b32 v11, 1, v78
    v_lshl_add_u32 v10, v11, 2, v10
    v_and_b32 v11, 3, v9
    v_add_u32 v10, v10, v11
    v_mul_u32_u24 v10, 160, v10
    v_mul_u32_u24 v11, 20, v78
    v_add_u32 v11, v11, v8
    v_and_b32 v13, 0x73, v11
    v_bfe_u32 v14, v11, 2, 1
    v_lshl_add_u32 v13, v14, 3, v13
    v_bfe_u32 v14, v11, 3, 1
    v_lshl_add_u32 v13, v14, 2, v13
    v_lshl_add_u32 v10, v13, 1, v10
    v_add_u32 v94, 131072, v10
    v_mov_b32 v246, 0
    v_mov_b32 v247, 0
    v_mov_b32 v248, 0
    v_mov_b32 v249, 0
    v_mov_b32 v250, 0
    v_mov_b32 v251, 0
    s_mov_b32 s52, s58
    s_and_b32 s53, s59, 0xffff
    s_mov_b32 s54, 256
    s_mov_b32 s55, 0x00020000
    s_lshl_b32 s56, s42, 2
    s_add_u32 s56, s56, 128
    s_lshl_b32 s43, s42, 4
    s_mul_i32 s50, s43, 1536
    s_add_u32 s50, s50, 25165824
    s_mul_i32 s51, s41, 1536
    s_add_u32 s51, s51, s50
    s_lshl_b32 s43, s60, 7
    s_add_u32 s51, s51, s43
    v_lshlrev_b32 v235, 6, v2
    v_add_u32 v235, v235, v1
    v_min_u32 v235, 319, v235
    v_lshlrev_b32 v235, 2, v235
    s_lshl_b32 s62, s41, 13
    s_add_u32 s62, s62, 26214400
    s_lshl_b32 s70, s41, 2
    s_lshl_b32 s43, s60, 5
    v_add_u32 v188, s43, v4
    v_lshlrev_b32 v188, 2, v188
    s_waitcnt vmcnt(11) lgkmcnt(0)
    s_barrier
    ds_read_b128 v[32:35], v242 offset:0
    ds_read_b64_tr_b16 v[16:17], v236 offset:0
    ds_read_b64_tr_b16 v[18:19], v236 offset:1024
    ds_read_b64_tr_b16 v[20:21], v237 offset:0
    ds_read_b64_tr_b16 v[22:23], v237 offset:1024
    ds_read_b64_tr_b16 v[24:25], v184 offset:0
    ds_read_b64_tr_b16 v[26:27], v184 offset:1024
    ds_read_b64_tr_b16 v[28:29], v185 offset:0
    ds_read_b64_tr_b16 v[30:31], v185 offset:1024
    s_waitcnt vmcnt(0)
    ds_write_b16 v88, v64
    ds_write_b16 v89, v65
    ds_write_b16 v90, v66
    ds_write_b16 v91, v67
    ds_write_b16 v92, v68
    ds_write_b16 v93, v69
    ds_write_b16 v94, v70
    s_nop 1
    s_waitcnt lgkmcnt(0)
    v_mfma_f32_32x32x16_bf16 v[64:79], v[16:19], v[32:35], 0
    ds_read_b128 v[56:59], v243 offset:0
    ds_read_b64_tr_b16 v[40:41], v236 offset:4096
    ds_read_b64_tr_b16 v[42:43], v236 offset:5120
    ds_read_b64_tr_b16 v[44:45], v237 offset:4096
    ds_read_b64_tr_b16 v[46:47], v237 offset:5120
    s_set_gpr_idx_on s63, 0x2
    v_lshlrev_b32 v252, 16, v16
    v_and_b32 v253, 0xffff0000, v16
    v_lshlrev_b32 v254, 16, v17
    v_and_b32 v255, 0xffff0000, v17
    s_set_gpr_idx_off
    v_pk_add_f32 v[248:249], v[248:249], v[252:253]
    v_pk_add_f32 v[248:249], v[248:249], v[254:255]
    v_mfma_f32_32x32x16_bf16 v[80:95], v[20:23], v[32:35], 0
    ds_read_b64_tr_b16 v[48:49], v184 offset:4096
    ds_read_b64_tr_b16 v[50:51], v184 offset:5120
    ds_read_b64_tr_b16 v[52:53], v185 offset:4096
    ds_read_b64_tr_b16 v[54:55], v185 offset:5120
    s_set_gpr_idx_on s63, 0x2
    v_lshlrev_b32 v252, 16, v18
    v_and_b32 v253, 0xffff0000, v18
    v_lshlrev_b32 v254, 16, v19
    v_and_b32 v255, 0xffff0000, v19
    s_set_gpr_idx_off
    v_pk_add_f32 v[248:249], v[248:249], v[252:253]
    v_pk_add_f32 v[248:249], v[248:249], v[254:255]
    v_mfma_f32_32x32x16_bf16 v[96:111], v[24:27], v[32:35], 0
    v_lshlrev_b32 v252, 16, v32
    v_and_b32 v253, 0xffff0000, v32
    v_lshlrev_b32 v254, 16, v33
    v_and_b32 v255, 0xffff0000, v33
    v_pk_fma_f32 v[246:247], v[252:253], v[252:253], v[246:247]
    v_pk_fma_f32 v[246:247], v[254:255], v[254:255], v[246:247]
    v_mfma_f32_32x32x16_bf16 v[112:127], v[28:31], v[32:35], 0
    v_lshlrev_b32 v252, 16, v34
    v_and_b32 v253, 0xffff0000, v34
    v_lshlrev_b32 v254, 16, v35
    v_and_b32 v255, 0xffff0000, v35
    v_pk_fma_f32 v[246:247], v[252:253], v[252:253], v[246:247]
    v_pk_fma_f32 v[246:247], v[254:255], v[254:255], v[246:247]
    s_add_u32 s44, s45, s65
    s_add_u32 m0, s57, 16384
    s_nop 0
    buffer_load_dwordx4 v240, s[16:19], s44 offen lds
    s_add_u32 m0, s57, 17408
    s_nop 0
    buffer_load_dwordx4 v241, s[16:19], s44 offen lds
    s_add_u32 s65, s65, 128
    s_cmp_ge_u32 s65, 1280
    s_cselect_b32 s65, 0, s65
    s_add_u32 s44, s66, s71
    s_mov_b64 exec, s[48:49]
    s_add_u32 m0, s46, 16384
    s_nop 0
    buffer_load_dwordx4 v238, s[20:23], s44 offen lds
    s_add_u32 m0, s46, 17408
    s_add_u32 s44, s44, 15360
    buffer_load_dwordx4 v238, s[20:23], s44 offen lds
    s_mov_b64 exec, -1
    s_add_u32 s66, s66, 122880
    s_cmp_ge_u32 s66, 2457600
    s_cselect_b32 s66, 0, s66
    s_add_u32 m0, s75, 24576
    s_nop 0
    buffer_load_dwordx4 v239, s[24:27], s67 offen lds
    s_add_u32 s67, s67, 98304
    s_cmp_ge_u32 s67, 1966080
    s_cselect_b32 s67, 0, s67
    s_waitcnt lgkmcnt(0)
    v_mfma_f32_32x32x16_bf16 v[64:79], v[40:43], v[56:59], v[64:79]
    s_barrier
    s_set_gpr_idx_on s63, 0x2
    v_lshlrev_b32 v252, 16, v40
    v_and_b32 v253, 0xffff0000, v40
    v_lshlrev_b32 v254, 16, v41
    v_and_b32 v255, 0xffff0000, v41
    s_set_gpr_idx_off
    v_pk_add_f32 v[248:249], v[248:249], v[252:253]
    v_pk_add_f32 v[248:249], v[248:249], v[254:255]
    v_mfma_f32_32x32x16_bf16 v[80:95], v[44:47], v[56:59], v[80:95]
    ds_read_b128 v[32:35], v244 offset:0
    ds_read_b64_tr_b16 v[16:17], v236 offset:8192
    ds_read_b64_tr_b16 v[18:19], v236 offset:9216
    ds_read_b64_tr_b16 v[20:21], v237 offset:8192
    ds_read_b64_tr_b16 v[22:23], v237 offset:9216
    s_set_gpr_idx_on s63, 0x2
    v_lshlrev_b32 v252, 16, v42
    v_and_b32 v253, 0xffff0000, v42
    v_lshlrev_b32 v254, 16, v43
    v_and_b32 v255, 0xffff0000, v43
    s_set_gpr_idx_off
    v_pk_add_f32 v[248:249], v[248:249], v[252:253]
    v_pk_add_f32 v[248:249], v[248:249], v[254:255]
    v_mfma_f32_32x32x16_bf16 v[96:111], v[48:51], v[56:59], v[96:111]
    ds_read_b64_tr_b16 v[24:25], v184 offset:8192
    ds_read_b64_tr_b16 v[26:27], v184 offset:9216
    ds_read_b64_tr_b16 v[28:29], v185 offset:8192
    ds_read_b64_tr_b16 v[30:31], v185 offset:9216
    v_lshlrev_b32 v252, 16, v56
    v_and_b32 v253, 0xffff0000, v56
    v_lshlrev_b32 v254, 16, v57
    v_and_b32 v255, 0xffff0000, v57
    v_pk_fma_f32 v[246:247], v[252:253], v[252:253], v[246:247]
    v_pk_fma_f32 v[246:247], v[254:255], v[254:255], v[246:247]
    v_mfma_f32_32x32x16_bf16 v[112:127], v[52:55], v[56:59], v[112:127]
    v_lshlrev_b32 v252, 16, v58
    v_and_b32 v253, 0xffff0000, v58
    v_lshlrev_b32 v254, 16, v59
    v_and_b32 v255, 0xffff0000, v59
    v_pk_fma_f32 v[246:247], v[252:253], v[252:253], v[246:247]
    v_pk_fma_f32 v[246:247], v[254:255], v[254:255], v[246:247]
    s_add_u32 s44, s66, s71
    s_mov_b64 exec, s[48:49]
    s_add_u32 m0, s46, 24576
    s_nop 0
    buffer_load_dwordx4 v238, s[20:23], s44 offen lds
    s_add_u32 m0, s46, 25600
    s_add_u32 s44, s44, 15360
    buffer_load_dwordx4 v238, s[20:23], s44 offen lds
    s_mov_b64 exec, -1
    s_add_u32 s66, s66, 122880
    s_cmp_ge_u32 s66, 2457600
    s_cselect_b32 s66, 0, s66
    s_add_u32 m0, s75, 36864
    s_nop 0
    buffer_load_dwordx4 v239, s[24:27], s67 offen lds
    s_add_u32 s67, s67, 98304
    s_cmp_ge_u32 s67, 1966080
    s_cselect_b32 s67, 0, s67
    s_add_u32 s44, s66, s71
    s_mov_b64 exec, s[48:49]
    s_add_u32 m0, s46, 0
    s_nop 0
    buffer_load_dwordx4 v238, s[20:23], s44 offen lds
    s_add_u32 m0, s46, 1024
    s_add_u32 s44, s44, 15360
    buffer_load_dwordx4 v238, s[20:23], s44 offen lds
    s_mov_b64 exec, -1
    s_add_u32 s66, s66, 122880
    s_cmp_ge_u32 s66, 2457600
    s_cselect_b32 s66, 0, s66
    s_add_u32 m0, s75, 0
    s_nop 0
    buffer_load_dwordx4 v239, s[24:27], s67 offen lds
    s_add_u32 s67, s67, 98304
    s_cmp_ge_u32 s67, 1966080
    s_cselect_b32 s67, 0, s67
    s_waitcnt lgkmcnt(0)
    v_mfma_f32_32x32x16_bf16 v[64:79], v[16:19], v[32:35], v[64:79]
    ds_read_b128 v[56:59], v245 offset:0
    ds_read_b64_tr_b16 v[40:41], v236 offset:12288
    ds_read_b64_tr_b16 v[42:43], v236 offset:13312
    ds_read_b64_tr_b16 v[44:45], v237 offset:12288
    ds_read_b64_tr_b16 v[46:47], v237 offset:13312
    s_set_gpr_idx_on s63, 0x2
    v_lshlrev_b32 v252, 16, v16
    v_and_b32 v253, 0xffff0000, v16
    v_lshlrev_b32 v254, 16, v17
    v_and_b32 v255, 0xffff0000, v17
    s_set_gpr_idx_off
    v_pk_add_f32 v[248:249], v[248:249], v[252:253]
    v_pk_add_f32 v[248:249], v[248:249], v[254:255]
    v_mfma_f32_32x32x16_bf16 v[80:95], v[20:23], v[32:35], v[80:95]
    ds_read_b64_tr_b16 v[48:49], v184 offset:12288
    ds_read_b64_tr_b16 v[50:51], v184 offset:13312
    ds_read_b64_tr_b16 v[52:53], v185 offset:12288
    ds_read_b64_tr_b16 v[54:55], v185 offset:13312
    s_set_gpr_idx_on s63, 0x2
    v_lshlrev_b32 v252, 16, v18
    v_and_b32 v253, 0xffff0000, v18
    v_lshlrev_b32 v254, 16, v19
    v_and_b32 v255, 0xffff0000, v19
    s_set_gpr_idx_off
    v_pk_add_f32 v[248:249], v[248:249], v[252:253]
    v_pk_add_f32 v[248:249], v[248:249], v[254:255]
    v_mfma_f32_32x32x16_bf16 v[96:111], v[24:27], v[32:35], v[96:111]
    v_lshlrev_b32 v252, 16, v32
    v_and_b32 v253, 0xffff0000, v32
    v_lshlrev_b32 v254, 16, v33
    v_and_b32 v255, 0xffff0000, v33
    v_pk_fma_f32 v[246:247], v[252:253], v[252:253], v[246:247]
    v_pk_fma_f32 v[246:247], v[254:255], v[254:255], v[246:247]
    v_mfma_f32_32x32x16_bf16 v[112:127], v[28:31], v[32:35], v[112:127]
    v_lshlrev_b32 v252, 16, v34
    v_and_b32 v253, 0xffff0000, v34
    v_lshlrev_b32 v254, 16, v35
    v_and_b32 v255, 0xffff0000, v35
    v_pk_fma_f32 v[246:247], v[252:253], v[252:253], v[246:247]
    v_pk_fma_f32 v[246:247], v[254:255], v[254:255], v[246:247]
    s_add_u32 s44, s45, s65
    s_add_u32 m0, s57, 32768
    s_nop 0
    buffer_load_dwordx4 v240, s[16:19], s44 offen lds
    s_add_u32 m0, s57, 33792
    s_nop 0
    buffer_load_dwordx4 v241, s[16:19], s44 offen lds
    s_add_u32 s65, s65, 128
    s_cmp_ge_u32 s65, 1280
    s_cselect_b32 s65, 0, s65
    s_waitcnt lgkmcnt(0)
    v_mfma_f32_32x32x16_bf16 v[64:79], v[40:43], v[56:59], v[64:79]
    s_waitcnt vmcnt(8)
    s_barrier
    s_set_gpr_idx_on s63, 0x2
    v_lshlrev_b32 v252, 16, v40
    v_and_b32 v253, 0xffff0000, v40
    v_lshlrev_b32 v254, 16, v41
    v_and_b32 v255, 0xffff0000, v41
    s_set_gpr_idx_off
    v_pk_add_f32 v[248:249], v[248:249], v[252:253]
    v_pk_add_f32 v[248:249], v[248:249], v[254:255]
    v_mfma_f32_32x32x16_bf16 v[80:95], v[44:47], v[56:59], v[80:95]
    ds_read_b128 v[32:35], v242 offset:16384
    ds_read_b64_tr_b16 v[16:17], v236 offset:16384
    ds_read_b64_tr_b16 v[18:19], v236 offset:17408
    ds_read_b64_tr_b16 v[20:21], v237 offset:16384
    ds_read_b64_tr_b16 v[22:23], v237 offset:17408
    s_set_gpr_idx_on s63, 0x2
    v_lshlrev_b32 v252, 16, v42
    v_and_b32 v253, 0xffff0000, v42
    v_lshlrev_b32 v254, 16, v43
    v_and_b32 v255, 0xffff0000, v43
    s_set_gpr_idx_off
    v_pk_add_f32 v[248:249], v[248:249], v[252:253]
    v_pk_add_f32 v[248:249], v[248:249], v[254:255]
    v_mfma_f32_32x32x16_bf16 v[96:111], v[48:51], v[56:59], v[96:111]
    ds_read_b64_tr_b16 v[24:25], v184 offset:16384
    ds_read_b64_tr_b16 v[26:27], v184 offset:17408
    ds_read_b64_tr_b16 v[28:29], v185 offset:16384
    ds_read_b64_tr_b16 v[30:31], v185 offset:17408
    v_lshlrev_b32 v252, 16, v56
    v_and_b32 v253, 0xffff0000, v56
    v_lshlrev_b32 v254, 16, v57
    v_and_b32 v255, 0xffff0000, v57
    v_pk_fma_f32 v[246:247], v[252:253], v[252:253], v[246:247]
    v_pk_fma_f32 v[246:247], v[254:255], v[254:255], v[246:247]
    v_mfma_f32_32x32x16_bf16 v[112:127], v[52:55], v[56:59], v[112:127]
    v_lshlrev_b32 v252, 16, v58
    v_and_b32 v253, 0xffff0000, v58
    v_lshlrev_b32 v254, 16, v59
    v_and_b32 v255, 0xffff0000, v59
    v_pk_fma_f32 v[246:247], v[252:253], v[252:253], v[246:247]
    v_pk_fma_f32 v[246:247], v[254:255], v[254:255], v[246:247]
    s_add_u32 s44, s66, s71
    s_mov_b64 exec, s[48:49]
    s_add_u32 m0, s46, 8192
    s_nop 0
    buffer_load_dwordx4 v238, s[20:23], s44 offen lds
    s_add_u32 m0, s46, 9216
    s_add_u32 s44, s44, 15360
    buffer_load_dwordx4 v238, s[20:23], s44 offen lds
    s_mov_b64 exec, -1
    s_add_u32 s66, s66, 122880
    s_cmp_ge_u32 s66, 2457600
    s_cselect_b32 s66, 0, s66
    s_add_u32 m0, s75, 12288
    s_nop 0
    buffer_load_dwordx4 v239, s[24:27], s67 offen lds
    s_add_u32 s67, s67, 98304
    s_cmp_ge_u32 s67, 1966080
    s_cselect_b32 s67, 0, s67
    s_add_u32 s44, s45, s65
    s_add_u32 m0, s57, 0
    s_nop 0
    buffer_load_dwordx4 v240, s[16:19], s44 offen lds
    s_add_u32 m0, s57, 1024
    s_nop 0
    buffer_load_dwordx4 v241, s[16:19], s44 offen lds
    s_add_u32 s65, s65, 128
    s_cmp_ge_u32 s65, 1280
    s_cselect_b32 s65, 0, s65
    s_waitcnt lgkmcnt(0)
    v_mfma_f32_32x32x16_bf16 v[64:79], v[16:19], v[32:35], v[64:79]
    ds_read_b128 v[56:59], v243 offset:16384
    ds_read_b64_tr_b16 v[40:41], v236 offset:20480
    ds_read_b64_tr_b16 v[42:43], v236 offset:21504
    ds_read_b64_tr_b16 v[44:45], v237 offset:20480
    ds_read_b64_tr_b16 v[46:47], v237 offset:21504
    v_add_f32 v248, v248, v249
    v_mov_b32 v249, v248
    s_nop 1
    v_permlane32_swap_b32 v249, v248
    s_nop 1
    v_add_f32 v248, v248, v249
    v_lshlrev_b32 v252, 2, v4
    buffer_store_dword v248, v252, s[32:35], s51 offen offset:0 sc1
    v_add_f32 v246, v246, v247
    v_mov_b32 v247, v246
    s_lshl_b32 s43, s42, 9
    s_add_u32 s43, s43, s62
    v_permlane32_swap_b32 v247, v246
    s_nop 1
    v_add_f32 v246, v246, v247
    buffer_store_dword v246, v188, s[32:35], s43 offen sc1
    v_mfma_f32_32x32x16_bf16 v[80:95], v[20:23], v[32:35], v[80:95]
    ds_read_b64_tr_b16 v[48:49], v184 offset:20480
    ds_read_b64_tr_b16 v[50:51], v184 offset:21504
    ds_read_b64_tr_b16 v[52:53], v185 offset:20480
    ds_read_b64_tr_b16 v[54:55], v185 offset:21504
    v_mfma_f32_32x32x16_bf16 v[96:111], v[24:27], v[32:35], v[96:111]
    v_mfma_f32_32x32x16_bf16 v[112:127], v[28:31], v[32:35], v[112:127]
    s_waitcnt lgkmcnt(0)
    v_mfma_f32_32x32x16_bf16 v[64:79], v[40:43], v[56:59], v[64:79]
    s_waitcnt vmcnt(12)
    s_barrier
    v_mfma_f32_32x32x16_bf16 v[80:95], v[44:47], v[56:59], v[80:95]
    ds_read_b128 v[32:35], v244 offset:16384
    ds_read_b64_tr_b16 v[16:17], v236 offset:24576
    ds_read_b64_tr_b16 v[18:19], v236 offset:25600
    ds_read_b64_tr_b16 v[20:21], v237 offset:24576
    ds_read_b64_tr_b16 v[22:23], v237 offset:25600
    v_mfma_f32_32x32x16_bf16 v[96:111], v[48:51], v[56:59], v[96:111]
    ds_read_b64_tr_b16 v[24:25], v184 offset:24576
    ds_read_b64_tr_b16 v[26:27], v184 offset:25600
    ds_read_b64_tr_b16 v[28:29], v185 offset:24576
    ds_read_b64_tr_b16 v[30:31], v185 offset:25600
    v_mfma_f32_32x32x16_bf16 v[112:127], v[52:55], v[56:59], v[112:127]
    s_add_u32 s44, s66, s71
    s_mov_b64 exec, s[48:49]
    s_add_u32 m0, s46, 16384
    s_nop 0
    buffer_load_dwordx4 v238, s[20:23], s44 offen lds
    s_add_u32 m0, s46, 17408
    s_add_u32 s44, s44, 15360
    buffer_load_dwordx4 v238, s[20:23], s44 offen lds
    s_mov_b64 exec, -1
    s_add_u32 s66, s66, 122880
    s_cmp_ge_u32 s66, 2457600
    s_cselect_b32 s66, 0, s66
    s_add_u32 m0, s75, 24576
    s_nop 0
    buffer_load_dwordx4 v239, s[24:27], s67 offen lds
    s_add_u32 s67, s67, 98304
    s_cmp_ge_u32 s67, 1966080
    s_cselect_b32 s67, 0, s67
    s_waitcnt lgkmcnt(0)
    v_mfma_f32_32x32x16_bf16 v[64:79], v[16:19], v[32:35], v[64:79]
    ds_read_b128 v[56:59], v245 offset:16384
    ds_read_b64_tr_b16 v[40:41], v236 offset:28672
    ds_read_b64_tr_b16 v[42:43], v236 offset:29696
    ds_read_b64_tr_b16 v[44:45], v237 offset:28672
    ds_read_b64_tr_b16 v[46:47], v237 offset:29696
    v_mfma_f32_32x32x16_bf16 v[80:95], v[20:23], v[32:35], v[80:95]
    ds_read_b64_tr_b16 v[48:49], v184 offset:28672
    ds_read_b64_tr_b16 v[50:51], v184 offset:29696
    ds_read_b64_tr_b16 v[52:53], v185 offset:28672
    ds_read_b64_tr_b16 v[54:55], v185 offset:29696
    v_mfma_f32_32x32x16_bf16 v[96:111], v[24:27], v[32:35], v[96:111]
    v_mfma_f32_32x32x16_bf16 v[112:127], v[28:31], v[32:35], v[112:127]
    s_waitcnt lgkmcnt(0)
    v_mfma_f32_32x32x16_bf16 v[64:79], v[40:43], v[56:59], v[64:79]
    s_waitcnt vmcnt(10)
    s_barrier
    v_mfma_f32_32x32x16_bf16 v[80:95], v[44:47], v[56:59], v[80:95]
    ds_read_b128 v[32:35], v242 offset:32768
    ds_read_b64_tr_b16 v[16:17], v236 offset:0
    ds_read_b64_tr_b16 v[18:19], v236 offset:1024
    ds_read_b64_tr_b16 v[20:21], v237 offset:0
    ds_read_b64_tr_b16 v[22:23], v237 offset:1024
    v_mfma_f32_32x32x16_bf16 v[96:111], v[48:51], v[56:59], v[96:111]
    ds_read_b64_tr_b16 v[24:25], v184 offset:0
    ds_read_b64_tr_b16 v[26:27], v184 offset:1024
    ds_read_b64_tr_b16 v[28:29], v185 offset:0
    ds_read_b64_tr_b16 v[30:31], v185 offset:1024
    v_mfma_f32_32x32x16_bf16 v[112:127], v[52:55], v[56:59], v[112:127]
    s_add_u32 s44, s66, s71
    s_mov_b64 exec, s[48:49]
    s_add_u32 m0, s46, 24576
    s_nop 0
    buffer_load_dwordx4 v238, s[20:23], s44 offen lds
    s_add_u32 m0, s46, 25600
    s_add_u32 s44, s44, 15360
    buffer_load_dwordx4 v238, s[20:23], s44 offen lds
    s_mov_b64 exec, -1
    s_add_u32 s66, s66, 122880
    s_cmp_ge_u32 s66, 2457600
    s_cselect_b32 s66, 0, s66
    s_add_u32 m0, s75, 36864
    s_nop 0
    buffer_load_dwordx4 v239, s[24:27], s67 offen lds
    s_add_u32 s67, s67, 98304
    s_cmp_ge_u32 s67, 1966080
    s_cselect_b32 s67, 0, s67
    s_add_u32 s44, s45, s65
    s_add_u32 m0, s57, 16384
    s_nop 0
    buffer_load_dwordx4 v240, s[16:19], s44 offen lds
    s_add_u32 m0, s57, 17408
    s_nop 0
    buffer_load_dwordx4 v241, s[16:19], s44 offen lds
    s_add_u32 s65, s65, 128
    s_cmp_ge_u32 s65, 1280
    s_cselect_b32 s65, 0, s65
    s_waitcnt lgkmcnt(0)
    v_mfma_f32_32x32x16_bf16 v[64:79], v[16:19], v[32:35], v[64:79]
    ds_read_b128 v[56:59], v243 offset:32768
    ds_read_b64_tr_b16 v[40:41], v236 offset:4096
    ds_read_b64_tr_b16 v[42:43], v236 offset:5120
    ds_read_b64_tr_b16 v[44:45], v237 offset:4096
    ds_read_b64_tr_b16 v[46:47], v237 offset:5120
    v_mfma_f32_32x32x16_bf16 v[80:95], v[20:23], v[32:35], v[80:95]
    ds_read_b64_tr_b16 v[48:49], v184 offset:4096
    ds_read_b64_tr_b16 v[50:51], v184 offset:5120
    ds_read_b64_tr_b16 v[52:53], v185 offset:4096
    ds_read_b64_tr_b16 v[54:55], v185 offset:5120
    v_mfma_f32_32x32x16_bf16 v[96:111], v[24:27], v[32:35], v[96:111]
    v_mfma_f32_32x32x16_bf16 v[112:127], v[28:31], v[32:35], v[112:127]
    s_waitcnt lgkmcnt(0)
    v_mfma_f32_32x32x16_bf16 v[64:79], v[40:43], v[56:59], v[64:79]
    s_waitcnt vmcnt(8)
    s_barrier
    v_mfma_f32_32x32x16_bf16 v[80:95], v[44:47], v[56:59], v[80:95]
    ds_read_b128 v[32:35], v244 offset:32768
    ds_read_b64_tr_b16 v[16:17], v236 offset:8192
    ds_read_b64_tr_b16 v[18:19], v236 offset:9216
    ds_read_b64_tr_b16 v[20:21], v237 offset:8192
    ds_read_b64_tr_b16 v[22:23], v237 offset:9216
    v_mfma_f32_32x32x16_bf16 v[96:111], v[48:51], v[56:59], v[96:111]
    ds_read_b64_tr_b16 v[24:25], v184 offset:8192
    ds_read_b64_tr_b16 v[26:27], v184 offset:9216
    ds_read_b64_tr_b16 v[28:29], v185 offset:8192
    ds_read_b64_tr_b16 v[30:31], v185 offset:9216
    v_mfma_f32_32x32x16_bf16 v[112:127], v[52:55], v[56:59], v[112:127]
    s_cmp_lt_u32 s41, 10
    s_cselect_b32 s43, 1, 0
    s_cmp_eq_u32 s40, 0
    s_cselect_b32 s43, s43, 0
    v_mov_b32 v252, 1
    v_mov_b32 v253, 0
    s_mov_b32 exec_lo, s43
    s_mov_b32 exec_hi, 0
    buffer_atomic_add v252, v253, s[52:55], s56 offen sc1
    s_cmp_lt_u32 s42, 10
    s_cselect_b32 s43, 1, 0
    s_cmp_eq_u32 s40, 0
    s_cselect_b32 s43, s43, 0
    s_mov_b32 exec_lo, s43
    buffer_atomic_add v252, v253, s[52:55], s70 offen sc1
    s_mov_b64 exec, -1
    s_add_u32 s44, s66, s71
    s_mov_b64 exec, s[48:49]
    s_add_u32 m0, s46, 0
    s_nop 0
    buffer_load_dwordx4 v238, s[20:23], s44 offen lds
    s_add_u32 m0, s46, 1024
    s_add_u32 s44, s44, 15360
    buffer_load_dwordx4 v238, s[20:23], s44 offen lds
    s_mov_b64 exec, -1
    s_add_u32 s66, s66, 122880
    s_cmp_ge_u32 s66, 2457600
    s_cselect_b32 s66, 0, s66
    s_add_u32 m0, s75, 0
    s_nop 0
    buffer_load_dwordx4 v239, s[24:27], s67 offen lds
    s_add_u32 s67, s67, 98304
    s_cmp_ge_u32 s67, 1966080
    s_cselect_b32 s67, 0, s67
    s_waitcnt lgkmcnt(0)
    v_mfma_f32_32x32x16_bf16 v[64:79], v[16:19], v[32:35], v[64:79]
    ds_read_b128 v[56:59], v245 offset:32768
    ds_read_b64_tr_b16 v[40:41], v236 offset:12288
    ds_read_b64_tr_b16 v[42:43], v236 offset:13312
    ds_read_b64_tr_b16 v[44:45], v237 offset:12288
    ds_read_b64_tr_b16 v[46:47], v237 offset:13312
    v_mfma_f32_32x32x16_bf16 v[80:95], v[20:23], v[32:35], v[80:95]
    ds_read_b64_tr_b16 v[48:49], v184 offset:12288
    ds_read_b64_tr_b16 v[50:51], v184 offset:13312
    ds_read_b64_tr_b16 v[52:53], v185 offset:12288
    ds_read_b64_tr_b16 v[54:55], v185 offset:13312
    v_mfma_f32_32x32x16_bf16 v[96:111], v[24:27], v[32:35], v[96:111]
    v_mfma_f32_32x32x16_bf16 v[112:127], v[28:31], v[32:35], v[112:127]
    s_waitcnt lgkmcnt(0)
    v_mfma_f32_32x32x16_bf16 v[64:79], v[40:43], v[56:59], v[64:79]
    s_waitcnt vmcnt(10)
    s_barrier
    v_mfma_f32_32x32x16_bf16 v[80:95], v[44:47], v[56:59], v[80:95]
    ds_read_b128 v[32:35], v242 offset:0
    ds_read_b64_tr_b16 v[16:17], v236 offset:16384
    ds_read_b64_tr_b16 v[18:19], v236 offset:17408
    ds_read_b64_tr_b16 v[20:21], v237 offset:16384
    ds_read_b64_tr_b16 v[22:23], v237 offset:17408
    v_mfma_f32_32x32x16_bf16 v[96:111], v[48:51], v[56:59], v[96:111]
    ds_read_b64_tr_b16 v[24:25], v184 offset:16384
    ds_read_b64_tr_b16 v[26:27], v184 offset:17408
    ds_read_b64_tr_b16 v[28:29], v185 offset:16384
    ds_read_b64_tr_b16 v[30:31], v185 offset:17408
    v_mfma_f32_32x32x16_bf16 v[112:127], v[52:55], v[56:59], v[112:127]
    s_add_u32 s44, s66, s71
    s_mov_b64 exec, s[48:49]
    s_add_u32 m0, s46, 8192
    s_nop 0
    buffer_load_dwordx4 v238, s[20:23], s44 offen lds
    s_add_u32 m0, s46, 9216
    s_add_u32 s44, s44, 15360
    buffer_load_dwordx4 v238, s[20:23], s44 offen lds
    s_mov_b64 exec, -1
    s_add_u32 s66, s66, 122880
    s_cmp_ge_u32 s66, 2457600
    s_cselect_b32 s66, 0, s66
    s_add_u32 m0, s75, 12288
    s_nop 0
    buffer_load_dwordx4 v239, s[24:27], s67 offen lds
    s_add_u32 s67, s67, 98304
    s_cmp_ge_u32 s67, 1966080
    s_cselect_b32 s67, 0, s67
    s_add_u32 s44, s45, s65
    s_add_u32 m0, s57, 32768
    s_nop 0
    buffer_load_dwordx4 v240, s[16:19], s44 offen lds
    s_add_u32 m0, s57, 33792
    s_nop 0
    buffer_load_dwordx4 v241, s[16:19], s44 offen lds
    s_add_u32 s65, s65, 128
    s_cmp_ge_u32 s65, 1280
    s_cselect_b32 s65, 0, s65
    s_waitcnt lgkmcnt(0)
    v_mfma_f32_32x32x16_bf16 v[64:79], v[16:19], v[32:35], v[64:79]
    ds_read_b128 v[56:59], v243 offset:0
    ds_read_b64_tr_b16 v[40:41], v236 offset:20480
    ds_read_b64_tr_b16 v[42:43], v236 offset:21504
    ds_read_b64_tr_b16 v[44:45], v237 offset:20480
    ds_read_b64_tr_b16 v[46:47], v237 offset:21504
    v_mfma_f32_32x32x16_bf16 v[80:95], v[20:23], v[32:35], v[80:95]
    ds_read_b64_tr_b16 v[48:49], v184 offset:20480
    ds_read_b64_tr_b16 v[50:51], v184 offset:21504
    ds_read_b64_tr_b16 v[52:53], v185 offset:20480
    ds_read_b64_tr_b16 v[54:55], v185 offset:21504
    v_mfma_f32_32x32x16_bf16 v[96:111], v[24:27], v[32:35], v[96:111]
    v_mfma_f32_32x32x16_bf16 v[112:127], v[28:31], v[32:35], v[112:127]
    s_waitcnt lgkmcnt(0)
    v_mfma_f32_32x32x16_bf16 v[64:79], v[40:43], v[56:59], v[64:79]
    s_waitcnt vmcnt(12)
    s_barrier
    v_mfma_f32_32x32x16_bf16 v[80:95], v[44:47], v[56:59], v[80:95]
    ds_read_b128 v[32:35], v244 offset:0
    ds_read_b64_tr_b16 v[16:17], v236 offset:24576
    ds_read_b64_tr_b16 v[18:19], v236 offset:25600
    ds_read_b64_tr_b16 v[20:21], v237 offset:24576
    ds_read_b64_tr_b16 v[22:23], v237 offset:25600
    v_mfma_f32_32x32x16_bf16 v[96:111], v[48:51], v[56:59], v[96:111]
    ds_read_b64_tr_b16 v[24:25], v184 offset:24576
    ds_read_b64_tr_b16 v[26:27], v184 offset:25600
    ds_read_b64_tr_b16 v[28:29], v185 offset:24576
    ds_read_b64_tr_b16 v[30:31], v185 offset:25600
    v_mfma_f32_32x32x16_bf16 v[112:127], v[52:55], v[56:59], v[112:127]
    s_add_u32 s44, s66, s71
    s_mov_b64 exec, s[48:49]
    s_add_u32 m0, s46, 16384
    s_nop 0
    buffer_load_dwordx4 v238, s[20:23], s44 offen lds
    s_add_u32 m0, s46, 17408
    s_add_u32 s44, s44, 15360
    buffer_load_dwordx4 v238, s[20:23], s44 offen lds
    s_mov_b64 exec, -1
    s_add_u32 s66, s66, 122880
    s_cmp_ge_u32 s66, 2457600
    s_cselect_b32 s66, 0, s66
    s_add_u32 m0, s75, 24576
    s_nop 0
    buffer_load_dwordx4 v239, s[24:27], s67 offen lds
    s_add_u32 s67, s67, 98304
    s_cmp_ge_u32 s67, 1966080
    s_cselect_b32 s67, 0, s67
    s_waitcnt lgkmcnt(0)
    v_mfma_f32_32x32x16_bf16 v[64:79], v[16:19], v[32:35], v[64:79]
    ds_read_b128 v[56:59], v245 offset:0
    ds_read_b64_tr_b16 v[40:41], v236 offset:28672
    ds_read_b64_tr_b16 v[42:43], v236 offset:29696
    ds_read_b64_tr_b16 v[44:45], v237 offset:28672
    ds_read_b64_tr_b16 v[46:47], v237 offset:29696
    v_mfma_f32_32x32x16_bf16 v[80:95], v[20:23], v[32:35], v[80:95]
    ds_read_b64_tr_b16 v[48:49], v184 offset:28672
    ds_read_b64_tr_b16 v[50:51], v184 offset:29696
    ds_read_b64_tr_b16 v[52:53], v185 offset:28672
    ds_read_b64_tr_b16 v[54:55], v185 offset:29696
    v_mfma_f32_32x32x16_bf16 v[96:111], v[24:27], v[32:35], v[96:111]
    v_mfma_f32_32x32x16_bf16 v[112:127], v[28:31], v[32:35], v[112:127]
    s_waitcnt lgkmcnt(0)
    v_mfma_f32_32x32x16_bf16 v[64:79], v[40:43], v[56:59], v[64:79]
    s_waitcnt vmcnt(8)
    s_barrier
    v_mfma_f32_32x32x16_bf16 v[80:95], v[44:47], v[56:59], v[80:95]
    ds_read_b128 v[32:35], v242 offset:16384
    ds_read_b64_tr_b16 v[16:17], v236 offset:0
    ds_read_b64_tr_b16 v[18:19], v236 offset:1024
    ds_read_b64_tr_b16 v[20:21], v237 offset:0
    ds_read_b64_tr_b16 v[22:23], v237 offset:1024
    v_mfma_f32_32x32x16_bf16 v[96:111], v[48:51], v[56:59], v[96:111]
    ds_read_b64_tr_b16 v[24:25], v184 offset:0
    ds_read_b64_tr_b16 v[26:27], v184 offset:1024
    ds_read_b64_tr_b16 v[28:29], v185 offset:0
    ds_read_b64_tr_b16 v[30:31], v185 offset:1024
    v_mfma_f32_32x32x16_bf16 v[112:127], v[52:55], v[56:59], v[112:127]
    s_add_u32 s44, s66, s71
    s_mov_b64 exec, s[48:49]
    s_add_u32 m0, s46, 24576
    s_nop 0
    buffer_load_dwordx4 v238, s[20:23], s44 offen lds
    s_add_u32 m0, s46, 25600
    s_add_u32 s44, s44, 15360
    buffer_load_dwordx4 v238, s[20:23], s44 offen lds
    s_mov_b64 exec, -1
    s_add_u32 s66, s66, 122880
    s_cmp_ge_u32 s66, 2457600
    s_cselect_b32 s66, 0, s66
    s_add_u32 m0, s75, 36864
    s_nop 0
    buffer_load_dwordx4 v239, s[24:27], s67 offen lds
    s_add_u32 s67, s67, 98304
    s_cmp_ge_u32 s67, 1966080
    s_cselect_b32 s67, 0, s67
    s_add_u32 s44, s45, s65
    s_add_u32 m0, s57, 0
    s_nop 0
    buffer_load_dwordx4 v240, s[16:19], s44 offen lds
    s_add_u32 m0, s57, 1024
    s_nop 0
    buffer_load_dwordx4 v241, s[16:19], s44 offen lds
    s_add_u32 s65, s65, 128
    s_cmp_ge_u32 s65, 1280
    s_cselect_b32 s65, 0, s65
    s_waitcnt lgkmcnt(0)
    v_mfma_f32_32x32x16_bf16 v[64:79], v[16:19], v[32:35], v[64:79]
    ds_read_b128 v[56:59], v243 offset:16384
    ds_read_b64_tr_b16 v[40:41], v236 offset:4096
    ds_read_b64_tr_b16 v[42:43], v236 offset:5120
    ds_read_b64_tr_b16 v[44:45], v237 offset:4096
    ds_read_b64_tr_b16 v[46:47], v237 offset:5120
    v_mfma_f32_32x32x16_bf16 v[80:95], v[20:23], v[32:35], v[80:95]
    ds_read_b64_tr_b16 v[48:49], v184 offset:4096
    ds_read_b64_tr_b16 v[50:51], v184 offset:5120
    ds_read_b64_tr_b16 v[52:53], v185 offset:4096
    ds_read_b64_tr_b16 v[54:55], v185 offset:5120
    v_mfma_f32_32x32x16_bf16 v[96:111], v[24:27], v[32:35], v[96:111]
    v_mfma_f32_32x32x16_bf16 v[112:127], v[28:31], v[32:35], v[112:127]
    s_waitcnt lgkmcnt(0)
    v_mfma_f32_32x32x16_bf16 v[64:79], v[40:43], v[56:59], v[64:79]
    s_waitcnt vmcnt(10)
    s_barrier
    v_mfma_f32_32x32x16_bf16 v[80:95], v[44:47], v[56:59], v[80:95]
    ds_read_b128 v[32:35], v244 offset:16384
    ds_read_b64_tr_b16 v[16:17], v236 offset:8192
    ds_read_b64_tr_b16 v[18:19], v236 offset:9216
    ds_read_b64_tr_b16 v[20:21], v237 offset:8192
    ds_read_b64_tr_b16 v[22:23], v237 offset:9216
    v_mfma_f32_32x32x16_bf16 v[96:111], v[48:51], v[56:59], v[96:111]
    ds_read_b64_tr_b16 v[24:25], v184 offset:8192
    ds_read_b64_tr_b16 v[26:27], v184 offset:9216
    ds_read_b64_tr_b16 v[28:29], v185 offset:8192
    ds_read_b64_tr_b16 v[30:31], v185 offset:9216
    v_mfma_f32_32x32x16_bf16 v[112:127], v[52:55], v[56:59], v[112:127]
    s_add_u32 s44, s66, s71
    s_mov_b64 exec, s[48:49]
    s_add_u32 m0, s46, 0
    s_nop 0
    buffer_load_dwordx4 v238, s[20:23], s44 offen lds
    s_add_u32 m0, s46, 1024
    s_add_u32 s44, s44, 15360
    buffer_load_dwordx4 v238, s[20:23], s44 offen lds
    s_mov_b64 exec, -1
    s_add_u32 s66, s66, 122880
    s_cmp_ge_u32 s66, 2457600
    s_cselect_b32 s66, 0, s66
    s_add_u32 m0, s75, 0
    s_nop 0
    buffer_load_dwordx4 v239, s[24:27], s67 offen lds
    s_add_u32 s67, s67, 98304
    s_cmp_ge_u32 s67, 1966080
    s_cselect_b32 s67, 0, s67
    s_waitcnt lgkmcnt(0)
    v_mfma_f32_32x32x16_bf16 v[64:79], v[16:19], v[32:35], v[64:79]
    ds_read_b128 v[56:59], v245 offset:16384
    ds_read_b64_tr_b16 v[40:41], v236 offset:12288
    ds_read_b64_tr_b16 v[42:43], v236 offset:13312
    ds_read_b64_tr_b16 v[44:45], v237 offset:12288
    ds_read_b64_tr_b16 v[46:47], v237 offset:13312
    v_mfma_f32_32x32x16_bf16 v[80:95], v[20:23], v[32:35], v[80:95]
    ds_read_b64_tr_b16 v[48:49], v184 offset:12288
    ds_read_b64_tr_b16 v[50:51], v184 offset:13312
    ds_read_b64_tr_b16 v[52:53], v185 offset:12288
    ds_read_b64_tr_b16 v[54:55], v185 offset:13312
    v_mfma_f32_32x32x16_bf16 v[96:111], v[24:27], v[32:35], v[96:111]
    v_mfma_f32_32x32x16_bf16 v[112:127], v[28:31], v[32:35], v[112:127]
    s_waitcnt lgkmcnt(0)
    v_mfma_f32_32x32x16_bf16 v[64:79], v[40:43], v[56:59], v[64:79]
    s_waitcnt vmcnt(8)
    s_barrier
    v_mfma_f32_32x32x16_bf16 v[80:95], v[44:47], v[56:59], v[80:95]
    ds_read_b128 v[32:35], v242 offset:32768
    ds_read_b64_tr_b16 v[16:17], v236 offset:16384
    ds_read_b64_tr_b16 v[18:19], v236 offset:17408
    ds_read_b64_tr_b16 v[20:21], v237 offset:16384
    ds_read_b64_tr_b16 v[22:23], v237 offset:17408
    v_mfma_f32_32x32x16_bf16 v[96:111], v[48:51], v[56:59], v[96:111]
    ds_read_b64_tr_b16 v[24:25], v184 offset:16384
    ds_read_b64_tr_b16 v[26:27], v184 offset:17408
    ds_read_b64_tr_b16 v[28:29], v185 offset:16384
    ds_read_b64_tr_b16 v[30:31], v185 offset:17408
    v_mfma_f32_32x32x16_bf16 v[112:127], v[52:55], v[56:59], v[112:127]
    s_add_u32 s44, s66, s71
    s_mov_b64 exec, s[48:49]
    s_add_u32 m0, s46, 8192
    s_nop 0
    buffer_load_dwordx4 v238, s[20:23], s44 offen lds
    s_add_u32 m0, s46, 9216
    s_add_u32 s44, s44, 15360
    buffer_load_dwordx4 v238, s[20:23], s44 offen lds
    s_mov_b64 exec, -1
    s_add_u32 s66, s66, 122880
    s_cmp_ge_u32 s66, 2457600
    s_cselect_b32 s66, 0, s66
    s_add_u32 m0, s75, 12288
    s_nop 0
    buffer_load_dwordx4 v239, s[24:27], s67 offen lds
    s_add_u32 s67, s67, 98304
    s_cmp_ge_u32 s67, 1966080
    s_cselect_b32 s67, 0, s67
    s_add_u32 s44, s45, s65
    s_add_u32 m0, s57, 16384
    s_nop 0
    buffer_load_dwordx4 v240, s[16:19], s44 offen lds
    s_add_u32 m0, s57, 17408
    s_nop 0
    buffer_load_dwordx4 v241, s[16:19], s44 offen lds
    s_add_u32 s65, s65, 128
    s_cmp_ge_u32 s65, 1280
    s_cselect_b32 s65, 0, s65
    s_waitcnt lgkmcnt(0)
    v_mfma_f32_32x32x16_bf16 v[64:79], v[16:19], v[32:35], v[64:79]
    ds_read_b128 v[56:59], v243 offset:32768
    ds_read_b64_tr_b16 v[40:41], v236 offset:20480
    ds_read_b64_tr_b16 v[42:43], v236 offset:21504
    ds_read_b64_tr_b16 v[44:45], v237 offset:20480
    ds_read_b64_tr_b16 v[46:47], v237 offset:21504
    v_mfma_f32_32x32x16_bf16 v[80:95], v[20:23], v[32:35], v[80:95]
    ds_read_b64_tr_b16 v[48:49], v184 offset:20480
    ds_read_b64_tr_b16 v[50:51], v184 offset:21504
    ds_read_b64_tr_b16 v[52:53], v185 offset:20480
    ds_read_b64_tr_b16 v[54:55], v185 offset:21504
    v_mfma_f32_32x32x16_bf16 v[96:111], v[24:27], v[32:35], v[96:111]
    v_mfma_f32_32x32x16_bf16 v[112:127], v[28:31], v[32:35], v[112:127]
    s_waitcnt lgkmcnt(0)
    v_mfma_f32_32x32x16_bf16 v[64:79], v[40:43], v[56:59], v[64:79]
    s_waitcnt vmcnt(10)
    s_barrier
    v_mfma_f32_32x32x16_bf16 v[80:95], v[44:47], v[56:59], v[80:95]
    ds_read_b128 v[32:35], v244 offset:32768
    ds_read_b64_tr_b16 v[16:17], v236 offset:24576
    ds_read_b64_tr_b16 v[18:19], v236 offset:25600
    ds_read_b64_tr_b16 v[20:21], v237 offset:24576
    ds_read_b64_tr_b16 v[22:23], v237 offset:25600
    v_mfma_f32_32x32x16_bf16 v[96:111], v[48:51], v[56:59], v[96:111]
    ds_read_b64_tr_b16 v[24:25], v184 offset:24576
    ds_read_b64_tr_b16 v[26:27], v184 offset:25600
    ds_read_b64_tr_b16 v[28:29], v185 offset:24576
    ds_read_b64_tr_b16 v[30:31], v185 offset:25600
    v_mfma_f32_32x32x16_bf16 v[112:127], v[52:55], v[56:59], v[112:127]
    s_add_u32 s44, s66, s71
    s_mov_b64 exec, s[48:49]
    s_add_u32 m0, s46, 16384
    s_nop 0
    buffer_load_dwordx4 v238, s[20:23], s44 offen lds
    s_add_u32 m0, s46, 17408
    s_add_u32 s44, s44, 15360
    buffer_load_dwordx4 v238, s[20:23], s44 offen lds
    s_mov_b64 exec, -1
    s_add_u32 s66, s66, 122880
    s_cmp_ge_u32 s66, 2457600
    s_cselect_b32 s66, 0, s66
    s_add_u32 m0, s75, 24576
    s_nop 0
    buffer_load_dwordx4 v239, s[24:27], s67 offen lds
    s_add_u32 s67, s67, 98304
    s_cmp_ge_u32 s67, 1966080
    s_cselect_b32 s67, 0, s67
    s_waitcnt lgkmcnt(0)
    v_mfma_f32_32x32x16_bf16 v[64:79], v[16:19], v[32:35], v[64:79]
    ds_read_b128 v[56:59], v245 offset:32768
    ds_read_b64_tr_b16 v[40:41], v236 offset:28672
    ds_read_b64_tr_b16 v[42:43], v236 offset:29696
    ds_read_b64_tr_b16 v[44:45], v237 offset:28672
    ds_read_b64_tr_b16 v[46:47], v237 offset:29696
    v_mfma_f32_32x32x16_bf16 v[80:95], v[20:23], v[32:35], v[80:95]
    ds_read_b64_tr_b16 v[48:49], v184 offset:28672
    ds_read_b64_tr_b16 v[50:51], v184 offset:29696
    ds_read_b64_tr_b16 v[52:53], v185 offset:28672
    ds_read_b64_tr_b16 v[54:55], v185 offset:29696
    v_mfma_f32_32x32x16_bf16 v[96:111], v[24:27], v[32:35], v[96:111]
    v_mfma_f32_32x32x16_bf16 v[112:127], v[28:31], v[32:35], v[112:127]
    s_waitcnt lgkmcnt(0)
    v_mfma_f32_32x32x16_bf16 v[64:79], v[40:43], v[56:59], v[64:79]
    s_waitcnt vmcnt(8)
    s_barrier
    v_mfma_f32_32x32x16_bf16 v[80:95], v[44:47], v[56:59], v[80:95]
    ds_read_b128 v[32:35], v242 offset:0
    ds_read_b64_tr_b16 v[16:17], v236 offset:0
    ds_read_b64_tr_b16 v[18:19], v236 offset:1024
    ds_read_b64_tr_b16 v[20:21], v237 offset:0
    ds_read_b64_tr_b16 v[22:23], v237 offset:1024
    v_mfma_f32_32x32x16_bf16 v[96:111], v[48:51], v[56:59], v[96:111]
    ds_read_b64_tr_b16 v[24:25], v184 offset:0
    ds_read_b64_tr_b16 v[26:27], v184 offset:1024
    ds_read_b64_tr_b16 v[28:29], v185 offset:0
    ds_read_b64_tr_b16 v[30:31], v185 offset:1024
    v_mfma_f32_32x32x16_bf16 v[112:127], v[52:55], v[56:59], v[112:127]
    s_add_u32 s44, s66, s71
    s_mov_b64 exec, s[48:49]
    s_add_u32 m0, s46, 24576
    s_nop 0
    buffer_load_dwordx4 v238, s[20:23], s44 offen lds
    s_add_u32 m0, s46, 25600
    s_add_u32 s44, s44, 15360
    buffer_load_dwordx4 v238, s[20:23], s44 offen lds
    s_mov_b64 exec, -1
    s_add_u32 s66, s66, 122880
    s_cmp_ge_u32 s66, 2457600
    s_cselect_b32 s66, 0, s66
    s_add_u32 m0, s75, 36864
    s_nop 0
    buffer_load_dwordx4 v239, s[24:27], s67 offen lds
    s_add_u32 s67, s67, 98304
    s_cmp_ge_u32 s67, 1966080
    s_cselect_b32 s67, 0, s67
    s_add_u32 s44, s45, s65
    s_add_u32 m0, s57, 32768
    s_nop 0
    buffer_load_dwordx4 v240, s[16:19], s44 offen lds
    s_add_u32 m0, s57, 33792
    s_nop 0
    buffer_load_dwordx4 v241, s[16:19], s44 offen lds
    s_add_u32 s65, s65, 128
    s_cmp_ge_u32 s65, 1280
    s_cselect_b32 s65, 0, s65
    s_waitcnt lgkmcnt(0)
    v_mfma_f32_32x32x16_bf16 v[64:79], v[16:19], v[32:35], v[64:79]
    ds_read_b128 v[56:59], v243 offset:0
    ds_read_b64_tr_b16 v[40:41], v236 offset:4096
    ds_read_b64_tr_b16 v[42:43], v236 offset:5120
    ds_read_b64_tr_b16 v[44:45], v237 offset:4096
    ds_read_b64_tr_b16 v[46:47], v237 offset:5120
    v_mfma_f32_32x32x16_bf16 v[80:95], v[20:23], v[32:35], v[80:95]
    ds_read_b64_tr_b16 v[48:49], v184 offset:4096
    ds_read_b64_tr_b16 v[50:51], v184 offset:5120
    ds_read_b64_tr_b16 v[52:53], v185 offset:4096
    ds_read_b64_tr_b16 v[54:55], v185 offset:5120
    v_mfma_f32_32x32x16_bf16 v[96:111], v[24:27], v[32:35], v[96:111]
    v_mfma_f32_32x32x16_bf16 v[112:127], v[28:31], v[32:35], v[112:127]
    s_waitcnt lgkmcnt(0)
    v_mfma_f32_32x32x16_bf16 v[64:79], v[40:43], v[56:59], v[64:79]
    s_waitcnt vmcnt(10)
    s_barrier
    v_mfma_f32_32x32x16_bf16 v[80:95], v[44:47], v[56:59], v[80:95]
    ds_read_b128 v[32:35], v244 offset:0
    ds_read_b64_tr_b16 v[16:17], v236 offset:8192
    ds_read_b64_tr_b16 v[18:19], v236 offset:9216
    ds_read_b64_tr_b16 v[20:21], v237 offset:8192
    ds_read_b64_tr_b16 v[22:23], v237 offset:9216
    v_mfma_f32_32x32x16_bf16 v[96:111], v[48:51], v[56:59], v[96:111]
    ds_read_b64_tr_b16 v[24:25], v184 offset:8192
    ds_read_b64_tr_b16 v[26:27], v184 offset:9216
    ds_read_b64_tr_b16 v[28:29], v185 offset:8192
    ds_read_b64_tr_b16 v[30:31], v185 offset:9216
    v_mfma_f32_32x32x16_bf16 v[112:127], v[52:55], v[56:59], v[112:127]
    s_add_u32 s44, s66, s71
    s_mov_b64 exec, s[48:49]
    s_add_u32 m0, s46, 0
    s_nop 0
    buffer_load_dwordx4 v238, s[20:23], s44 offen lds
    s_add_u32 m0, s46, 1024
    s_add_u32 s44, s44, 15360
    buffer_load_dwordx4 v238, s[20:23], s44 offen lds
    s_mov_b64 exec, -1
    s_add_u32 s66, s66, 122880
    s_cmp_ge_u32 s66, 2457600
    s_cselect_b32 s66, 0, s66
    s_add_u32 m0, s75, 0
    s_nop 0
    buffer_load_dwordx4 v239, s[24:27], s67 offen lds
    s_add_u32 s67, s67, 98304
    s_cmp_ge_u32 s67, 1966080
    s_cselect_b32 s67, 0, s67
    s_waitcnt lgkmcnt(0)
    v_mfma_f32_32x32x16_bf16 v[64:79], v[16:19], v[32:35], v[64:79]
    ds_read_b128 v[56:59], v245 offset:0
    ds_read_b64_tr_b16 v[40:41], v236 offset:12288
    ds_read_b64_tr_b16 v[42:43], v236 offset:13312
    ds_read_b64_tr_b16 v[44:45], v237 offset:12288
    ds_read_b64_tr_b16 v[46:47], v237 offset:13312
    v_mfma_f32_32x32x16_bf16 v[80:95], v[20:23], v[32:35], v[80:95]
    ds_read_b64_tr_b16 v[48:49], v184 offset:12288
    ds_read_b64_tr_b16 v[50:51], v184 offset:13312
    ds_read_b64_tr_b16 v[52:53], v185 offset:12288
    ds_read_b64_tr_b16 v[54:55], v185 offset:13312
    v_mfma_f32_32x32x16_bf16 v[96:111], v[24:27], v[32:35], v[96:111]
    v_mfma_f32_32x32x16_bf16 v[112:127], v[28:31], v[32:35], v[112:127]
    s_waitcnt lgkmcnt(0)
    v_mfma_f32_32x32x16_bf16 v[64:79], v[40:43], v[56:59], v[64:79]
    s_waitcnt vmcnt(8)
    s_barrier
    v_mfma_f32_32x32x16_bf16 v[80:95], v[44:47], v[56:59], v[80:95]
    ds_read_b128 v[32:35], v242 offset:16384
    ds_read_b64_tr_b16 v[16:17], v236 offset:16384
    ds_read_b64_tr_b16 v[18:19], v236 offset:17408
    ds_read_b64_tr_b16 v[20:21], v237 offset:16384
    ds_read_b64_tr_b16 v[22:23], v237 offset:17408
    v_mfma_f32_32x32x16_bf16 v[96:111], v[48:51], v[56:59], v[96:111]
    ds_read_b64_tr_b16 v[24:25], v184 offset:16384
    ds_read_b64_tr_b16 v[26:27], v184 offset:17408
    ds_read_b64_tr_b16 v[28:29], v185 offset:16384
    ds_read_b64_tr_b16 v[30:31], v185 offset:17408
    v_mfma_f32_32x32x16_bf16 v[112:127], v[52:55], v[56:59], v[112:127]
    s_add_u32 s44, s66, s71
    s_mov_b64 exec, s[48:49]
    s_add_u32 m0, s46, 8192
    s_nop 0
    buffer_load_dwordx4 v238, s[20:23], s44 offen lds
    s_add_u32 m0, s46, 9216
    s_add_u32 s44, s44, 15360
    buffer_load_dwordx4 v238, s[20:23], s44 offen lds
    s_mov_b64 exec, -1
    s_add_u32 s66, s66, 122880
    s_cmp_ge_u32 s66, 2457600
    s_cselect_b32 s66, 0, s66
    s_add_u32 m0, s75, 12288
    s_nop 0
    buffer_load_dwordx4 v239, s[24:27], s67 offen lds
    s_add_u32 s67, s67, 98304
    s_cmp_ge_u32 s67, 1966080
    s_cselect_b32 s67, 0, s67
    s_add_u32 s44, s45, s65
    s_add_u32 m0, s57, 0
    s_nop 0
    buffer_load_dwordx4 v240, s[16:19], s44 offen lds
    s_add_u32 m0, s57, 1024
    s_nop 0
    buffer_load_dwordx4 v241, s[16:19], s44 offen lds
    s_add_u32 s65, s65, 128
    s_cmp_ge_u32 s65, 1280
    s_cselect_b32 s65, 0, s65
    s_waitcnt lgkmcnt(0)
    v_mfma_f32_32x32x16_bf16 v[64:79], v[16:19], v[32:35], v[64:79]
    ds_read_b128 v[56:59], v243 offset:16384
    ds_read_b64_tr_b16 v[40:41], v236 offset:20480
    ds_read_b64_tr_b16 v[42:43], v236 offset:21504
    ds_read_b64_tr_b16 v[44:45], v237 offset:20480
    ds_read_b64_tr_b16 v[46:47], v237 offset:21504
    v_mfma_f32_32x32x16_bf16 v[80:95], v[20:23], v[32:35], v[80:95]
    ds_read_b64_tr_b16 v[48:49], v184 offset:20480
    ds_read_b64_tr_b16 v[50:51], v184 offset:21504
    ds_read_b64_tr_b16 v[52:53], v185 offset:20480
    ds_read_b64_tr_b16 v[54:55], v185 offset:21504
    v_mfma_f32_32x32x16_bf16 v[96:111], v[24:27], v[32:35], v[96:111]
    v_mfma_f32_32x32x16_bf16 v[112:127], v[28:31], v[32:35], v[112:127]
    s_waitcnt lgkmcnt(0)
    v_mfma_f32_32x32x16_bf16 v[64:79], v[40:43], v[56:59], v[64:79]
    s_waitcnt vmcnt(10)
    s_barrier
    v_mfma_f32_32x32x16_bf16 v[80:95], v[44:47], v[56:59], v[80:95]
    ds_read_b128 v[32:35], v244 offset:16384
    ds_read_b64_tr_b16 v[16:17], v236 offset:24576
    ds_read_b64_tr_b16 v[18:19], v236 offset:25600
    ds_read_b64_tr_b16 v[20:21], v237 offset:24576
    ds_read_b64_tr_b16 v[22:23], v237 offset:25600
    v_mfma_f32_32x32x16_bf16 v[96:111], v[48:51], v[56:59], v[96:111]
    ds_read_b64_tr_b16 v[24:25], v184 offset:24576
    ds_read_b64_tr_b16 v[26:27], v184 offset:25600
    ds_read_b64_tr_b16 v[28:29], v185 offset:24576
    ds_read_b64_tr_b16 v[30:31], v185 offset:25600
    v_mfma_f32_32x32x16_bf16 v[112:127], v[52:55], v[56:59], v[112:127]
    v_mov_b32 v253, 0
    buffer_load_dword v234, v253, s[52:55], s56 offen sc1
    buffer_load_dword v189, v253, s[52:55], s70 offen sc1
    s_add_u32 s44, s66, s71
    s_mov_b64 exec, s[48:49]
    s_add_u32 m0, s46, 16384
    s_nop 0
    buffer_load_dwordx4 v238, s[20:23], s44 offen lds
    s_add_u32 m0, s46, 17408
    s_add_u32 s44, s44, 15360
    buffer_load_dwordx4 v238, s[20:23], s44 offen lds
    s_mov_b64 exec, -1
    s_add_u32 s66, s66, 122880
    s_cmp_ge_u32 s66, 2457600
    s_cselect_b32 s66, 0, s66
    s_add_u32 m0, s75, 24576
    s_nop 0
    buffer_load_dwordx4 v239, s[24:27], s67 offen lds
    s_add_u32 s67, s67, 98304
    s_cmp_ge_u32 s67, 1966080
    s_cselect_b32 s67, 0, s67
    s_waitcnt lgkmcnt(0)
    v_mfma_f32_32x32x16_bf16 v[64:79], v[16:19], v[32:35], v[64:79]
    ds_read_b128 v[56:59], v245 offset:16384
    ds_read_b64_tr_b16 v[40:41], v236 offset:28672
    ds_read_b64_tr_b16 v[42:43], v236 offset:29696
    ds_read_b64_tr_b16 v[44:45], v237 offset:28672
    ds_read_b64_tr_b16 v[46:47], v237 offset:29696
    v_mfma_f32_32x32x16_bf16 v[80:95], v[20:23], v[32:35], v[80:95]
    ds_read_b64_tr_b16 v[48:49], v184 offset:28672
    ds_read_b64_tr_b16 v[50:51], v184 offset:29696
    ds_read_b64_tr_b16 v[52:53], v185 offset:28672
    ds_read_b64_tr_b16 v[54:55], v185 offset:29696
    v_mfma_f32_32x32x16_bf16 v[96:111], v[24:27], v[32:35], v[96:111]
    v_mfma_f32_32x32x16_bf16 v[112:127], v[28:31], v[32:35], v[112:127]
    s_waitcnt lgkmcnt(0)
    v_mfma_f32_32x32x16_bf16 v[64:79], v[40:43], v[56:59], v[64:79]
    s_waitcnt vmcnt(10)
    s_barrier
    v_mfma_f32_32x32x16_bf16 v[80:95], v[44:47], v[56:59], v[80:95]
    ds_read_b128 v[32:35], v242 offset:32768
    ds_read_b64_tr_b16 v[16:17], v236 offset:0
    ds_read_b64_tr_b16 v[18:19], v236 offset:1024
    ds_read_b64_tr_b16 v[20:21], v237 offset:0
    ds_read_b64_tr_b16 v[22:23], v237 offset:1024
    v_mfma_f32_32x32x16_bf16 v[96:111], v[48:51], v[56:59], v[96:111]
    ds_read_b64_tr_b16 v[24:25], v184 offset:0
    ds_read_b64_tr_b16 v[26:27], v184 offset:1024
    ds_read_b64_tr_b16 v[28:29], v185 offset:0
    ds_read_b64_tr_b16 v[30:31], v185 offset:1024
    v_mfma_f32_32x32x16_bf16 v[112:127], v[52:55], v[56:59], v[112:127]
    s_add_u32 s44, s66, s71
    s_mov_b64 exec, s[48:49]
    s_add_u32 m0, s46, 24576
    s_nop 0
    buffer_load_dwordx4 v238, s[20:23], s44 offen lds
    s_add_u32 m0, s46, 25600
    s_add_u32 s44, s44, 15360
    buffer_load_dwordx4 v238, s[20:23], s44 offen lds
    s_mov_b64 exec, -1
    s_add_u32 s66, s66, 122880
    s_cmp_ge_u32 s66, 2457600
    s_cselect_b32 s66, 0, s66
    s_add_u32 m0, s75, 36864
    s_nop 0
    buffer_load_dwordx4 v239, s[24:27], s67 offen lds
    s_add_u32 s67, s67, 98304
    s_cmp_ge_u32 s67, 1966080
    s_cselect_b32 s67, 0, s67
    s_waitcnt lgkmcnt(0)
    v_mfma_f32_32x32x16_bf16 v[64:79], v[16:19], v[32:35], v[64:79]
    ds_read_b128 v[56:59], v243 offset:32768
    ds_read_b64_tr_b16 v[40:41], v236 offset:4096
    ds_read_b64_tr_b16 v[42:43], v236 offset:5120
    ds_read_b64_tr_b16 v[44:45], v237 offset:4096
    ds_read_b64_tr_b16 v[46:47], v237 offset:5120
    v_mfma_f32_32x32x16_bf16 v[80:95], v[20:23], v[32:35], v[80:95]
    ds_read_b64_tr_b16 v[48:49], v184 offset:4096
    ds_read_b64_tr_b16 v[50:51], v184 offset:5120
    ds_read_b64_tr_b16 v[52:53], v185 offset:4096
    ds_read_b64_tr_b16 v[54:55], v185 offset:5120
    v_mfma_f32_32x32x16_bf16 v[96:111], v[24:27], v[32:35], v[96:111]
    v_mfma_f32_32x32x16_bf16 v[112:127], v[28:31], v[32:35], v[112:127]
    s_waitcnt lgkmcnt(0)
    v_mfma_f32_32x32x16_bf16 v[64:79], v[40:43], v[56:59], v[64:79]
    s_waitcnt vmcnt(10)
    s_barrier
    v_mfma_f32_32x32x16_bf16 v[80:95], v[44:47], v[56:59], v[80:95]
    ds_read_b128 v[32:35], v244 offset:32768
    ds_read_b64_tr_b16 v[16:17], v236 offset:8192
    ds_read_b64_tr_b16 v[18:19], v236 offset:9216
    ds_read_b64_tr_b16 v[20:21], v237 offset:8192
    ds_read_b64_tr_b16 v[22:23], v237 offset:9216
    v_mfma_f32_32x32x16_bf16 v[96:111], v[48:51], v[56:59], v[96:111]
    ds_read_b64_tr_b16 v[24:25], v184 offset:8192
    ds_read_b64_tr_b16 v[26:27], v184 offset:9216
    ds_read_b64_tr_b16 v[28:29], v185 offset:8192
    ds_read_b64_tr_b16 v[30:31], v185 offset:9216
    v_mfma_f32_32x32x16_bf16 v[112:127], v[52:55], v[56:59], v[112:127]
    s_waitcnt vmcnt(6)
    v_min_u32 v234, v234, v189
    s_nop 0
    v_readfirstlane_b32 s47, v234
    s_mov_b32 s43, s50
    buffer_load_dword v224, v235, s[32:35], s43 offen sc1
    s_add_u32 s43, s43, 1536
    buffer_load_dword v225, v235, s[32:35], s43 offen sc1
    s_add_u32 s43, s43, 1536
    buffer_load_dword v226, v235, s[32:35], s43 offen sc1
    s_add_u32 s43, s43, 1536
    buffer_load_dword v227, v235, s[32:35], s43 offen sc1
    s_add_u32 s43, s43, 1536
    buffer_load_dword v228, v235, s[32:35], s43 offen sc1
    s_add_u32 s43, s43, 1536
    buffer_load_dword v229, v235, s[32:35], s43 offen sc1
    s_add_u32 s43, s43, 1536
    buffer_load_dword v230, v235, s[32:35], s43 offen sc1
    s_add_u32 s43, s43, 1536
    buffer_load_dword v231, v235, s[32:35], s43 offen sc1
    s_add_u32 s43, s43, 1536
    buffer_load_dword v232, v235, s[32:35], s43 offen sc1
    s_add_u32 s43, s43, 1536
    buffer_load_dword v233, v235, s[32:35], s43 offen sc1
    buffer_load_dword v190, v188, s[32:35], s62 offen offset:0 sc1
    buffer_load_dword v191, v188, s[32:35], s62 offen offset:512 sc1
    buffer_load_dword v192, v188, s[32:35], s62 offen offset:1024 sc1
    buffer_load_dword v193, v188, s[32:35], s62 offen offset:1536 sc1
    buffer_load_dword v194, v188, s[32:35], s62 offen offset:2048 sc1
    buffer_load_dword v195, v188, s[32:35], s62 offen offset:2560 sc1
    buffer_load_dword v196, v188, s[32:35], s62 offen offset:3072 sc1
    buffer_load_dword v197, v188, s[32:35], s62 offen offset:3584 sc1
    s_add_u32 s43, s62, 4096
    buffer_load_dword v198, v188, s[32:35], s43 offen offset:0 sc1
    buffer_load_dword v199, v188, s[32:35], s43 offen offset:512 sc1
    s_waitcnt lgkmcnt(0)
    v_mfma_f32_32x32x16_bf16 v[64:79], v[16:19], v[32:35], v[64:79]
    ds_read_b128 v[56:59], v245 offset:32768
    ds_read_b64_tr_b16 v[40:41], v236 offset:12288
    ds_read_b64_tr_b16 v[42:43], v236 offset:13312
    ds_read_b64_tr_b16 v[44:45], v237 offset:12288
    ds_read_b64_tr_b16 v[46:47], v237 offset:13312
    v_mfma_f32_32x32x16_bf16 v[80:95], v[20:23], v[32:35], v[80:95]
    ds_read_b64_tr_b16 v[48:49], v184 offset:12288
    ds_read_b64_tr_b16 v[50:51], v184 offset:13312
    ds_read_b64_tr_b16 v[52:53], v185 offset:12288
    ds_read_b64_tr_b16 v[54:55], v185 offset:13312
    v_mfma_f32_32x32x16_bf16 v[96:111], v[24:27], v[32:35], v[96:111]
    v_mfma_f32_32x32x16_bf16 v[112:127], v[28:31], v[32:35], v[112:127]
    s_waitcnt lgkmcnt(0)
    v_mfma_f32_32x32x16_bf16 v[64:79], v[40:43], v[56:59], v[64:79]
    s_waitcnt vmcnt(23)
    s_barrier
    v_mfma_f32_32x32x16_bf16 v[80:95], v[44:47], v[56:59], v[80:95]
    ds_read_b128 v[32:35], v242 offset:0
    ds_read_b64_tr_b16 v[16:17], v236 offset:16384
    ds_read_b64_tr_b16 v[18:19], v236 offset:17408
    ds_read_b64_tr_b16 v[20:21], v237 offset:16384
    ds_read_b64_tr_b16 v[22:23], v237 offset:17408
    v_mfma_f32_32x32x16_bf16 v[96:111], v[48:51], v[56:59], v[96:111]
    ds_read_b64_tr_b16 v[24:25], v184 offset:16384
    ds_read_b64_tr_b16 v[26:27], v184 offset:17408
    ds_read_b64_tr_b16 v[28:29], v185 offset:16384
    ds_read_b64_tr_b16 v[30:31], v185 offset:17408
    v_mfma_f32_32x32x16_bf16 v[112:127], v[52:55], v[56:59], v[112:127]
    s_waitcnt lgkmcnt(0)
    v_mfma_f32_32x32x16_bf16 v[64:79], v[16:19], v[32:35], v[64:79]
    ds_read_b128 v[56:59], v243 offset:0
    ds_read_b64_tr_b16 v[40:41], v236 offset:20480
    ds_read_b64_tr_b16 v[42:43], v236 offset:21504
    ds_read_b64_tr_b16 v[44:45], v237 offset:20480
    ds_read_b64_tr_b16 v[46:47], v237 offset:21504
    v_mfma_f32_32x32x16_bf16 v[80:95], v[20:23], v[32:35], v[80:95]
    ds_read_b64_tr_b16 v[48:49], v184 offset:20480
    ds_read_b64_tr_b16 v[50:51], v184 offset:21504
    ds_read_b64_tr_b16 v[52:53], v185 offset:20480
    ds_read_b64_tr_b16 v[54:55], v185 offset:21504
    v_mfma_f32_32x32x16_bf16 v[96:111], v[24:27], v[32:35], v[96:111]
    v_mfma_f32_32x32x16_bf16 v[112:127], v[28:31], v[32:35], v[112:127]
    s_waitcnt lgkmcnt(0)
    v_mfma_f32_32x32x16_bf16 v[64:79], v[40:43], v[56:59], v[64:79]
    s_waitcnt vmcnt(20)
    s_barrier
    v_mfma_f32_32x32x16_bf16 v[80:95], v[44:47], v[56:59], v[80:95]
    ds_read_b128 v[32:35], v244 offset:0
    ds_read_b64_tr_b16 v[16:17], v236 offset:24576
    ds_read_b64_tr_b16 v[18:19], v236 offset:25600
    ds_read_b64_tr_b16 v[20:21], v237 offset:24576
    ds_read_b64_tr_b16 v[22:23], v237 offset:25600
    v_mfma_f32_32x32x16_bf16 v[96:111], v[48:51], v[56:59], v[96:111]
    ds_read_b64_tr_b16 v[24:25], v184 offset:24576
    ds_read_b64_tr_b16 v[26:27], v184 offset:25600
    ds_read_b64_tr_b16 v[28:29], v185 offset:24576
    ds_read_b64_tr_b16 v[30:31], v185 offset:25600
    v_mfma_f32_32x32x16_bf16 v[112:127], v[52:55], v[56:59], v[112:127]
    s_waitcnt lgkmcnt(0)
    v_mfma_f32_32x32x16_bf16 v[64:79], v[16:19], v[32:35], v[64:79]
    ds_read_b128 v[56:59], v245 offset:0
    ds_read_b64_tr_b16 v[40:41], v236 offset:28672
    ds_read_b64_tr_b16 v[42:43], v236 offset:29696
    ds_read_b64_tr_b16 v[44:45], v237 offset:28672
    ds_read_b64_tr_b16 v[46:47], v237 offset:29696
    v_mfma_f32_32x32x16_bf16 v[80:95], v[20:23], v[32:35], v[80:95]
    ds_read_b64_tr_b16 v[48:49], v184 offset:28672
    ds_read_b64_tr_b16 v[50:51], v184 offset:29696
    ds_read_b64_tr_b16 v[52:53], v185 offset:28672
    ds_read_b64_tr_b16 v[54:55], v185 offset:29696
    v_mfma_f32_32x32x16_bf16 v[96:111], v[24:27], v[32:35], v[96:111]
    v_mfma_f32_32x32x16_bf16 v[112:127], v[28:31], v[32:35], v[112:127]
    s_waitcnt lgkmcnt(0)
    v_mfma_f32_32x32x16_bf16 v[64:79], v[40:43], v[56:59], v[64:79]
    v_mfma_f32_32x32x16_bf16 v[80:95], v[44:47], v[56:59], v[80:95]
    v_mfma_f32_32x32x16_bf16 v[96:111], v[48:51], v[56:59], v[96:111]
    v_mfma_f32_32x32x16_bf16 v[112:127], v[52:55], v[56:59], v[112:127]
    s_setprio 3
    s_cmp_ge_u32 s47, 10
    s_cbranch_scc1 L_gok_1
L_gpoll_2:
    v_mov_b32 v253, 0
    buffer_load_dword v234, v253, s[52:55], s56 offen sc1
    buffer_load_dword v189, v253, s[52:55], s70 offen sc1
    s_waitcnt vmcnt(0)
    v_min_u32 v234, v234, v189
    s_nop 0
    v_readfirstlane_b32 s47, v234
    s_nop 3
    s_cmp_ge_u32 s47, 10
    s_cbranch_scc0 L_gpoll_2
    s_mov_b32 s43, s50
    buffer_load_dword v224, v235, s[32:35], s43 offen sc1
    s_add_u32 s43, s43, 1536
    buffer_load_dword v225, v235, s[32:35], s43 offen sc1
    s_add_u32 s43, s43, 1536
    buffer_load_dword v226, v235, s[32:35], s43 offen sc1
    s_add_u32 s43, s43, 1536
    buffer_load_dword v227, v235, s[32:35], s43 offen sc1
    s_add_u32 s43, s43, 1536
    buffer_load_dword v228, v235, s[32:35], s43 offen sc1
    s_add_u32 s43, s43, 1536
    buffer_load_dword v229, v235, s[32:35], s43 offen sc1
    s_add_u32 s43, s43, 1536
    buffer_load_dword v230, v235, s[32:35], s43 offen sc1
    s_add_u32 s43, s43, 1536
    buffer_load_dword v231, v235, s[32:35], s43 offen sc1
    s_add_u32 s43, s43, 1536
    buffer_load_dword v232, v235, s[32:35], s43 offen sc1
    s_add_u32 s43, s43, 1536
    buffer_load_dword v233, v235, s[32:35], s43 offen sc1
    buffer_load_dword v190, v188, s[32:35], s62 offen offset:0 sc1
    buffer_load_dword v191, v188, s[32:35], s62 offen offset:512 sc1
    buffer_load_dword v192, v188, s[32:35], s62 offen offset:1024 sc1
    buffer_load_dword v193, v188, s[32:35], s62 offen offset:1536 sc1
    buffer_load_dword v194, v188, s[32:35], s62 offen offset:2048 sc1
    buffer_load_dword v195, v188, s[32:35], s62 offen offset:2560 sc1
    buffer_load_dword v196, v188, s[32:35], s62 offen offset:3072 sc1
    buffer_load_dword v197, v188, s[32:35], s62 offen offset:3584 sc1
    s_add_u32 s43, s62, 4096
    buffer_load_dword v198, v188, s[32:35], s43 offen offset:0 sc1
    buffer_load_dword v199, v188, s[32:35], s43 offen offset:512 sc1
L_gok_1:
    s_waitcnt vmcnt(0)
    v_add_f32 v190, v190, v191
    v_add_f32 v192, v192, v193
    v_add_f32 v194, v194, v195
    v_add_f32 v196, v196, v197
    v_add_f32 v198, v198, v199
    v_add_f32 v190, v190, v192
    v_add_f32 v194, v194, v196
    v_add_f32 v190, v190, v198
    v_add_f32 v246, v190, v194
    v_add_f32 v224, v224, v225
    v_add_f32 v226, v226, v227
    v_add_f32 v228, v228, v229
    v_add_f32 v230, v230, v231
    v_add_f32 v232, v232, v233
    v_add_f32 v224, v224, v226
    v_add_f32 v228, v228, v230
    v_add_f32 v224, v224, v232
    v_add_f32 v224, v224, v228
    v_add_u32 v9, 146432, v235
    ds_write_b32 v9, v224
    s_lshl_b32 s43, s60, 8
    s_add_u32 s43, s43, 147968
    v_lshlrev_b32 v11, 3, v4
    v_add_u32 v11, s43, v11
    v_lshlrev_b32 v10, 4, v3
    v_add_u32 v10, 146432, v10
    s_nop 5
    v_mov_b32 v5, v124
    v_mov_b32 v6, v124
    s_nop 1
    v_permlane32_swap_b32 v5, v6
    s_nop 1
    v_mov_b32 v8, 0x3acccccd
    v_mul_f32 v12, v5, v8
    v_mul_f32 v13, v246, v8
    v_fma_f32 v13, -v12, v12, v13
    v_max_f32 v13, 0, v13
    v_cvt_pk_bf16_f32 v14, v12, v13
    v_lshlrev_b32 v12, 16, v14
    v_and_b32 v13, 0xffff0000, v14
    v_add_f32 v13, 0x3727c5ac, v13
    v_cvt_pk_bf16_f32 v14, v13, v13
    v_and_b32 v13, 0xffff0000, v14
    v_sqrt_f32 v13, v13
    s_nop 0
    v_cvt_pk_bf16_f32 v14, v13, v13
    v_and_b32 v13, 0xffff0000, v14
    v_rcp_f32 v14, v13
    v_sub_f32 v13, 0, v12
    v_mov_b32 v12, v13
    v_mov_b32 v15, v14
    ds_write_b32 v11, v13
    ds_write_b32 v11, v14 offset:4
    s_waitcnt lgkmcnt(0)
    s_barrier
    ds_read_b128 v[160:163], v10 offset:0
    ds_read_b128 v[164:167], v10 offset:32
    ds_read_b128 v[168:171], v10 offset:64
    ds_read_b128 v[172:175], v10 offset:96
    ds_read_b128 v[176:179], v10 offset:128
    ds_read_b128 v[180:183], v10 offset:160
    ds_read_b128 v[184:187], v10 offset:192
    ds_read_b128 v[188:191], v10 offset:224
    ds_read_b128 v[192:195], v10 offset:256
    ds_read_b128 v[196:199], v10 offset:288
    ds_read_b128 v[200:203], v10 offset:320
    ds_read_b128 v[204:207], v10 offset:352
    ds_read_b128 v[208:211], v10 offset:384
    ds_read_b128 v[212:215], v10 offset:416
    ds_read_b128 v[216:219], v10 offset:448
    v_mul_u32_u24 v9, 160, v4
    v_lshl_add_u32 v9, v3, 4, v9
    v_add_u32 v9, 131072, v9
    s_waitcnt lgkmcnt(0)
    v_pk_fma_f32 v[64:65], v[12:13], v[160:161], v[64:65]
    v_pk_fma_f32 v[66:67], v[12:13], v[162:163], v[66:67]
    v_pk_fma_f32 v[68:69], v[12:13], v[164:165], v[68:69]
    v_pk_fma_f32 v[70:71], v[12:13], v[166:167], v[70:71]
    v_pk_fma_f32 v[72:73], v[12:13], v[168:169], v[72:73]
    v_pk_fma_f32 v[74:75], v[12:13], v[170:171], v[74:75]
    v_pk_fma_f32 v[76:77], v[12:13], v[172:173], v[76:77]
    v_pk_fma_f32 v[78:79], v[12:13], v[174:175], v[78:79]
    v_pk_fma_f32 v[80:81], v[12:13], v[176:177], v[80:81]
    v_pk_fma_f32 v[82:83], v[12:13], v[178:179], v[82:83]
    v_pk_fma_f32 v[84:85], v[12:13], v[180:181], v[84:85]
    v_pk_fma_f32 v[86:87], v[12:13], v[182:183], v[86:87]
    v_pk_fma_f32 v[88:89], v[12:13], v[184:185], v[88:89]
    v_pk_fma_f32 v[90:91], v[12:13], v[186:187], v[90:91]
    v_pk_fma_f32 v[92:93], v[12:13], v[188:189], v[92:93]
    v_pk_fma_f32 v[94:95], v[12:13], v[190:191], v[94:95]
    v_pk_fma_f32 v[96:97], v[12:13], v[192:193], v[96:97]
    v_pk_fma_f32 v[98:99], v[12:13], v[194:195], v[98:99]
    v_pk_fma_f32 v[100:101], v[12:13], v[196:197], v[100:101]
    v_pk_fma_f32 v[102:103], v[12:13], v[198:199], v[102:103]
    v_pk_fma_f32 v[104:105], v[12:13], v[200:201], v[104:105]
    v_pk_fma_f32 v[106:107], v[12:13], v[202:203], v[106:107]
    v_pk_fma_f32 v[108:109], v[12:13], v[204:205], v[108:109]
    v_pk_fma_f32 v[110:111], v[12:13], v[206:207], v[110:111]
    v_pk_fma_f32 v[112:113], v[12:13], v[208:209], v[112:113]
    v_pk_fma_f32 v[114:115], v[12:13], v[210:211], v[114:115]
    v_pk_fma_f32 v[116:117], v[12:13], v[212:213], v[116:117]
    v_pk_fma_f32 v[118:119], v[12:13], v[214:215], v[118:119]
    v_pk_fma_f32 v[120:121], v[12:13], v[216:217], v[120:121]
    v_pk_fma_f32 v[122:123], v[12:13], v[218:219], v[122:123]
    v_pk_mul_f32 v[64:65], v[14:15], v[64:65]
    v_pk_mul_f32 v[66:67], v[14:15], v[66:67]
    v_pk_mul_f32 v[68:69], v[14:15], v[68:69]
    v_pk_mul_f32 v[70:71], v[14:15], v[70:71]
    v_pk_mul_f32 v[72:73], v[14:15], v[72:73]
    v_pk_mul_f32 v[74:75], v[14:15], v[74:75]
    v_pk_mul_f32 v[76:77], v[14:15], v[76:77]
    v_pk_mul_f32 v[78:79], v[14:15], v[78:79]
    v_pk_mul_f32 v[80:81], v[14:15], v[80:81]
    v_pk_mul_f32 v[82:83], v[14:15], v[82:83]
    v_pk_mul_f32 v[84:85], v[14:15], v[84:85]
    v_pk_mul_f32 v[86:87], v[14:15], v[86:87]
    v_pk_mul_f32 v[88:89], v[14:15], v[88:89]
    v_pk_mul_f32 v[90:91], v[14:15], v[90:91]
    v_pk_mul_f32 v[92:93], v[14:15], v[92:93]
    v_pk_mul_f32 v[94:95], v[14:15], v[94:95]
    v_pk_mul_f32 v[96:97], v[14:15], v[96:97]
    v_pk_mul_f32 v[98:99], v[14:15], v[98:99]
    v_pk_mul_f32 v[100:101], v[14:15], v[100:101]
    v_pk_mul_f32 v[102:103], v[14:15], v[102:103]
    v_pk_mul_f32 v[104:105], v[14:15], v[104:105]
    v_pk_mul_f32 v[106:107], v[14:15], v[106:107]
    v_pk_mul_f32 v[108:109], v[14:15], v[108:109]
    v_pk_mul_f32 v[110:111], v[14:15], v[110:111]
    v_pk_mul_f32 v[112:113], v[14:15], v[112:113]
    v_pk_mul_f32 v[114:115], v[14:15], v[114:115]
    v_pk_mul_f32 v[116:117], v[14:15], v[116:117]
    v_pk_mul_f32 v[118:119], v[14:15], v[118:119]
    v_pk_mul_f32 v[120:121], v[14:15], v[120:121]
    v_pk_mul_f32 v[122:123], v[14:15], v[122:123]
    v_cvt_pk_bf16_f32 v16, v64, v65
    v_cvt_pk_bf16_f32 v17, v66, v67
    v_cvt_pk_bf16_f32 v18, v68, v69
    v_cvt_pk_bf16_f32 v19, v70, v71
    v_cvt_pk_bf16_f32 v20, v72, v73
    v_cvt_pk_bf16_f32 v21, v74, v75
    v_cvt_pk_bf16_f32 v22, v76, v77
    v_cvt_pk_bf16_f32 v23, v78, v79
    v_cvt_pk_bf16_f32 v24, v80, v81
    v_cvt_pk_bf16_f32 v25, v82, v83
    v_cvt_pk_bf16_f32 v26, v84, v85
    v_cvt_pk_bf16_f32 v27, v86, v87
    v_cvt_pk_bf16_f32 v28, v88, v89
    v_cvt_pk_bf16_f32 v29, v90, v91
    v_cvt_pk_bf16_f32 v30, v92, v93
    v_cvt_pk_bf16_f32 v31, v94, v95
    v_cvt_pk_bf16_f32 v32, v96, v97
    v_cvt_pk_bf16_f32 v33, v98, v99
    v_cvt_pk_bf16_f32 v34, v100, v101
    v_cvt_pk_bf16_f32 v35, v102, v103
    v_cvt_pk_bf16_f32 v36, v104, v105
    v_cvt_pk_bf16_f32 v37, v106, v107
    v_cvt_pk_bf16_f32 v38, v108, v109
    v_cvt_pk_bf16_f32 v39, v110, v111
    v_cvt_pk_bf16_f32 v40, v112, v113
    v_cvt_pk_bf16_f32 v41, v114, v115
    v_cvt_pk_bf16_f32 v42, v116, v117
    v_cvt_pk_bf16_f32 v43, v118, v119
    v_cvt_pk_bf16_f32 v44, v120, v121
    v_cvt_pk_bf16_f32 v45, v122, v123
    ds_read_b128 v[160:163], v9 offset:0
    ds_read_b128 v[164:167], v9 offset:32
    ds_read_b128 v[168:171], v9 offset:64
    ds_read_b128 v[172:175], v9 offset:96
    ds_read_b128 v[176:179], v9 offset:128
    ds_read_b128 v[180:183], v9 offset:5120
    ds_read_b128 v[184:187], v9 offset:5152
    ds_read_b128 v[188:191], v9 offset:5184
    ds_read_b128 v[192:195], v9 offset:5216
    ds_read_b128 v[196:199], v9 offset:5248
    ds_read_b128 v[200:203], v9 offset:10240
    ds_read_b128 v[204:207], v9 offset:10272
    ds_read_b128 v[208:211], v9 offset:10304
    ds_read_b128 v[212:215], v9 offset:10336
    ds_read_b128 v[216:219], v9 offset:10368
    s_lshl_b32 s43, s60, 5
    v_add_u32 v11, s43, v4
    v_mul_u32_u24 v11, 288, v11
    v_add_u32 v11, 0, v11
    v_lshl_add_u32 v10, v3, 3, v11
    s_waitcnt lgkmcnt(0)
    v_mfma_f32_32x32x16_bf16 v[64:79], v[160:163], v[16:19], 0
    v_mfma_f32_32x32x16_bf16 v[80:95], v[180:183], v[16:19], 0
    v_mfma_f32_32x32x16_bf16 v[96:111], v[200:203], v[16:19], 0
    v_mfma_f32_32x32x16_bf16 v[64:79], v[164:167], v[20:23], v[64:79]
    v_mfma_f32_32x32x16_bf16 v[80:95], v[184:187], v[20:23], v[80:95]
    v_mfma_f32_32x32x16_bf16 v[96:111], v[204:207], v[20:23], v[96:111]
    v_mfma_f32_32x32x16_bf16 v[64:79], v[168:171], v[24:27], v[64:79]
    v_mfma_f32_32x32x16_bf16 v[80:95], v[188:191], v[24:27], v[80:95]
    v_mfma_f32_32x32x16_bf16 v[96:111], v[208:211], v[24:27], v[96:111]
    v_mfma_f32_32x32x16_bf16 v[64:79], v[172:175], v[28:31], v[64:79]
    v_mfma_f32_32x32x16_bf16 v[80:95], v[192:195], v[28:31], v[80:95]
    v_mfma_f32_32x32x16_bf16 v[96:111], v[212:215], v[28:31], v[96:111]
    v_mfma_f32_32x32x16_bf16 v[64:79], v[176:179], v[32:35], v[64:79]
    v_mfma_f32_32x32x16_bf16 v[80:95], v[196:199], v[32:35], v[80:95]
    v_mfma_f32_32x32x16_bf16 v[96:111], v[216:219], v[32:35], v[96:111]
    ds_write_b64 v10, v[36:37] offset:160
    ds_write_b64 v10, v[38:39] offset:176
    ds_write_b64 v10, v[40:41] offset:192
    ds_write_b64 v10, v[42:43] offset:208
    ds_write_b64 v10, v[44:45] offset:224
    s_mov_b32 s50, 0
    s_mov_b32 s51, -1
    s_mov_b32 s52, -1
    s_mov_b32 s53, 0
    s_lshl_b32 s43, s41, 4
    s_add_u32 s43, s43, s42
    s_lshl_b32 s43, s43, 2
    s_add_u32 s43, s43, s60
    s_mul_i32 s47, s43, 5120
    s_add_u32 s47, s47, 14680064
    v_mul_u32_u24 v9, 160, v4
    v_mov_b32 v16, 0x3fb8aa3b
    v_mov_b32 v17, 0x3fb8aa3b
    v_mov_b32 v20, 0x3f80
    v_mov_b32 v21, 0
    v_mov_b32 v22, 0
    v_mov_b32 v23, 0
    s_mov_b64 exec, s[52:53]
    ds_write_b128 v11, v[20:23] offset:240
    s_mov_b64 exec, -1
    s_nop 7
    v_cvt_pk_bf16_f32 v112, v64, v65
    v_cvt_pk_bf16_f32 v113, v66, v67
    v_cvt_pk_bf16_f32 v114, v68, v69
    v_cvt_pk_bf16_f32 v115, v70, v71
    v_cvt_pk_bf16_f32 v116, v72, v73
    v_cvt_pk_bf16_f32 v117, v74, v75
    v_cvt_pk_bf16_f32 v118, v76, v77
    v_cvt_pk_bf16_f32 v119, v78, v79
    v_cvt_pk_bf16_f32 v120, v80, v81
    v_cvt_pk_bf16_f32 v121, v82, v83
    v_cvt_pk_bf16_f32 v122, v84, v85
    v_cvt_pk_bf16_f32 v123, v86, v87
    v_cvt_pk_bf16_f32 v124, v88, v89
    v_cvt_pk_bf16_f32 v125, v90, v91
    v_cvt_pk_bf16_f32 v126, v92, v93
    v_cvt_pk_bf16_f32 v127, v94, v95
    v_cvt_pk_bf16_f32 v128, v96, v97
    v_cvt_pk_bf16_f32 v129, v98, v99
    v_cvt_pk_bf16_f32 v130, v100, v101
    v_cvt_pk_bf16_f32 v131, v102, v103
    v_lshlrev_b32 v64, 16, v112
    v_and_b32 v65, 0xffff0000, v112
    v_lshlrev_b32 v66, 16, v113
    v_and_b32 v67, 0xffff0000, v113
    v_lshlrev_b32 v68, 16, v114
    v_and_b32 v69, 0xffff0000, v114
    v_lshlrev_b32 v70, 16, v115
    v_and_b32 v71, 0xffff0000, v115
    v_lshlrev_b32 v72, 16, v116
    v_and_b32 v73, 0xffff0000, v116
    v_lshlrev_b32 v74, 16, v117
    v_and_b32 v75, 0xffff0000, v117
    v_lshlrev_b32 v76, 16, v118
    v_and_b32 v77, 0xffff0000, v118
    v_lshlrev_b32 v78, 16, v119
    v_and_b32 v79, 0xffff0000, v119
    v_lshlrev_b32 v80, 16, v120
    v_and_b32 v81, 0xffff0000, v120
    v_lshlrev_b32 v82, 16, v121
    v_and_b32 v83, 0xffff0000, v121
    v_lshlrev_b32 v84, 16, v122
    v_and_b32 v85, 0xffff0000, v122
    v_lshlrev_b32 v86, 16, v123
    v_and_b32 v87, 0xffff0000, v123
    v_lshlrev_b32 v88, 16, v124
    v_and_b32 v89, 0xffff0000, v124
    v_lshlrev_b32 v90, 16, v125
    v_and_b32 v91, 0xffff0000, v125
    v_lshlrev_b32 v92, 16, v126
    v_and_b32 v93, 0xffff0000, v126
    v_lshlrev_b32 v94, 16, v127
    v_and_b32 v95, 0xffff0000, v127
    v_lshlrev_b32 v96, 16, v128
    v_and_b32 v97, 0xffff0000, v128
    v_lshlrev_b32 v98, 16, v129
    v_and_b32 v99, 0xffff0000, v129
    v_lshlrev_b32 v100, 16, v130
    v_and_b32 v101, 0xffff0000, v130
    v_lshlrev_b32 v102, 16, v131
    v_and_b32 v103, 0xffff0000, v131
    v_max3_f32 v24, v64, v65, v66
    v_min3_f32 v26, v64, v65, v66
    v_max3_f32 v24, v24, v67, v68
    v_min3_f32 v26, v26, v67, v68
    v_max3_f32 v24, v24, v69, v70
    v_min3_f32 v26, v26, v69, v70
    v_max3_f32 v24, v24, v71, v72
    v_min3_f32 v26, v26, v71, v72
    v_max3_f32 v24, v24, v73, v74
    v_min3_f32 v26, v26, v73, v74
    v_max3_f32 v24, v24, v75, v76
    v_min3_f32 v26, v26, v75, v76
    v_max3_f32 v24, v24, v77, v78
    v_min3_f32 v26, v26, v77, v78
    v_max3_f32 v24, v24, v79, v80
    v_min3_f32 v26, v26, v79, v80
    v_max3_f32 v24, v24, v81, v82
    v_min3_f32 v26, v26, v81, v82
    v_max_f32 v24, v24, v83
    v_min_f32 v26, v26, v83
    v_mul_f32 v24, v24, v16
    v_mul_f32 v26, v26, v16
    v_sub_f32 v24, 0, v24
    v_mov_b32 v25, v24
    v_mov_b32 v27, v26
    v_max3_f32 v28, v84, v85, v86
    v_min3_f32 v30, v84, v85, v86
    v_max3_f32 v28, v28, v87, v88
    v_min3_f32 v30, v30, v87, v88
    v_max3_f32 v28, v28, v89, v90
    v_min3_f32 v30, v30, v89, v90
    v_max3_f32 v28, v28, v91, v92
    v_min3_f32 v30, v30, v91, v92
    v_max3_f32 v28, v28, v93, v94
    v_min3_f32 v30, v30, v93, v94
    v_max3_f32 v28, v28, v95, v96
    v_min3_f32 v30, v30, v95, v96
    v_max3_f32 v28, v28, v97, v98
    v_min3_f32 v30, v30, v97, v98
    v_max3_f32 v28, v28, v99, v100
    v_min3_f32 v30, v30, v99, v100
    v_max3_f32 v28, v28, v101, v102
    v_min3_f32 v30, v30, v101, v102
    v_max_f32 v28, v28, v103
    v_min_f32 v30, v30, v103
    v_mul_f32 v28, v28, v16
    v_mul_f32 v30, v30, v16
    v_sub_f32 v28, 0, v28
    v_mov_b32 v29, v28
    v_mov_b32 v31, v30
    v_pk_fma_f32 v[160:161], v[64:65], v[16:17], v[24:25]
    v_pk_fma_f32 v[162:163], v[66:67], v[16:17], v[24:25]
    v_pk_fma_f32 v[164:165], v[68:69], v[16:17], v[24:25]
    v_pk_fma_f32 v[166:167], v[70:71], v[16:17], v[24:25]
    v_pk_fma_f32 v[168:169], v[72:73], v[16:17], v[24:25]
    v_pk_fma_f32 v[170:171], v[74:75], v[16:17], v[24:25]
    v_pk_fma_f32 v[172:173], v[76:77], v[16:17], v[24:25]
    v_pk_fma_f32 v[174:175], v[78:79], v[16:17], v[24:25]
    v_pk_fma_f32 v[176:177], v[80:81], v[16:17], v[24:25]
    v_pk_fma_f32 v[178:179], v[82:83], v[16:17], v[24:25]
    v_pk_fma_f32 v[180:181], v[64:65], v[16:17], v[26:27] neg_lo:[1,0,0] neg_hi:[1,0,0]
    v_pk_fma_f32 v[182:183], v[66:67], v[16:17], v[26:27] neg_lo:[1,0,0] neg_hi:[1,0,0]
    v_pk_fma_f32 v[184:185], v[68:69], v[16:17], v[26:27] neg_lo:[1,0,0] neg_hi:[1,0,0]
    v_pk_fma_f32 v[186:187], v[70:71], v[16:17], v[26:27] neg_lo:[1,0,0] neg_hi:[1,0,0]
    v_pk_fma_f32 v[188:189], v[72:73], v[16:17], v[26:27] neg_lo:[1,0,0] neg_hi:[1,0,0]
    v_pk_fma_f32 v[190:191], v[74:75], v[16:17], v[26:27] neg_lo:[1,0,0] neg_hi:[1,0,0]
    v_pk_fma_f32 v[192:193], v[76:77], v[16:17], v[26:27] neg_lo:[1,0,0] neg_hi:[1,0,0]
    v_pk_fma_f32 v[194:195], v[78:79], v[16:17], v[26:27] neg_lo:[1,0,0] neg_hi:[1,0,0]
    v_pk_fma_f32 v[196:197], v[80:81], v[16:17], v[26:27] neg_lo:[1,0,0] neg_hi:[1,0,0]
    v_pk_fma_f32 v[198:199], v[82:83], v[16:17], v[26:27] neg_lo:[1,0,0] neg_hi:[1,0,0]
    v_pk_fma_f32 v[200:201], v[84:85], v[16:17], v[28:29]
    v_pk_fma_f32 v[202:203], v[86:87], v[16:17], v[28:29]
    v_pk_fma_f32 v[204:205], v[88:89], v[16:17], v[28:29]
    v_pk_fma_f32 v[206:207], v[90:91], v[16:17], v[28:29]
    v_pk_fma_f32 v[208:209], v[92:93], v[16:17], v[28:29]
    v_pk_fma_f32 v[210:211], v[94:95], v[16:17], v[28:29]
    v_pk_fma_f32 v[212:213], v[96:97], v[16:17], v[28:29]
    v_pk_fma_f32 v[214:215], v[98:99], v[16:17], v[28:29]
    v_pk_fma_f32 v[216:217], v[100:101], v[16:17], v[28:29]
    v_pk_fma_f32 v[218:219], v[102:103], v[16:17], v[28:29]
    v_pk_fma_f32 v[220:221], v[84:85], v[16:17], v[30:31] neg_lo:[1,0,0] neg_hi:[1,0,0]
    v_pk_fma_f32 v[222:223], v[86:87], v[16:17], v[30:31] neg_lo:[1,0,0] neg_hi:[1,0,0]
    v_pk_fma_f32 v[224:225], v[88:89], v[16:17], v[30:31] neg_lo:[1,0,0] neg_hi:[1,0,0]
    v_pk_fma_f32 v[226:227], v[90:91], v[16:17], v[30:31] neg_lo:[1,0,0] neg_hi:[1,0,0]
    v_pk_fma_f32 v[228:229], v[92:93], v[16:17], v[30:31] neg_lo:[1,0,0] neg_hi:[1,0,0]
    v_pk_fma_f32 v[230:231], v[94:95], v[16:17], v[30:31] neg_lo:[1,0,0] neg_hi:[1,0,0]
    v_pk_fma_f32 v[232:233], v[96:97], v[16:17], v[30:31] neg_lo:[1,0,0] neg_hi:[1,0,0]
    v_pk_fma_f32 v[234:235], v[98:99], v[16:17], v[30:31] neg_lo:[1,0,0] neg_hi:[1,0,0]
    v_pk_fma_f32 v[236:237], v[100:101], v[16:17], v[30:31] neg_lo:[1,0,0] neg_hi:[1,0,0]
    v_pk_fma_f32 v[238:239], v[102:103], v[16:17], v[30:31] neg_lo:[1,0,0] neg_hi:[1,0,0]
    v_exp_f32 v160, v160
    v_exp_f32 v161, v161
    v_exp_f32 v162, v162
    v_exp_f32 v163, v163
    v_exp_f32 v164, v164
    v_exp_f32 v165, v165
    v_exp_f32 v166, v166
    v_exp_f32 v167, v167
    v_exp_f32 v168, v168
    v_exp_f32 v169, v169
    v_exp_f32 v170, v170
    v_exp_f32 v171, v171
    v_exp_f32 v172, v172
    v_exp_f32 v173, v173
    v_exp_f32 v174, v174
    v_exp_f32 v175, v175
    v_exp_f32 v176, v176
    v_exp_f32 v177, v177
    v_exp_f32 v178, v178
    v_exp_f32 v179, v179
    v_exp_f32 v180, v180
    v_exp_f32 v181, v181
    v_exp_f32 v182, v182
    v_exp_f32 v183, v183
    v_exp_f32 v184, v184
    v_exp_f32 v185, v185
    v_exp_f32 v186, v186
    v_exp_f32 v187, v187
    v_exp_f32 v188, v188
    v_exp_f32 v189, v189
    v_exp_f32 v190, v190
    v_exp_f32 v191, v191
    v_exp_f32 v192, v192
    v_exp_f32 v193, v193
    v_exp_f32 v194, v194
    v_exp_f32 v195, v195
    v_exp_f32 v196, v196
    v_exp_f32 v197, v197
    v_exp_f32 v198, v198
    v_exp_f32 v199, v199
    v_exp_f32 v200, v200
    v_exp_f32 v201, v201
    v_exp_f32 v202, v202
    v_exp_f32 v203, v203
    v_exp_f32 v204, v204
    v_exp_f32 v205, v205
    v_exp_f32 v206, v206
    v_exp_f32 v207, v207
    v_exp_f32 v208, v208
    v_exp_f32 v209, v209
    v_exp_f32 v210, v210
    v_exp_f32 v211, v211
    v_exp_f32 v212, v212
    v_exp_f32 v213, v213
    v_exp_f32 v214, v214
    v_exp_f32 v215, v215
    v_exp_f32 v216, v216
    v_exp_f32 v217, v217
    v_exp_f32 v218, v218
    v_exp_f32 v219, v219
    v_exp_f32 v220, v220
    v_exp_f32 v221, v221
    v_exp_f32 v222, v222
    v_exp_f32 v223, v223
    v_exp_f32 v224, v224
    v_exp_f32 v225, v225
    v_exp_f32 v226, v226
    v_exp_f32 v227, v227
    v_exp_f32 v228, v228
    v_exp_f32 v229, v229
    v_exp_f32 v230, v230
    v_exp_f32 v231, v231
    v_exp_f32 v232, v232
    v_exp_f32 v233, v233
    v_exp_f32 v234, v234
    v_exp_f32 v235, v235
    v_exp_f32 v236, v236
    v_exp_f32 v237, v237
    v_exp_f32 v238, v238
    v_exp_f32 v239, v239
    s_nop 0
    v_pk_add_f32 v[32:33], v[160:161], v[162:163]
    v_pk_add_f32 v[32:33], v[32:33], v[164:165]
    v_pk_add_f32 v[32:33], v[32:33], v[166:167]
    v_pk_add_f32 v[32:33], v[32:33], v[168:169]
    v_pk_add_f32 v[32:33], v[32:33], v[170:171]
    v_pk_add_f32 v[32:33], v[32:33], v[172:173]
    v_pk_add_f32 v[32:33], v[32:33], v[174:175]
    v_pk_add_f32 v[32:33], v[32:33], v[176:177]
    v_pk_add_f32 v[32:33], v[32:33], v[178:179]
    v_pk_add_f32 v[34:35], v[180:181], v[182:183]
    v_pk_add_f32 v[34:35], v[34:35], v[184:185]
    v_pk_add_f32 v[34:35], v[34:35], v[186:187]
    v_pk_add_f32 v[34:35], v[34:35], v[188:189]
    v_pk_add_f32 v[34:35], v[34:35], v[190:191]
    v_pk_add_f32 v[34:35], v[34:35], v[192:193]
    v_pk_add_f32 v[34:35], v[34:35], v[194:195]
    v_pk_add_f32 v[34:35], v[34:35], v[196:197]
    v_pk_add_f32 v[34:35], v[34:35], v[198:199]
    v_pk_add_f32 v[36:37], v[200:201], v[202:203]
    v_pk_add_f32 v[36:37], v[36:37], v[204:205]
    v_pk_add_f32 v[36:37], v[36:37], v[206:207]
    v_pk_add_f32 v[36:37], v[36:37], v[208:209]
    v_pk_add_f32 v[36:37], v[36:37], v[210:211]
    v_pk_add_f32 v[36:37], v[36:37], v[212:213]
    v_pk_add_f32 v[36:37], v[36:37], v[214:215]
    v_pk_add_f32 v[36:37], v[36:37], v[216:217]
    v_pk_add_f32 v[36:37], v[36:37], v[218:219]
    v_pk_add_f32 v[38:39], v[220:221], v[222:223]
    v_pk_add_f32 v[38:39], v[38:39], v[224:225]
    v_pk_add_f32 v[38:39], v[38:39], v[226:227]
    v_pk_add_f32 v[38:39], v[38:39], v[228:229]
    v_pk_add_f32 v[38:39], v[38:39], v[230:231]
    v_pk_add_f32 v[38:39], v[38:39], v[232:233]
    v_pk_add_f32 v[38:39], v[38:39], v[234:235]
    v_pk_add_f32 v[38:39], v[38:39], v[236:237]
    v_pk_add_f32 v[38:39], v[38:39], v[238:239]
    v_add_f32 v32, v32, v33
    v_add_f32 v34, v34, v35
    v_add_f32 v36, v36, v37
    v_add_f32 v38, v38, v39
    v_rcp_f32 v32, v32
    v_rcp_f32 v34, v34
    v_rcp_f32 v36, v36
    v_rcp_f32 v38, v38
    s_nop 0
    v_mov_b32 v33, v32
    v_mov_b32 v35, v34
    v_mov_b32 v37, v36
    v_mov_b32 v39, v38
    v_pk_mul_f32 v[160:161], v[160:161], v[32:33]
    v_pk_mul_f32 v[162:163], v[162:163], v[32:33]
    v_pk_mul_f32 v[164:165], v[164:165], v[32:33]
    v_pk_mul_f32 v[166:167], v[166:167], v[32:33]
    v_pk_mul_f32 v[168:169], v[168:169], v[32:33]
    v_pk_mul_f32 v[170:171], v[170:171], v[32:33]
    v_pk_mul_f32 v[172:173], v[172:173], v[32:33]
    v_pk_mul_f32 v[174:175], v[174:175], v[32:33]
    v_pk_mul_f32 v[176:177], v[176:177], v[32:33]
    v_pk_mul_f32 v[178:179], v[178:179], v[32:33]
    v_pk_mul_f32 v[180:181], v[180:181], v[34:35]
    v_pk_mul_f32 v[182:183], v[182:183], v[34:35]
    v_pk_mul_f32 v[184:185], v[184:185], v[34:35]
    v_pk_mul_f32 v[186:187], v[186:187], v[34:35]
    v_pk_mul_f32 v[188:189], v[188:189], v[34:35]
    v_pk_mul_f32 v[190:191], v[190:191], v[34:35]
    v_pk_mul_f32 v[192:193], v[192:193], v[34:35]
    v_pk_mul_f32 v[194:195], v[194:195], v[34:35]
    v_pk_mul_f32 v[196:197], v[196:197], v[34:35]
    v_pk_mul_f32 v[198:199], v[198:199], v[34:35]
    v_pk_mul_f32 v[200:201], v[200:201], v[36:37]
    v_pk_mul_f32 v[202:203], v[202:203], v[36:37]
    v_pk_mul_f32 v[204:205], v[204:205], v[36:37]
    v_pk_mul_f32 v[206:207], v[206:207], v[36:37]
    v_pk_mul_f32 v[208:209], v[208:209], v[36:37]
    v_pk_mul_f32 v[210:211], v[210:211], v[36:37]
    v_pk_mul_f32 v[212:213], v[212:213], v[36:37]
    v_pk_mul_f32 v[214:215], v[214:215], v[36:37]
    v_pk_mul_f32 v[216:217], v[216:217], v[36:37]
    v_pk_mul_f32 v[218:219], v[218:219], v[36:37]
    v_pk_mul_f32 v[220:221], v[220:221], v[38:39]
    v_pk_mul_f32 v[222:223], v[222:223], v[38:39]
    v_pk_mul_f32 v[224:225], v[224:225], v[38:39]
    v_pk_mul_f32 v[226:227], v[226:227], v[38:39]
    v_pk_mul_f32 v[228:229], v[228:229], v[38:39]
    v_pk_mul_f32 v[230:231], v[230:231], v[38:39]
    v_pk_mul_f32 v[232:233], v[232:233], v[38:39]
    v_pk_mul_f32 v[234:235], v[234:235], v[38:39]
    v_pk_mul_f32 v[236:237], v[236:237], v[38:39]
    v_pk_mul_f32 v[238:239], v[238:239], v[38:39]
    v_cvt_pk_bf16_f32 v64, v160, v161
    v_cvt_pk_bf16_f32 v65, v162, v163
    v_cvt_pk_bf16_f32 v66, v164, v165
    v_cvt_pk_bf16_f32 v67, v166, v167
    v_cvt_pk_bf16_f32 v68, v168, v169
    v_cvt_pk_bf16_f32 v69, v170, v171
    v_cvt_pk_bf16_f32 v70, v172, v173
    v_cvt_pk_bf16_f32 v71, v174, v175
    v_cvt_pk_bf16_f32 v72, v176, v177
    v_cvt_pk_bf16_f32 v73, v178, v179
    v_cvt_pk_bf16_f32 v74, v180, v181
    v_cvt_pk_bf16_f32 v75, v182, v183
    v_cvt_pk_bf16_f32 v76, v184, v185
    v_cvt_pk_bf16_f32 v77, v186, v187
    v_cvt_pk_bf16_f32 v78, v188, v189
    v_cvt_pk_bf16_f32 v79, v190, v191
    v_cvt_pk_bf16_f32 v80, v192, v193
    v_cvt_pk_bf16_f32 v81, v194, v195
    v_cvt_pk_bf16_f32 v82, v196, v197
    v_cvt_pk_bf16_f32 v83, v198, v199
    v_cvt_pk_bf16_f32 v84, v200, v201
    v_cvt_pk_bf16_f32 v85, v202, v203
    v_cvt_pk_bf16_f32 v86, v204, v205
    v_cvt_pk_bf16_f32 v87, v206, v207
    v_cvt_pk_bf16_f32 v88, v208, v209
    v_cvt_pk_bf16_f32 v89, v210, v211
    v_cvt_pk_bf16_f32 v90, v212, v213
    v_cvt_pk_bf16_f32 v91, v214, v215
    v_cvt_pk_bf16_f32 v92, v216, v217
    v_cvt_pk_bf16_f32 v93, v218, v219
    v_cvt_pk_bf16_f32 v94, v220, v221
    v_cvt_pk_bf16_f32 v95, v222, v223
    v_cvt_pk_bf16_f32 v96, v224, v225
    v_cvt_pk_bf16_f32 v97, v226, v227
    v_cvt_pk_bf16_f32 v98, v228, v229
    v_cvt_pk_bf16_f32 v99, v230, v231
    v_cvt_pk_bf16_f32 v100, v232, v233
    v_cvt_pk_bf16_f32 v101, v234, v235
    v_cvt_pk_bf16_f32 v102, v236, v237
    v_cvt_pk_bf16_f32 v103, v238, v239
    s_mov_b64 exec, s[52:53]
    ds_write_b128 v11, v[64:67] offset:0
    ds_write_b128 v11, v[68:71] offset:16
    ds_write_b128 v11, v[72:75] offset:32
    ds_write_b128 v11, v[76:79] offset:48
    ds_write_b128 v11, v[80:83] offset:64
    ds_write_b128 v11, v[84:87] offset:80
    ds_write_b128 v11, v[88:91] offset:96
    ds_write_b128 v11, v[92:95] offset:112
    ds_write_b128 v11, v[96:99] offset:128
    ds_write_b128 v11, v[100:103] offset:144
    s_mov_b64 exec, -1
    v_lshrrev_b32 v5, 4, v1
    v_bfe_u32 v6, v1, 2, 2
    v_lshl_add_u32 v5, v5, 2, v6
    v_mul_u32_u24 v5, 288, v5
    v_and_b32 v6, 3, v1
    v_lshl_add_u32 v5, v6, 3, v5
    v_add_u32 v5, 0, v5
    s_lshl_b32 s43, s42, 4
    s_add_u32 s43, s43, s41
    s_mul_i32 s47, s43, 7680
    s_add_u32 s47, s47, 9437184
    v_lshlrev_b32 v8, 4, v1
    v_mov_b32 v6, 148992
    v_mov_b32 v7, 1
    s_waitcnt lgkmcnt(0)
    s_mov_b64 exec, 1
    ds_add_u32 v6, v7
    s_mov_b64 exec, -1
L_lsync_3:
    ds_read_b32 v7, v6
    s_waitcnt lgkmcnt(0)
    v_readfirstlane_b32 s43, v7
    s_nop 3
    s_cmp_lt_u32 s43, 4
    s_cbranch_scc1 L_lsync_3
    s_add_u32 s54, s60, 0
    s_min_u32 s54, s54, 14
    s_mul_i32 s55, s54, 11
    s_lshr_b32 s55, s55, 5
    s_mul_i32 s56, s55, 3
    s_sub_u32 s56, s54, s56
    s_lshl_b32 s55, s55, 5
    s_lshl_b32 s56, s56, 5
    s_add_u32 s56, s56, 160
    v_add_u32 v6, s55, v5
    v_add_u32 v7, s56, v5
    ds_read_b64_tr_b16 v[104:105], v6 offset:0
    ds_read_b64_tr_b16 v[108:109], v7 offset:0
    ds_read_b64_tr_b16 v[106:107], v6 offset:4608
    ds_read_b64_tr_b16 v[110:111], v7 offset:4608
    ds_read_b64_tr_b16 v[112:113], v6 offset:9216
    ds_read_b64_tr_b16 v[116:117], v7 offset:9216
    ds_read_b64_tr_b16 v[114:115], v6 offset:13824
    ds_read_b64_tr_b16 v[118:119], v7 offset:13824
    ds_read_b64_tr_b16 v[120:121], v6 offset:18432
    ds_read_b64_tr_b16 v[124:125], v7 offset:18432
    ds_read_b64_tr_b16 v[122:123], v6 offset:23040
    ds_read_b64_tr_b16 v[126:127], v7 offset:23040
    ds_read_b64_tr_b16 v[128:129], v6 offset:27648
    ds_read_b64_tr_b16 v[132:133], v7 offset:27648
    ds_read_b64_tr_b16 v[130:131], v6 offset:32256
    ds_read_b64_tr_b16 v[134:135], v7 offset:32256
    s_lshl_b32 s54, s54, 9
    s_add_u32 s68, s54, s47
    s_add_u32 s54, s60, 4
    s_min_u32 s54, s54, 14
    s_mul_i32 s55, s54, 11
    s_lshr_b32 s55, s55, 5
    s_mul_i32 s56, s55, 3
    s_sub_u32 s56, s54, s56
    s_lshl_b32 s55, s55, 5
    s_lshl_b32 s56, s56, 5
    s_add_u32 s56, s56, 160
    v_add_u32 v6, s55, v5
    v_add_u32 v7, s56, v5
    ds_read_b64_tr_b16 v[136:137], v6 offset:0
    ds_read_b64_tr_b16 v[140:141], v7 offset:0
    ds_read_b64_tr_b16 v[138:139], v6 offset:4608
    ds_read_b64_tr_b16 v[142:143], v7 offset:4608
    ds_read_b64_tr_b16 v[144:145], v6 offset:9216
    ds_read_b64_tr_b16 v[148:149], v7 offset:9216
    ds_read_b64_tr_b16 v[146:147], v6 offset:13824
    ds_read_b64_tr_b16 v[150:151], v7 offset:13824
    ds_read_b64_tr_b16 v[152:153], v6 offset:18432
    ds_read_b64_tr_b16 v[156:157], v7 offset:18432
    ds_read_b64_tr_b16 v[154:155], v6 offset:23040
    ds_read_b64_tr_b16 v[158:159], v7 offset:23040
    ds_read_b64_tr_b16 v[160:161], v6 offset:27648
    ds_read_b64_tr_b16 v[164:165], v7 offset:27648
    ds_read_b64_tr_b16 v[162:163], v6 offset:32256
    ds_read_b64_tr_b16 v[166:167], v7 offset:32256
    s_lshl_b32 s54, s54, 9
    s_add_u32 s69, s54, s47
    s_add_u32 s54, s60, 8
    s_min_u32 s54, s54, 14
    s_mul_i32 s55, s54, 11
    s_lshr_b32 s55, s55, 5
    s_mul_i32 s56, s55, 3
    s_sub_u32 s56, s54, s56
    s_lshl_b32 s55, s55, 5
    s_lshl_b32 s56, s56, 5
    s_add_u32 s56, s56, 160
    v_add_u32 v6, s55, v5
    v_add_u32 v7, s56, v5
    ds_read_b64_tr_b16 v[168:169], v6 offset:0
    ds_read_b64_tr_b16 v[172:173], v7 offset:0
    ds_read_b64_tr_b16 v[170:171], v6 offset:4608
    ds_read_b64_tr_b16 v[174:175], v7 offset:4608
    ds_read_b64_tr_b16 v[176:177], v6 offset:9216
    ds_read_b64_tr_b16 v[180:181], v7 offset:9216
    ds_read_b64_tr_b16 v[178:179], v6 offset:13824
    ds_read_b64_tr_b16 v[182:183], v7 offset:13824
    ds_read_b64_tr_b16 v[184:185], v6 offset:18432
    ds_read_b64_tr_b16 v[188:189], v7 offset:18432
    ds_read_b64_tr_b16 v[186:187], v6 offset:23040
    ds_read_b64_tr_b16 v[190:191], v7 offset:23040
    ds_read_b64_tr_b16 v[192:193], v6 offset:27648
    ds_read_b64_tr_b16 v[196:197], v7 offset:27648
    ds_read_b64_tr_b16 v[194:195], v6 offset:32256
    ds_read_b64_tr_b16 v[198:199], v7 offset:32256
    s_lshl_b32 s54, s54, 9
    s_add_u32 s70, s54, s47
    s_add_u32 s54, s60, 12
    s_min_u32 s54, s54, 14
    s_mul_i32 s55, s54, 11
    s_lshr_b32 s55, s55, 5
    s_mul_i32 s56, s55, 3
    s_sub_u32 s56, s54, s56
    s_lshl_b32 s55, s55, 5
    s_lshl_b32 s56, s56, 5
    s_add_u32 s56, s56, 160
    v_add_u32 v6, s55, v5
    v_add_u32 v7, s56, v5
    ds_read_b64_tr_b16 v[200:201], v6 offset:0
    ds_read_b64_tr_b16 v[204:205], v7 offset:0
    ds_read_b64_tr_b16 v[202:203], v6 offset:4608
    ds_read_b64_tr_b16 v[206:207], v7 offset:4608
    ds_read_b64_tr_b16 v[208:209], v6 offset:9216
    ds_read_b64_tr_b16 v[212:213], v7 offset:9216
    ds_read_b64_tr_b16 v[210:211], v6 offset:13824
    ds_read_b64_tr_b16 v[214:215], v7 offset:13824
    ds_read_b64_tr_b16 v[216:217], v6 offset:18432
    ds_read_b64_tr_b16 v[220:221], v7 offset:18432
    ds_read_b64_tr_b16 v[218:219], v6 offset:23040
    ds_read_b64_tr_b16 v[222:223], v7 offset:23040
    ds_read_b64_tr_b16 v[224:225], v6 offset:27648
    ds_read_b64_tr_b16 v[228:229], v7 offset:27648
    ds_read_b64_tr_b16 v[226:227], v6 offset:32256
    ds_read_b64_tr_b16 v[230:231], v7 offset:32256
    s_lshl_b32 s54, s54, 9
    s_add_u32 s71, s54, s47
    s_waitcnt lgkmcnt(0)
    v_mfma_f32_16x16x32_bf16 v[16:19], v[104:107], v[108:111], 0
    v_mfma_f32_16x16x32_bf16 v[20:23], v[136:139], v[140:143], 0
    v_mfma_f32_16x16x32_bf16 v[24:27], v[168:171], v[172:175], 0
    v_mfma_f32_16x16x32_bf16 v[28:31], v[200:203], v[204:207], 0
    v_mfma_f32_16x16x32_bf16 v[16:19], v[112:115], v[116:119], v[16:19]
    v_mfma_f32_16x16x32_bf16 v[20:23], v[144:147], v[148:151], v[20:23]
    v_mfma_f32_16x16x32_bf16 v[24:27], v[176:179], v[180:183], v[24:27]
    v_mfma_f32_16x16x32_bf16 v[28:31], v[208:211], v[212:215], v[28:31]
    v_mfma_f32_16x16x32_bf16 v[16:19], v[120:123], v[124:127], v[16:19]
    v_mfma_f32_16x16x32_bf16 v[20:23], v[152:155], v[156:159], v[20:23]
    v_mfma_f32_16x16x32_bf16 v[24:27], v[184:187], v[188:191], v[24:27]
    v_mfma_f32_16x16x32_bf16 v[28:31], v[216:219], v[220:223], v[28:31]
    v_mfma_f32_16x16x32_bf16 v[16:19], v[128:131], v[132:135], v[16:19]
    v_mfma_f32_16x16x32_bf16 v[20:23], v[160:163], v[164:167], v[20:23]
    v_mfma_f32_16x16x32_bf16 v[24:27], v[192:195], v[196:199], v[24:27]
    v_mfma_f32_16x16x32_bf16 v[28:31], v[224:227], v[228:231], v[28:31]
    s_nop 7
    v_lshlrev_b32 v8, 3, v1
    v_cvt_pk_bf16_f32 v40, v16, v17
    v_cvt_pk_bf16_f32 v41, v18, v19
    v_cvt_pk_bf16_f32 v42, v20, v21
    v_cvt_pk_bf16_f32 v43, v22, v23
    v_cvt_pk_bf16_f32 v44, v24, v25
    v_cvt_pk_bf16_f32 v45, v26, v27
    v_cvt_pk_bf16_f32 v46, v28, v29
    v_cvt_pk_bf16_f32 v47, v30, v31
    buffer_store_dwordx2 v[40:41], v8, s[32:35], s68 offen sc1
    buffer_store_dwordx2 v[42:43], v8, s[32:35], s69 offen sc1
    buffer_store_dwordx2 v[44:45], v8, s[32:35], s70 offen sc1
    buffer_store_dwordx2 v[46:47], v8, s[32:35], s71 offen sc1
    v_mov_b32 v32, 0
    v_mov_b32 v33, 0
    v_mov_b32 v34, 0
    v_mov_b32 v35, 0
    v_lshlrev_b32 v5, 4, v0
    v_add_u32 v5, 131072, v5
    ds_write_b128 v5, v[32:35]
    ds_write_b128 v5, v[32:35] offset:4096
    ds_write_b128 v5, v[32:35] offset:8192
    v_permlane32_swap_b32 v64, v84
    v_permlane32_swap_b32 v65, v85
    v_permlane32_swap_b32 v66, v86
    v_permlane32_swap_b32 v67, v87
    v_permlane32_swap_b32 v68, v88
    v_permlane32_swap_b32 v69, v89
    v_permlane32_swap_b32 v70, v90
    v_permlane32_swap_b32 v71, v91
    v_permlane32_swap_b32 v72, v92
    v_permlane32_swap_b32 v73, v93
    v_permlane32_swap_b32 v74, v94
    v_permlane32_swap_b32 v75, v95
    v_permlane32_swap_b32 v76, v96
    v_permlane32_swap_b32 v77, v97
    v_permlane32_swap_b32 v78, v98
    v_permlane32_swap_b32 v79, v99
    v_permlane32_swap_b32 v80, v100
    v_permlane32_swap_b32 v81, v101
    v_permlane32_swap_b32 v82, v102
    v_permlane32_swap_b32 v83, v103
    s_mul_i32 s46, s42, 122880
    s_add_u32 s46, s46, 9437184
    v_lshlrev_b32 v8, 3, v1
    s_add_u32 s54, s40, 0
    s_min_u32 s54, s54, 14
    s_lshl_b32 s62, s54, 9
    s_add_u32 s62, s62, s46
    s_mul_i32 s55, s54, 11
    s_lshr_b32 s55, s55, 5
    s_mul_i32 s56, s55, 3
    s_sub_u32 s56, s54, s56
    s_lshl_b32 s55, s55, 4
    s_lshl_b32 s56, s56, 4
    v_and_b32 v39, 15, v1
    v_add_u32 v39, s56, v39
    v_lshrrev_b32 v40, 4, v1
    v_lshlrev_b32 v40, 2, v40
    v_add_u32 v40, s55, v40
    v_cmp_le_u32 vcc, 40, v40
    s_nop 1
    v_cndmask_b32 v41, 0, 1, vcc
    v_mul_u32_u24 v42, 40, v41
    v_sub_u32 v40, v40, v42
    v_mul_u32_u24 v42, 20, v41
    v_sub_u32 v42, v39, v42
    v_cmp_gt_u32 s[64:65], 20, v42
    v_cmp_eq_u32 s[48:49], 40, v39
    s_nop 1
    v_cndmask_b32 v42, v42, 20, s[48:49]
    s_or_b64 s[64:65], s[64:65], s[48:49]
    v_lshrrev_b32 v43, 2, v42
    v_lshlrev_b32 v43, 3, v43
    v_lshl_add_u32 v43, v41, 2, v43
    v_and_b32 v44, 3, v42
    v_add_u32 v43, v43, v44
    v_mul_u32_u24 v43, 160, v43
    v_lshrrev_b32 v44, 3, v40
    v_lshlrev_b32 v44, 4, v44
    v_lshl_add_u32 v44, v41, 3, v44
    v_and_b32 v45, 7, v40
    v_add_u32 v44, v44, v45
    v_lshl_add_u32 v43, v44, 1, v43
    v_add_u32 v36, 131072, v43
    s_add_u32 s54, s40, 8
    s_min_u32 s54, s54, 14
    s_lshl_b32 s63, s54, 9
    s_add_u32 s63, s63, s46
    s_mul_i32 s55, s54, 11
    s_lshr_b32 s55, s55, 5
    s_mul_i32 s56, s55, 3
    s_sub_u32 s56, s54, s56
    s_lshl_b32 s55, s55, 4
    s_lshl_b32 s56, s56, 4
    v_and_b32 v39, 15, v1
    v_add_u32 v39, s56, v39
    v_lshrrev_b32 v40, 4, v1
    v_lshlrev_b32 v40, 2, v40
    v_add_u32 v40, s55, v40
    v_cmp_le_u32 vcc, 40, v40
    s_nop 1
    v_cndmask_b32 v41, 0, 1, vcc
    v_mul_u32_u24 v42, 40, v41
    v_sub_u32 v40, v40, v42
    v_mul_u32_u24 v42, 20, v41
    v_sub_u32 v42, v39, v42
    v_cmp_gt_u32 s[66:67], 20, v42
    v_cmp_eq_u32 s[48:49], 40, v39
    s_nop 1
    v_cndmask_b32 v42, v42, 20, s[48:49]
    s_or_b64 s[66:67], s[66:67], s[48:49]
    v_lshrrev_b32 v43, 2, v42
    v_lshlrev_b32 v43, 3, v43
    v_lshl_add_u32 v43, v41, 2, v43
    v_and_b32 v44, 3, v42
    v_add_u32 v43, v43, v44
    v_mul_u32_u24 v43, 160, v43
    v_lshrrev_b32 v44, 3, v40
    v_lshlrev_b32 v44, 4, v44
    v_lshl_add_u32 v44, v41, 3, v44
    v_and_b32 v45, 7, v40
    v_add_u32 v44, v44, v45
    v_lshl_add_u32 v43, v44, 1, v43
    v_add_u32 v37, 131072, v43
    s_lshl_b32 s43, s41, 1
    s_lshr_b32 s47, s60, 1
    s_add_u32 s43, s43, s47
    s_mul_i32 s43, s43, 278528
    s_and_b32 s47, s60, 1
    s_lshl_b32 s47, s47, 11
    s_add_u32 s47, s47, s43
    s_mul_i32 s43, s42, 40
    v_mul_u32_u24 v9, 20, v3
    v_add_u32 v9, s43, v9
    v_lshlrev_b32 v10, 6, v4
    v_add_u32 v11, 0, v9
    v_lshrrev_b32 v12, 5, v11
    v_lshlrev_b32 v12, 12, v12
    v_and_b32 v11, 31, v11
    v_lshl_add_u32 v12, v11, 1, v12
    v_add_u32 v50, v12, v10
    v_add_u32 v11, 4, v9
    v_lshrrev_b32 v12, 5, v11
    v_lshlrev_b32 v12, 12, v12
    v_and_b32 v11, 31, v11
    v_lshl_add_u32 v12, v11, 1, v12
    v_add_u32 v51, v12, v10
    v_add_u32 v11, 8, v9
    v_lshrrev_b32 v12, 5, v11
    v_lshlrev_b32 v12, 12, v12
    v_and_b32 v11, 31, v11
    v_lshl_add_u32 v12, v11, 1, v12
    v_add_u32 v52, v12, v10
    v_add_u32 v11, 12, v9
    v_lshrrev_b32 v12, 5, v11
    v_lshlrev_b32 v12, 12, v12
    v_and_b32 v11, 31, v11
    v_lshl_add_u32 v12, v11, 1, v12
    v_add_u32 v53, v12, v10
    v_add_u32 v11, 16, v9
    v_lshrrev_b32 v12, 5, v11
    v_lshlrev_b32 v12, 12, v12
    v_and_b32 v11, 31, v11
    v_lshl_add_u32 v12, v11, 1, v12
    v_add_u32 v54, v12, v10
    v_mul_u32_u24 v38, 160, v4
    v_lshl_add_u32 v38, v3, 4, v38
    v_add_u32 v38, 131072, v38
    s_waitcnt vmcnt(0)
    v_mov_b32 v6, 148996
    v_mov_b32 v7, 1
    s_waitcnt lgkmcnt(0)
    s_mov_b64 exec, 1
    ds_add_u32 v6, v7
    s_mov_b64 exec, -1
L_lsync_4:
    ds_read_b32 v7, v6
    s_waitcnt lgkmcnt(0)
    v_readfirstlane_b32 s43, v7
    s_nop 3
    s_cmp_lt_u32 s43, 4
    s_cbranch_scc1 L_lsync_4
    s_mov_b32 s52, s58
    s_and_b32 s53, s59, 0xffff
    s_mov_b32 s54, 256
    s_mov_b32 s55, 0x00020000
    s_lshl_b32 s56, s42, 2
    s_add_u32 s56, s56, 64
    v_mov_b32 v6, 1
    v_mov_b32 v7, 0
    s_cmp_lg_u32 s40, 0
    s_cbranch_scc1 L_nopoll_5
    s_mov_b64 exec, 1
    buffer_atomic_add v6, v7, s[52:55], s56 offen sc0 sc1
    s_lshl_b32 s46, s42, 12
    s_add_u32 s46, s46, 29360128
    s_lshl_b32 s44, s41, 8
    s_add_u32 s44, s44, s46
    s_waitcnt vmcnt(0)
    v_readfirstlane_b32 s43, v6
    s_nop 3
    s_and_b32 s43, s43, 15
    s_cmp_lg_u32 s43, 15
    s_cbranch_scc1 L_notlast_6
    s_mov_b64 exec, 0xffff
    v_lshlrev_b32 v6, 8, v1
    v_mov_b32 v9, 1
    buffer_store_dword v9, v6, s[32:35], s46 offen sc1
    s_mov_b64 exec, 1
L_notlast_6:
L_kpoll_7:
    s_sleep 2
    buffer_load_dword v6, v7, s[32:35], s44 offen sc1
    s_waitcnt vmcnt(0)
    v_readfirstlane_b32 s43, v6
    s_nop 3
    s_cmp_lg_u32 s43, 1
    s_cbranch_scc1 L_kpoll_7
    s_mov_b64 exec, -1
L_nopoll_5:
    s_barrier
    buffer_load_dwordx2 v[106:107], v8, s[32:35], s62 offen sc1
    s_add_u32 s62, s62, 7680
    buffer_load_dwordx2 v[110:111], v8, s[32:35], s62 offen sc1
    s_add_u32 s62, s62, 7680
    buffer_load_dwordx2 v[114:115], v8, s[32:35], s62 offen sc1
    s_add_u32 s62, s62, 7680
    buffer_load_dwordx2 v[118:119], v8, s[32:35], s62 offen sc1
    s_add_u32 s62, s62, 7680
    buffer_load_dwordx2 v[122:123], v8, s[32:35], s62 offen sc1
    s_add_u32 s62, s62, 7680
    buffer_load_dwordx2 v[126:127], v8, s[32:35], s62 offen sc1
    s_add_u32 s62, s62, 7680
    buffer_load_dwordx2 v[130:131], v8, s[32:35], s62 offen sc1
    s_add_u32 s62, s62, 7680
    buffer_load_dwordx2 v[134:135], v8, s[32:35], s62 offen sc1
    s_add_u32 s62, s62, 7680
    buffer_load_dwordx2 v[138:139], v8, s[32:35], s62 offen sc1
    s_add_u32 s62, s62, 7680
    buffer_load_dwordx2 v[142:143], v8, s[32:35], s62 offen sc1
    s_add_u32 s62, s62, 7680
    buffer_load_dwordx2 v[146:147], v8, s[32:35], s62 offen sc1
    s_add_u32 s62, s62, 7680
    buffer_load_dwordx2 v[150:151], v8, s[32:35], s62 offen sc1
    s_add_u32 s62, s62, 7680
    buffer_load_dwordx2 v[154:155], v8, s[32:35], s62 offen sc1
    s_add_u32 s62, s62, 7680
    buffer_load_dwordx2 v[158:159], v8, s[32:35], s62 offen sc1
    s_add_u32 s62, s62, 7680
    buffer_load_dwordx2 v[162:163], v8, s[32:35], s62 offen sc1
    s_add_u32 s62, s62, 7680
    buffer_load_dwordx2 v[166:167], v8, s[32:35], s62 offen sc1
    buffer_load_dwordx2 v[170:171], v8, s[32:35], s63 offen sc1
    s_add_u32 s63, s63, 7680
    buffer_load_dwordx2 v[174:175], v8, s[32:35], s63 offen sc1
    s_add_u32 s63, s63, 7680
    buffer_load_dwordx2 v[178:179], v8, s[32:35], s63 offen sc1
    s_add_u32 s63, s63, 7680
    buffer_load_dwordx2 v[182:183], v8, s[32:35], s63 offen sc1
    s_add_u32 s63, s63, 7680
    buffer_load_dwordx2 v[186:187], v8, s[32:35], s63 offen sc1
    s_add_u32 s63, s63, 7680
    buffer_load_dwordx2 v[190:191], v8, s[32:35], s63 offen sc1
    s_add_u32 s63, s63, 7680
    buffer_load_dwordx2 v[194:195], v8, s[32:35], s63 offen sc1
    s_add_u32 s63, s63, 7680
    buffer_load_dwordx2 v[198:199], v8, s[32:35], s63 offen sc1
    s_add_u32 s63, s63, 7680
    buffer_load_dwordx2 v[202:203], v8, s[32:35], s63 offen sc1
    s_add_u32 s63, s63, 7680
    buffer_load_dwordx2 v[206:207], v8, s[32:35], s63 offen sc1
    s_add_u32 s63, s63, 7680
    buffer_load_dwordx2 v[210:211], v8, s[32:35], s63 offen sc1
    s_add_u32 s63, s63, 7680
    buffer_load_dwordx2 v[214:215], v8, s[32:35], s63 offen sc1
    s_add_u32 s63, s63, 7680
    buffer_load_dwordx2 v[218:219], v8, s[32:35], s63 offen sc1
    s_add_u32 s63, s63, 7680
    buffer_load_dwordx2 v[222:223], v8, s[32:35], s63 offen sc1
    s_add_u32 s63, s63, 7680
    buffer_load_dwordx2 v[226:227], v8, s[32:35], s63 offen sc1
    s_add_u32 s63, s63, 7680
    buffer_load_dwordx2 v[230:231], v8, s[32:35], s63 offen sc1
    s_waitcnt vmcnt(16)
    v_lshlrev_b32 v104, 16, v106
    v_and_b32 v105, 0xffff0000, v106
    v_lshlrev_b32 v106, 16, v107
    v_and_b32 v107, 0xffff0000, v107
    v_lshlrev_b32 v108, 16, v110
    v_and_b32 v109, 0xffff0000, v110
    v_lshlrev_b32 v110, 16, v111
    v_and_b32 v111, 0xffff0000, v111
    v_lshlrev_b32 v112, 16, v114
    v_and_b32 v113, 0xffff0000, v114
    v_lshlrev_b32 v114, 16, v115
    v_and_b32 v115, 0xffff0000, v115
    v_lshlrev_b32 v116, 16, v118
    v_and_b32 v117, 0xffff0000, v118
    v_lshlrev_b32 v118, 16, v119
    v_and_b32 v119, 0xffff0000, v119
    v_lshlrev_b32 v120, 16, v122
    v_and_b32 v121, 0xffff0000, v122
    v_lshlrev_b32 v122, 16, v123
    v_and_b32 v123, 0xffff0000, v123
    v_lshlrev_b32 v124, 16, v126
    v_and_b32 v125, 0xffff0000, v126
    v_lshlrev_b32 v126, 16, v127
    v_and_b32 v127, 0xffff0000, v127
    v_lshlrev_b32 v128, 16, v130
    v_and_b32 v129, 0xffff0000, v130
    v_lshlrev_b32 v130, 16, v131
    v_and_b32 v131, 0xffff0000, v131
    v_lshlrev_b32 v132, 16, v134
    v_and_b32 v133, 0xffff0000, v134
    v_lshlrev_b32 v134, 16, v135
    v_and_b32 v135, 0xffff0000, v135
    v_lshlrev_b32 v136, 16, v138
    v_and_b32 v137, 0xffff0000, v138
    v_lshlrev_b32 v138, 16, v139
    v_and_b32 v139, 0xffff0000, v139
    v_lshlrev_b32 v140, 16, v142
    v_and_b32 v141, 0xffff0000, v142
    v_lshlrev_b32 v142, 16, v143
    v_and_b32 v143, 0xffff0000, v143
    v_lshlrev_b32 v144, 16, v146
    v_and_b32 v145, 0xffff0000, v146
    v_lshlrev_b32 v146, 16, v147
    v_and_b32 v147, 0xffff0000, v147
    v_lshlrev_b32 v148, 16, v150
    v_and_b32 v149, 0xffff0000, v150
    v_lshlrev_b32 v150, 16, v151
    v_and_b32 v151, 0xffff0000, v151
    v_lshlrev_b32 v152, 16, v154
    v_and_b32 v153, 0xffff0000, v154
    v_lshlrev_b32 v154, 16, v155
    v_and_b32 v155, 0xffff0000, v155
    v_lshlrev_b32 v156, 16, v158
    v_and_b32 v157, 0xffff0000, v158
    v_lshlrev_b32 v158, 16, v159
    v_and_b32 v159, 0xffff0000, v159
    v_lshlrev_b32 v160, 16, v162
    v_and_b32 v161, 0xffff0000, v162
    v_lshlrev_b32 v162, 16, v163
    v_and_b32 v163, 0xffff0000, v163
    v_lshlrev_b32 v164, 16, v166
    v_and_b32 v165, 0xffff0000, v166
    v_lshlrev_b32 v166, 16, v167
    v_and_b32 v167, 0xffff0000, v167
    v_pk_add_f32 v[104:105], v[104:105], v[136:137]
    v_pk_add_f32 v[106:107], v[106:107], v[138:139]
    v_pk_add_f32 v[108:109], v[108:109], v[140:141]
    v_pk_add_f32 v[110:111], v[110:111], v[142:143]
    v_pk_add_f32 v[112:113], v[112:113], v[144:145]
    v_pk_add_f32 v[114:115], v[114:115], v[146:147]
    v_pk_add_f32 v[116:117], v[116:117], v[148:149]
    v_pk_add_f32 v[118:119], v[118:119], v[150:151]
    v_pk_add_f32 v[120:121], v[120:121], v[152:153]
    v_pk_add_f32 v[122:123], v[122:123], v[154:155]
    v_pk_add_f32 v[124:125], v[124:125], v[156:157]
    v_pk_add_f32 v[126:127], v[126:127], v[158:159]
    v_pk_add_f32 v[128:129], v[128:129], v[160:161]
    v_pk_add_f32 v[130:131], v[130:131], v[162:163]
    v_pk_add_f32 v[132:133], v[132:133], v[164:165]
    v_pk_add_f32 v[134:135], v[134:135], v[166:167]
    v_pk_add_f32 v[104:105], v[104:105], v[120:121]
    v_pk_add_f32 v[106:107], v[106:107], v[122:123]
    v_pk_add_f32 v[108:109], v[108:109], v[124:125]
    v_pk_add_f32 v[110:111], v[110:111], v[126:127]
    v_pk_add_f32 v[112:113], v[112:113], v[128:129]
    v_pk_add_f32 v[114:115], v[114:115], v[130:131]
    v_pk_add_f32 v[116:117], v[116:117], v[132:133]
    v_pk_add_f32 v[118:119], v[118:119], v[134:135]
    v_pk_add_f32 v[104:105], v[104:105], v[112:113]
    v_pk_add_f32 v[106:107], v[106:107], v[114:115]
    v_pk_add_f32 v[108:109], v[108:109], v[116:117]
    v_pk_add_f32 v[110:111], v[110:111], v[118:119]
    v_pk_add_f32 v[104:105], v[104:105], v[108:109]
    v_pk_add_f32 v[106:107], v[106:107], v[110:111]
    v_cvt_pk_bf16_f32 v44, v104, v105
    v_cvt_pk_bf16_f32 v45, v106, v107
    s_and_saveexec_b64 s[48:49], s[64:65]
    ds_write_b64 v36, v[44:45]
    s_mov_b64 exec, s[48:49]
    s_waitcnt vmcnt(0)
    v_lshlrev_b32 v168, 16, v170
    v_and_b32 v169, 0xffff0000, v170
    v_lshlrev_b32 v170, 16, v171
    v_and_b32 v171, 0xffff0000, v171
    v_lshlrev_b32 v172, 16, v174
    v_and_b32 v173, 0xffff0000, v174
    v_lshlrev_b32 v174, 16, v175
    v_and_b32 v175, 0xffff0000, v175
    v_lshlrev_b32 v176, 16, v178
    v_and_b32 v177, 0xffff0000, v178
    v_lshlrev_b32 v178, 16, v179
    v_and_b32 v179, 0xffff0000, v179
    v_lshlrev_b32 v180, 16, v182
    v_and_b32 v181, 0xffff0000, v182
    v_lshlrev_b32 v182, 16, v183
    v_and_b32 v183, 0xffff0000, v183
    v_lshlrev_b32 v184, 16, v186
    v_and_b32 v185, 0xffff0000, v186
    v_lshlrev_b32 v186, 16, v187
    v_and_b32 v187, 0xffff0000, v187
    v_lshlrev_b32 v188, 16, v190
    v_and_b32 v189, 0xffff0000, v190
    v_lshlrev_b32 v190, 16, v191
    v_and_b32 v191, 0xffff0000, v191
    v_lshlrev_b32 v192, 16, v194
    v_and_b32 v193, 0xffff0000, v194
    v_lshlrev_b32 v194, 16, v195
    v_and_b32 v195, 0xffff0000, v195
    v_lshlrev_b32 v196, 16, v198
    v_and_b32 v197, 0xffff0000, v198
    v_lshlrev_b32 v198, 16, v199
    v_and_b32 v199, 0xffff0000, v199
    v_lshlrev_b32 v200, 16, v202
    v_and_b32 v201, 0xffff0000, v202
    v_lshlrev_b32 v202, 16, v203
    v_and_b32 v203, 0xffff0000, v203
    v_lshlrev_b32 v204, 16, v206
    v_and_b32 v205, 0xffff0000, v206
    v_lshlrev_b32 v206, 16, v207
    v_and_b32 v207, 0xffff0000, v207
    v_lshlrev_b32 v208, 16, v210
    v_and_b32 v209, 0xffff0000, v210
    v_lshlrev_b32 v210, 16, v211
    v_and_b32 v211, 0xffff0000, v211
    v_lshlrev_b32 v212, 16, v214
    v_and_b32 v213, 0xffff0000, v214
    v_lshlrev_b32 v214, 16, v215
    v_and_b32 v215, 0xffff0000, v215
    v_lshlrev_b32 v216, 16, v218
    v_and_b32 v217, 0xffff0000, v218
    v_lshlrev_b32 v218, 16, v219
    v_and_b32 v219, 0xffff0000, v219
    v_lshlrev_b32 v220, 16, v222
    v_and_b32 v221, 0xffff0000, v222
    v_lshlrev_b32 v222, 16, v223
    v_and_b32 v223, 0xffff0000, v223
    v_lshlrev_b32 v224, 16, v226
    v_and_b32 v225, 0xffff0000, v226
    v_lshlrev_b32 v226, 16, v227
    v_and_b32 v227, 0xffff0000, v227
    v_lshlrev_b32 v228, 16, v230
    v_and_b32 v229, 0xffff0000, v230
    v_lshlrev_b32 v230, 16, v231
    v_and_b32 v231, 0xffff0000, v231
    v_pk_add_f32 v[168:169], v[168:169], v[200:201]
    v_pk_add_f32 v[170:171], v[170:171], v[202:203]
    v_pk_add_f32 v[172:173], v[172:173], v[204:205]
    v_pk_add_f32 v[174:175], v[174:175], v[206:207]
    v_pk_add_f32 v[176:177], v[176:177], v[208:209]
    v_pk_add_f32 v[178:179], v[178:179], v[210:211]
    v_pk_add_f32 v[180:181], v[180:181], v[212:213]
    v_pk_add_f32 v[182:183], v[182:183], v[214:215]
    v_pk_add_f32 v[184:185], v[184:185], v[216:217]
    v_pk_add_f32 v[186:187], v[186:187], v[218:219]
    v_pk_add_f32 v[188:189], v[188:189], v[220:221]
    v_pk_add_f32 v[190:191], v[190:191], v[222:223]
    v_pk_add_f32 v[192:193], v[192:193], v[224:225]
    v_pk_add_f32 v[194:195], v[194:195], v[226:227]
    v_pk_add_f32 v[196:197], v[196:197], v[228:229]
    v_pk_add_f32 v[198:199], v[198:199], v[230:231]
    v_pk_add_f32 v[168:169], v[168:169], v[184:185]
    v_pk_add_f32 v[170:171], v[170:171], v[186:187]
    v_pk_add_f32 v[172:173], v[172:173], v[188:189]
    v_pk_add_f32 v[174:175], v[174:175], v[190:191]
    v_pk_add_f32 v[176:177], v[176:177], v[192:193]
    v_pk_add_f32 v[178:179], v[178:179], v[194:195]
    v_pk_add_f32 v[180:181], v[180:181], v[196:197]
    v_pk_add_f32 v[182:183], v[182:183], v[198:199]
    v_pk_add_f32 v[168:169], v[168:169], v[176:177]
    v_pk_add_f32 v[170:171], v[170:171], v[178:179]
    v_pk_add_f32 v[172:173], v[172:173], v[180:181]
    v_pk_add_f32 v[174:175], v[174:175], v[182:183]
    v_pk_add_f32 v[168:169], v[168:169], v[172:173]
    v_pk_add_f32 v[170:171], v[170:171], v[174:175]
    v_cvt_pk_bf16_f32 v44, v168, v169
    v_cvt_pk_bf16_f32 v45, v170, v171
    s_and_saveexec_b64 s[48:49], s[66:67]
    ds_write_b64 v37, v[44:45]
    s_mov_b64 exec, s[48:49]
    s_waitcnt lgkmcnt(0)
    s_barrier
    ds_read_b128 v[160:163], v38 offset:0
    ds_read_b128 v[164:167], v38 offset:32
    ds_read_b128 v[168:171], v38 offset:64
    ds_read_b128 v[172:175], v38 offset:96
    ds_read_b128 v[176:179], v38 offset:128
    ds_read_b128 v[180:183], v38 offset:5120
    ds_read_b128 v[184:187], v38 offset:5152
    ds_read_b128 v[188:191], v38 offset:5184
    ds_read_b128 v[192:195], v38 offset:5216
    ds_read_b128 v[196:199], v38 offset:5248
    s_waitcnt lgkmcnt(0)
    v_mfma_f32_32x32x16_bf16 v[128:143], v[160:163], v[84:87], 0
    v_mfma_f32_32x32x16_bf16 v[144:159], v[180:183], v[84:87], 0
    v_mfma_f32_32x32x16_bf16 v[128:143], v[164:167], v[88:91], v[128:143]
    v_mfma_f32_32x32x16_bf16 v[144:159], v[184:187], v[88:91], v[144:159]
    v_mfma_f32_32x32x16_bf16 v[128:143], v[168:171], v[92:95], v[128:143]
    v_mfma_f32_32x32x16_bf16 v[144:159], v[188:191], v[92:95], v[144:159]
    v_mfma_f32_32x32x16_bf16 v[128:143], v[172:175], v[96:99], v[128:143]
    v_mfma_f32_32x32x16_bf16 v[144:159], v[192:195], v[96:99], v[144:159]
    v_mfma_f32_32x32x16_bf16 v[128:143], v[176:179], v[100:103], v[128:143]
    v_mfma_f32_32x32x16_bf16 v[144:159], v[196:199], v[100:103], v[144:159]
    s_nop 11
    v_cvt_pk_bf16_f32 v16, v128, v129
    v_cvt_pk_bf16_f32 v17, v130, v131
    v_cvt_pk_bf16_f32 v18, v132, v133
    v_cvt_pk_bf16_f32 v19, v134, v135
    v_cvt_pk_bf16_f32 v20, v136, v137
    v_cvt_pk_bf16_f32 v21, v138, v139
    v_cvt_pk_bf16_f32 v22, v140, v141
    v_cvt_pk_bf16_f32 v23, v142, v143
    v_cvt_pk_bf16_f32 v24, v144, v145
    v_cvt_pk_bf16_f32 v25, v146, v147
    v_cvt_pk_bf16_f32 v58, v148, v148
    v_and_b32 v58, 0xffff0000, v58
    v_add_f32 v58, 0x358637bd, v58
    v_cvt_pk_bf16_f32 v58, v58, v58
    v_and_b32 v58, 0xffff0000, v58
    v_rcp_f32 v58, v58
    v_lshlrev_b32 v128, 16, v16
    v_and_b32 v129, 0xffff0000, v16
    v_lshlrev_b32 v130, 16, v17
    v_and_b32 v131, 0xffff0000, v17
    v_lshlrev_b32 v132, 16, v18
    v_and_b32 v133, 0xffff0000, v18
    v_lshlrev_b32 v134, 16, v19
    v_and_b32 v135, 0xffff0000, v19
    v_lshlrev_b32 v136, 16, v20
    v_and_b32 v137, 0xffff0000, v20
    v_lshlrev_b32 v138, 16, v21
    v_and_b32 v139, 0xffff0000, v21
    v_lshlrev_b32 v140, 16, v22
    v_and_b32 v141, 0xffff0000, v22
    v_lshlrev_b32 v142, 16, v23
    v_and_b32 v143, 0xffff0000, v23
    v_lshlrev_b32 v144, 16, v24
    v_and_b32 v145, 0xffff0000, v24
    v_lshlrev_b32 v146, 16, v25
    v_and_b32 v147, 0xffff0000, v25
    v_mov_b32 v59, v58
    v_pk_mul_f32 v[128:129], v[128:129], v[58:59]
    v_pk_mul_f32 v[130:131], v[130:131], v[58:59]
    v_pk_mul_f32 v[132:133], v[132:133], v[58:59]
    v_pk_mul_f32 v[134:135], v[134:135], v[58:59]
    v_pk_mul_f32 v[136:137], v[136:137], v[58:59]
    v_pk_mul_f32 v[138:139], v[138:139], v[58:59]
    v_pk_mul_f32 v[140:141], v[140:141], v[58:59]
    v_pk_mul_f32 v[142:143], v[142:143], v[58:59]
    v_pk_mul_f32 v[144:145], v[144:145], v[58:59]
    v_pk_mul_f32 v[146:147], v[146:147], v[58:59]
    v_cvt_pk_bf16_f32 v16, v128, v129
    v_cvt_pk_bf16_f32 v17, v130, v131
    v_cvt_pk_bf16_f32 v18, v132, v133
    v_cvt_pk_bf16_f32 v19, v134, v135
    v_cvt_pk_bf16_f32 v20, v136, v137
    v_cvt_pk_bf16_f32 v21, v138, v139
    v_cvt_pk_bf16_f32 v22, v140, v141
    v_cvt_pk_bf16_f32 v23, v142, v143
    v_cvt_pk_bf16_f32 v24, v144, v145
    v_cvt_pk_bf16_f32 v25, v146, v147
    buffer_store_dwordx2 v[16:17], v50, s[32:35], s47 offen
    buffer_store_dwordx2 v[18:19], v51, s[32:35], s47 offen
    buffer_store_dwordx2 v[20:21], v52, s[32:35], s47 offen
    buffer_store_dwordx2 v[22:23], v53, s[32:35], s47 offen
    buffer_store_dwordx2 v[24:25], v54, s[32:35], s47 offen
    s_endpgm
L_k1_roleB:
    s_add_u32 m0, s75, 0
    s_nop 0
    buffer_load_dwordx4 v239, s[24:27], s67 offen lds
    s_add_u32 m0, s76, 0
    s_nop 0
    buffer_load_dwordx4 v187, s[28:31], s67 offen lds
    s_add_u32 s67, s67, 98304
    s_cmp_ge_u32 s67, 1966080
    s_cselect_b32 s67, 0, s67
    s_add_u32 s44, s45, s65
    s_add_u32 m0, s57, 0
    s_nop 0
    buffer_load_dwordx4 v240, s[16:19], s44 offen lds
    s_add_u32 m0, s57, 1024
    s_nop 0
    buffer_load_dwordx4 v241, s[16:19], s44 offen lds
    s_add_u32 s65, s65, 128
    s_cmp_ge_u32 s65, 1280
    s_cselect_b32 s65, 0, s65
    s_add_u32 m0, s75, 12288
    s_nop 0
    buffer_load_dwordx4 v239, s[24:27], s67 offen lds
    s_add_u32 m0, s76, 12288
    s_nop 0
    buffer_load_dwordx4 v187, s[28:31], s67 offen lds
    s_add_u32 s67, s67, 98304
    s_cmp_ge_u32 s67, 1966080
    s_cselect_b32 s67, 0, s67
    s_mov_b32 s32, s14
    s_and_b32 s33, s15, 0xffff
    s_mov_b32 s34, 0x2000000
    s_mov_b32 s35, 0x00020000
    s_mov_b32 s36, s8
    s_and_b32 s37, s9, 0xffff
    s_mov_b32 s38, 0x6400
    s_mov_b32 s39, 0x00020000
    v_lshlrev_b32 v5, 3, v3
    v_bfe_u32 v6, v1, 2, 2
    v_add_u32 v5, v5, v6
    v_mul_u32_u24 v5, 192, v5
    v_bfe_u32 v7, v1, 4, 1
    v_lshl_add_u32 v5, v7, 5, v5
    v_and_b32 v7, 3, v1
    v_lshl_add_u32 v5, v7, 3, v5
    v_add_u32 v236, 32768, v5
    s_lshl_b32 s43, s60, 5
    v_add_u32 v5, s43, v4
    v_lshlrev_b32 v5, 7, v5
    v_add_u32 v5, 81920, v5
    v_bfe_u32 v6, v4, 1, 3
    v_add_u32 v7, 0, v3
    v_xor_b32 v7, v7, v6
    v_lshl_add_u32 v242, v7, 4, v5
    v_add_u32 v7, 2, v3
    v_xor_b32 v7, v7, v6
    v_lshl_add_u32 v243, v7, 4, v5
    v_add_u32 v7, 4, v3
    v_xor_b32 v7, v7, v6
    v_lshl_add_u32 v244, v7, 4, v5
    v_add_u32 v7, 6, v3
    v_xor_b32 v7, v7, v6
    v_lshl_add_u32 v245, v7, 4, v5
    s_lshl_b32 s63, s60, 2
    s_add_u32 s64, s60, 4
    s_min_u32 s64, s64, 5
    s_lshl_b32 s64, s64, 2
    v_mov_b32 v8, 0
    v_mov_b32 v9, 0
    v_mov_b32 v10, 0
    v_mov_b32 v11, 0
    v_subrev_u32 v7, 256, v0
    v_lshlrev_b32 v5, 4, v7
    v_add_u32 v5, 131072, v5
    ds_write_b128 v5, v[8:11] offset:0
    ds_write_b128 v5, v[8:11] offset:4096
    ds_write_b128 v5, v[8:11] offset:8192
    v_cmp_gt_u32 vcc, 192, v7
    s_and_saveexec_b64 s[50:51], vcc
    ds_write_b128 v5, v[8:11] offset:12288
    s_mov_b64 exec, s[50:51]
    v_mov_b32 v5, 148992
    ds_write_b64 v5, v[8:9]
    ds_write_b64 v5, v[8:9] offset:8
    v_lshrrev_b32 v5, 5, v7
    v_lshlrev_b32 v5, 13, v5
    v_lshl_add_u32 v5, v4, 8, v5
    v_and_b32 v6, 3, v4
    v_xor_b32 v6, 3, v6
    v_lshl_add_u32 v5, v6, 6, v5
    v_add_u32 v5, 48, v5
    v_mov_b32 v8, 0x3f80
    v_cmp_gt_u32 vcc, 128, v7
    s_and_saveexec_b64 s[50:51], vcc
    ds_write_b128 v5, v[8:11]
    s_mov_b64 exec, s[50:51]
    v_mov_b32 v246, 0
    v_mov_b32 v247, 0
    v_mov_b32 v248, 0
    v_mov_b32 v249, 0
    v_mov_b32 v250, 0
    v_mov_b32 v251, 0
    s_mov_b32 s52, s58
    s_and_b32 s53, s59, 0xffff
    s_mov_b32 s54, 256
    s_mov_b32 s55, 0x00020000
    s_lshl_b32 s56, s42, 2
    s_add_u32 s56, s56, 128
    s_lshl_b32 s43, s42, 4
    s_mul_i32 s50, s43, 1536
    s_add_u32 s50, s50, 25165824
    s_mul_i32 s51, s41, 1536
    s_add_u32 s51, s51, s50
    s_lshl_b32 s43, s60, 7
    s_add_u32 s51, s51, s43
    s_add_u32 s51, s51, 512
    v_lshlrev_b32 v235, 6, v2
    v_add_u32 v235, v235, v1
    v_min_u32 v235, 319, v235
    v_lshlrev_b32 v235, 2, v235
    s_waitcnt vmcnt(2) lgkmcnt(0)
    s_barrier
    ds_read_b128 v[160:163], v242 offset:0
    ds_read_b64_tr_b16 v[16:17], v236 offset:0
    ds_read_b64_tr_b16 v[18:19], v236 offset:768
    ds_read_b64_tr_b16 v[20:21], v236 offset:6144
    ds_read_b64_tr_b16 v[22:23], v236 offset:6912
    ds_read_b64_tr_b16 v[24:25], v236 offset:64
    ds_read_b64_tr_b16 v[26:27], v236 offset:832
    ds_read_b64_tr_b16 v[28:29], v236 offset:6208
    ds_read_b64_tr_b16 v[30:31], v236 offset:6976
    ds_read_b64_tr_b16 v[32:33], v236 offset:128
    ds_read_b64_tr_b16 v[34:35], v236 offset:896
    ds_read_b64_tr_b16 v[36:37], v236 offset:6272
    ds_read_b64_tr_b16 v[38:39], v236 offset:7040
    s_waitcnt lgkmcnt(0)
    v_mfma_f32_32x32x16_bf16 v[64:79], v[16:19], v[160:163], 0
    ds_read_b128 v[164:167], v243 offset:0
    ds_read_b64_tr_b16 v[40:41], v236 offset:3072
    ds_read_b64_tr_b16 v[42:43], v236 offset:3840
    ds_read_b64_tr_b16 v[44:45], v236 offset:9216
    ds_read_b64_tr_b16 v[46:47], v236 offset:9984
    v_mfma_f32_32x32x16_bf16 v[80:95], v[20:23], v[160:163], 0
    ds_read_b64_tr_b16 v[48:49], v236 offset:3136
    ds_read_b64_tr_b16 v[50:51], v236 offset:3904
    ds_read_b64_tr_b16 v[52:53], v236 offset:9280
    ds_read_b64_tr_b16 v[54:55], v236 offset:10048
    ds_read_b64_tr_b16 v[56:57], v236 offset:3200
    v_mfma_f32_32x32x16_bf16 v[96:111], v[24:27], v[160:163], 0
    ds_read_b64_tr_b16 v[58:59], v236 offset:3968
    ds_read_b64_tr_b16 v[60:61], v236 offset:9344
    ds_read_b64_tr_b16 v[62:63], v236 offset:10112
    s_set_gpr_idx_on s63, 0x2
    v_lshlrev_b32 v252, 16, v16
    v_and_b32 v253, 0xffff0000, v16
    v_lshlrev_b32 v254, 16, v17
    v_and_b32 v255, 0xffff0000, v17
    s_set_gpr_idx_off
    v_pk_add_f32 v[248:249], v[248:249], v[252:253]
    v_pk_add_f32 v[248:249], v[248:249], v[254:255]
    v_mfma_f32_32x32x16_bf16 v[112:127], v[28:31], v[160:163], 0
    s_set_gpr_idx_on s63, 0x2
    v_lshlrev_b32 v252, 16, v18
    v_and_b32 v253, 0xffff0000, v18
    v_lshlrev_b32 v254, 16, v19
    v_and_b32 v255, 0xffff0000, v19
    s_set_gpr_idx_off
    v_pk_add_f32 v[248:249], v[248:249], v[252:253]
    v_pk_add_f32 v[248:249], v[248:249], v[254:255]
    v_mfma_f32_32x32x16_bf16 v[128:143], v[32:35], v[160:163], 0
    s_set_gpr_idx_on s64, 0x2
    v_lshlrev_b32 v252, 16, v16
    v_and_b32 v253, 0xffff0000, v16
    v_lshlrev_b32 v254, 16, v17
    v_and_b32 v255, 0xffff0000, v17
    s_set_gpr_idx_off
    v_pk_add_f32 v[250:251], v[250:251], v[252:253]
    v_pk_add_f32 v[250:251], v[250:251], v[254:255]
    v_mfma_f32_32x32x16_bf16 v[144:159], v[36:39], v[160:163], 0
    s_set_gpr_idx_on s64, 0x2
    v_lshlrev_b32 v252, 16, v18
    v_and_b32 v253, 0xffff0000, v18
    v_lshlrev_b32 v254, 16, v19
    v_and_b32 v255, 0xffff0000, v19
    s_set_gpr_idx_off
    v_pk_add_f32 v[250:251], v[250:251], v[252:253]
    v_pk_add_f32 v[250:251], v[250:251], v[254:255]
    s_add_u32 s44, s45, s65
    s_add_u32 m0, s57, 16384
    s_nop 0
    buffer_load_dwordx4 v240, s[16:19], s44 offen lds
    s_add_u32 m0, s57, 17408
    s_nop 0
    buffer_load_dwordx4 v241, s[16:19], s44 offen lds
    s_add_u32 s65, s65, 128
    s_cmp_ge_u32 s65, 1280
    s_cselect_b32 s65, 0, s65
    s_add_u32 m0, s75, 24576
    s_nop 0
    buffer_load_dwordx4 v239, s[24:27], s67 offen lds
    s_add_u32 m0, s76, 24576
    s_nop 0
    buffer_load_dwordx4 v187, s[28:31], s67 offen lds
    s_add_u32 s67, s67, 98304
    s_cmp_ge_u32 s67, 1966080
    s_cselect_b32 s67, 0, s67
    s_waitcnt lgkmcnt(0)
    v_mfma_f32_32x32x16_bf16 v[64:79], v[40:43], v[164:167], v[64:79]
    s_waitcnt vmcnt(4)
    s_barrier
    v_mfma_f32_32x32x16_bf16 v[80:95], v[44:47], v[164:167], v[80:95]
    ds_read_b128 v[160:163], v244 offset:0
    ds_read_b64_tr_b16 v[16:17], v236 offset:12288
    ds_read_b64_tr_b16 v[18:19], v236 offset:13056
    ds_read_b64_tr_b16 v[20:21], v236 offset:18432
    ds_read_b64_tr_b16 v[22:23], v236 offset:19200
    v_mfma_f32_32x32x16_bf16 v[96:111], v[48:51], v[164:167], v[96:111]
    ds_read_b64_tr_b16 v[24:25], v236 offset:12352
    ds_read_b64_tr_b16 v[26:27], v236 offset:13120
    ds_read_b64_tr_b16 v[28:29], v236 offset:18496
    ds_read_b64_tr_b16 v[30:31], v236 offset:19264
    ds_read_b64_tr_b16 v[32:33], v236 offset:12416
    s_set_gpr_idx_on s63, 0x2
    v_lshlrev_b32 v252, 16, v40
    v_and_b32 v253, 0xffff0000, v40
    v_lshlrev_b32 v254, 16, v41
    v_and_b32 v255, 0xffff0000, v41
    s_set_gpr_idx_off
    v_pk_add_f32 v[248:249], v[248:249], v[252:253]
    v_pk_add_f32 v[248:249], v[248:249], v[254:255]
    v_mfma_f32_32x32x16_bf16 v[112:127], v[52:55], v[164:167], v[112:127]
    ds_read_b64_tr_b16 v[34:35], v236 offset:13184
    ds_read_b64_tr_b16 v[36:37], v236 offset:18560
    ds_read_b64_tr_b16 v[38:39], v236 offset:19328
    s_set_gpr_idx_on s63, 0x2
    v_lshlrev_b32 v252, 16, v42
    v_and_b32 v253, 0xffff0000, v42
    v_lshlrev_b32 v254, 16, v43
    v_and_b32 v255, 0xffff0000, v43
    s_set_gpr_idx_off
    v_pk_add_f32 v[248:249], v[248:249], v[252:253]
    v_pk_add_f32 v[248:249], v[248:249], v[254:255]
    v_mfma_f32_32x32x16_bf16 v[128:143], v[56:59], v[164:167], v[128:143]
    s_set_gpr_idx_on s64, 0x2
    v_lshlrev_b32 v252, 16, v40
    v_and_b32 v253, 0xffff0000, v40
    v_lshlrev_b32 v254, 16, v41
    v_and_b32 v255, 0xffff0000, v41
    s_set_gpr_idx_off
    v_pk_add_f32 v[250:251], v[250:251], v[252:253]
    v_pk_add_f32 v[250:251], v[250:251], v[254:255]
    v_mfma_f32_32x32x16_bf16 v[144:159], v[60:63], v[164:167], v[144:159]
    s_set_gpr_idx_on s64, 0x2
    v_lshlrev_b32 v252, 16, v42
    v_and_b32 v253, 0xffff0000, v42
    v_lshlrev_b32 v254, 16, v43
    v_and_b32 v255, 0xffff0000, v43
    s_set_gpr_idx_off
    v_pk_add_f32 v[250:251], v[250:251], v[252:253]
    v_pk_add_f32 v[250:251], v[250:251], v[254:255]
    s_add_u32 m0, s75, 36864
    s_nop 0
    buffer_load_dwordx4 v239, s[24:27], s67 offen lds
    s_add_u32 m0, s76, 36864
    s_nop 0
    buffer_load_dwordx4 v187, s[28:31], s67 offen lds
    s_add_u32 s67, s67, 98304
    s_cmp_ge_u32 s67, 1966080
    s_cselect_b32 s67, 0, s67
    s_add_u32 m0, s75, 0
    s_nop 0
    buffer_load_dwordx4 v239, s[24:27], s67 offen lds
    s_add_u32 m0, s76, 0
    s_nop 0
    buffer_load_dwordx4 v187, s[28:31], s67 offen lds
    s_add_u32 s67, s67, 98304
    s_cmp_ge_u32 s67, 1966080
    s_cselect_b32 s67, 0, s67
    s_waitcnt lgkmcnt(0)
    v_mfma_f32_32x32x16_bf16 v[64:79], v[16:19], v[160:163], v[64:79]
    ds_read_b128 v[164:167], v245 offset:0
    ds_read_b64_tr_b16 v[40:41], v236 offset:15360
    ds_read_b64_tr_b16 v[42:43], v236 offset:16128
    ds_read_b64_tr_b16 v[44:45], v236 offset:21504
    ds_read_b64_tr_b16 v[46:47], v236 offset:22272
    v_mfma_f32_32x32x16_bf16 v[80:95], v[20:23], v[160:163], v[80:95]
    ds_read_b64_tr_b16 v[48:49], v236 offset:15424
    ds_read_b64_tr_b16 v[50:51], v236 offset:16192
    ds_read_b64_tr_b16 v[52:53], v236 offset:21568
    ds_read_b64_tr_b16 v[54:55], v236 offset:22336
    ds_read_b64_tr_b16 v[56:57], v236 offset:15488
    v_mfma_f32_32x32x16_bf16 v[96:111], v[24:27], v[160:163], v[96:111]
    ds_read_b64_tr_b16 v[58:59], v236 offset:16256
    ds_read_b64_tr_b16 v[60:61], v236 offset:21632
    ds_read_b64_tr_b16 v[62:63], v236 offset:22400
    s_set_gpr_idx_on s63, 0x2
    v_lshlrev_b32 v252, 16, v16
    v_and_b32 v253, 0xffff0000, v16
    v_lshlrev_b32 v254, 16, v17
    v_and_b32 v255, 0xffff0000, v17
    s_set_gpr_idx_off
    v_pk_add_f32 v[248:249], v[248:249], v[252:253]
    v_pk_add_f32 v[248:249], v[248:249], v[254:255]
    v_mfma_f32_32x32x16_bf16 v[112:127], v[28:31], v[160:163], v[112:127]
    s_set_gpr_idx_on s63, 0x2
    v_lshlrev_b32 v252, 16, v18
    v_and_b32 v253, 0xffff0000, v18
    v_lshlrev_b32 v254, 16, v19
    v_and_b32 v255, 0xffff0000, v19
    s_set_gpr_idx_off
    v_pk_add_f32 v[248:249], v[248:249], v[252:253]
    v_pk_add_f32 v[248:249], v[248:249], v[254:255]
    v_mfma_f32_32x32x16_bf16 v[128:143], v[32:35], v[160:163], v[128:143]
    s_set_gpr_idx_on s64, 0x2
    v_lshlrev_b32 v252, 16, v16
    v_and_b32 v253, 0xffff0000, v16
    v_lshlrev_b32 v254, 16, v17
    v_and_b32 v255, 0xffff0000, v17
    s_set_gpr_idx_off
    v_pk_add_f32 v[250:251], v[250:251], v[252:253]
    v_pk_add_f32 v[250:251], v[250:251], v[254:255]
    v_mfma_f32_32x32x16_bf16 v[144:159], v[36:39], v[160:163], v[144:159]
    s_set_gpr_idx_on s64, 0x2
    v_lshlrev_b32 v252, 16, v18
    v_and_b32 v253, 0xffff0000, v18
    v_lshlrev_b32 v254, 16, v19
    v_and_b32 v255, 0xffff0000, v19
    s_set_gpr_idx_off
    v_pk_add_f32 v[250:251], v[250:251], v[252:253]
    v_pk_add_f32 v[250:251], v[250:251], v[254:255]
    s_add_u32 s44, s45, s65
    s_add_u32 m0, s57, 32768
    s_nop 0
    buffer_load_dwordx4 v240, s[16:19], s44 offen lds
    s_add_u32 m0, s57, 33792
    s_nop 0
    buffer_load_dwordx4 v241, s[16:19], s44 offen lds
    s_add_u32 s65, s65, 128
    s_cmp_ge_u32 s65, 1280
    s_cselect_b32 s65, 0, s65
    s_waitcnt lgkmcnt(0)
    v_mfma_f32_32x32x16_bf16 v[64:79], v[40:43], v[164:167], v[64:79]
    s_waitcnt vmcnt(6)
    s_barrier
    v_mfma_f32_32x32x16_bf16 v[80:95], v[44:47], v[164:167], v[80:95]
    ds_read_b128 v[160:163], v242 offset:16384
    ds_read_b64_tr_b16 v[16:17], v236 offset:24576
    ds_read_b64_tr_b16 v[18:19], v236 offset:25344
    ds_read_b64_tr_b16 v[20:21], v236 offset:30720
    ds_read_b64_tr_b16 v[22:23], v236 offset:31488
    v_mfma_f32_32x32x16_bf16 v[96:111], v[48:51], v[164:167], v[96:111]
    ds_read_b64_tr_b16 v[24:25], v236 offset:24640
    ds_read_b64_tr_b16 v[26:27], v236 offset:25408
    ds_read_b64_tr_b16 v[28:29], v236 offset:30784
    ds_read_b64_tr_b16 v[30:31], v236 offset:31552
    ds_read_b64_tr_b16 v[32:33], v236 offset:24704
    s_set_gpr_idx_on s63, 0x2
    v_lshlrev_b32 v252, 16, v40
    v_and_b32 v253, 0xffff0000, v40
    v_lshlrev_b32 v254, 16, v41
    v_and_b32 v255, 0xffff0000, v41
    s_set_gpr_idx_off
    v_pk_add_f32 v[248:249], v[248:249], v[252:253]
    v_pk_add_f32 v[248:249], v[248:249], v[254:255]
    v_mfma_f32_32x32x16_bf16 v[112:127], v[52:55], v[164:167], v[112:127]
    ds_read_b64_tr_b16 v[34:35], v236 offset:25472
    ds_read_b64_tr_b16 v[36:37], v236 offset:30848
    ds_read_b64_tr_b16 v[38:39], v236 offset:31616
    s_set_gpr_idx_on s63, 0x2
    v_lshlrev_b32 v252, 16, v42
    v_and_b32 v253, 0xffff0000, v42
    v_lshlrev_b32 v254, 16, v43
    v_and_b32 v255, 0xffff0000, v43
    s_set_gpr_idx_off
    v_pk_add_f32 v[248:249], v[248:249], v[252:253]
    v_pk_add_f32 v[248:249], v[248:249], v[254:255]
    v_mfma_f32_32x32x16_bf16 v[128:143], v[56:59], v[164:167], v[128:143]
    s_set_gpr_idx_on s64, 0x2
    v_lshlrev_b32 v252, 16, v40
    v_and_b32 v253, 0xffff0000, v40
    v_lshlrev_b32 v254, 16, v41
    v_and_b32 v255, 0xffff0000, v41
    s_set_gpr_idx_off
    v_pk_add_f32 v[250:251], v[250:251], v[252:253]
    v_pk_add_f32 v[250:251], v[250:251], v[254:255]
    v_mfma_f32_32x32x16_bf16 v[144:159], v[60:63], v[164:167], v[144:159]
    s_set_gpr_idx_on s64, 0x2
    v_lshlrev_b32 v252, 16, v42
    v_and_b32 v253, 0xffff0000, v42
    v_lshlrev_b32 v254, 16, v43
    v_and_b32 v255, 0xffff0000, v43
    s_set_gpr_idx_off
    v_pk_add_f32 v[250:251], v[250:251], v[252:253]
    v_pk_add_f32 v[250:251], v[250:251], v[254:255]
    s_add_u32 m0, s75, 12288
    s_nop 0
    buffer_load_dwordx4 v239, s[24:27], s67 offen lds
    s_add_u32 m0, s76, 12288
    s_nop 0
    buffer_load_dwordx4 v187, s[28:31], s67 offen lds
    s_add_u32 s67, s67, 98304
    s_cmp_ge_u32 s67, 1966080
    s_cselect_b32 s67, 0, s67
    s_add_u32 s44, s45, s65
    s_add_u32 m0, s57, 0
    s_nop 0
    buffer_load_dwordx4 v240, s[16:19], s44 offen lds
    s_add_u32 m0, s57, 1024
    s_nop 0
    buffer_load_dwordx4 v241, s[16:19], s44 offen lds
    s_add_u32 s65, s65, 128
    s_cmp_ge_u32 s65, 1280
    s_cselect_b32 s65, 0, s65
    s_waitcnt lgkmcnt(0)
    v_mfma_f32_32x32x16_bf16 v[64:79], v[16:19], v[160:163], v[64:79]
    ds_read_b128 v[164:167], v243 offset:16384
    ds_read_b64_tr_b16 v[40:41], v236 offset:27648
    ds_read_b64_tr_b16 v[42:43], v236 offset:28416
    ds_read_b64_tr_b16 v[44:45], v236 offset:33792
    ds_read_b64_tr_b16 v[46:47], v236 offset:34560
    v_add_f32 v248, v248, v249
    v_mov_b32 v249, v248
    s_nop 1
    v_permlane32_swap_b32 v249, v248
    s_nop 1
    v_add_f32 v248, v248, v249
    v_lshlrev_b32 v252, 2, v4
    buffer_store_dword v248, v252, s[32:35], s51 offen offset:0 sc1
    v_add_f32 v250, v250, v251
    v_mov_b32 v251, v250
    s_nop 1
    v_permlane32_swap_b32 v251, v250
    s_nop 1
    v_add_f32 v250, v250, v251
    v_lshlrev_b32 v252, 2, v4
    buffer_store_dword v250, v252, s[32:35], s51 offen offset:512 sc1
    v_mfma_f32_32x32x16_bf16 v[80:95], v[20:23], v[160:163], v[80:95]
    ds_read_b64_tr_b16 v[48:49], v236 offset:27712
    ds_read_b64_tr_b16 v[50:51], v236 offset:28480
    ds_read_b64_tr_b16 v[52:53], v236 offset:33856
    ds_read_b64_tr_b16 v[54:55], v236 offset:34624
    ds_read_b64_tr_b16 v[56:57], v236 offset:27776
    v_mfma_f32_32x32x16_bf16 v[96:111], v[24:27], v[160:163], v[96:111]
    ds_read_b64_tr_b16 v[58:59], v236 offset:28544
    ds_read_b64_tr_b16 v[60:61], v236 offset:33920
    ds_read_b64_tr_b16 v[62:63], v236 offset:34688
    v_mfma_f32_32x32x16_bf16 v[112:127], v[28:31], v[160:163], v[112:127]
    v_mfma_f32_32x32x16_bf16 v[128:143], v[32:35], v[160:163], v[128:143]
    v_mfma_f32_32x32x16_bf16 v[144:159], v[36:39], v[160:163], v[144:159]
    s_waitcnt lgkmcnt(0)
    v_mfma_f32_32x32x16_bf16 v[64:79], v[40:43], v[164:167], v[64:79]
    s_waitcnt vmcnt(10)
    s_barrier
    v_mfma_f32_32x32x16_bf16 v[80:95], v[44:47], v[164:167], v[80:95]
    ds_read_b128 v[160:163], v244 offset:16384
    ds_read_b64_tr_b16 v[16:17], v236 offset:36864
    ds_read_b64_tr_b16 v[18:19], v236 offset:37632
    ds_read_b64_tr_b16 v[20:21], v236 offset:43008
    ds_read_b64_tr_b16 v[22:23], v236 offset:43776
    v_mfma_f32_32x32x16_bf16 v[96:111], v[48:51], v[164:167], v[96:111]
    ds_read_b64_tr_b16 v[24:25], v236 offset:36928
    ds_read_b64_tr_b16 v[26:27], v236 offset:37696
    ds_read_b64_tr_b16 v[28:29], v236 offset:43072
    ds_read_b64_tr_b16 v[30:31], v236 offset:43840
    ds_read_b64_tr_b16 v[32:33], v236 offset:36992
    v_mfma_f32_32x32x16_bf16 v[112:127], v[52:55], v[164:167], v[112:127]
    ds_read_b64_tr_b16 v[34:35], v236 offset:37760
    ds_read_b64_tr_b16 v[36:37], v236 offset:43136
    ds_read_b64_tr_b16 v[38:39], v236 offset:43904
    v_mfma_f32_32x32x16_bf16 v[128:143], v[56:59], v[164:167], v[128:143]
    v_mfma_f32_32x32x16_bf16 v[144:159], v[60:63], v[164:167], v[144:159]
    s_add_u32 m0, s75, 24576
    s_nop 0
    buffer_load_dwordx4 v239, s[24:27], s67 offen lds
    s_add_u32 m0, s76, 24576
    s_nop 0
    buffer_load_dwordx4 v187, s[28:31], s67 offen lds
    s_add_u32 s67, s67, 98304
    s_cmp_ge_u32 s67, 1966080
    s_cselect_b32 s67, 0, s67
    s_waitcnt lgkmcnt(0)
    v_mfma_f32_32x32x16_bf16 v[64:79], v[16:19], v[160:163], v[64:79]
    ds_read_b128 v[164:167], v245 offset:16384
    ds_read_b64_tr_b16 v[40:41], v236 offset:39936
    ds_read_b64_tr_b16 v[42:43], v236 offset:40704
    ds_read_b64_tr_b16 v[44:45], v236 offset:46080
    ds_read_b64_tr_b16 v[46:47], v236 offset:46848
    v_mfma_f32_32x32x16_bf16 v[80:95], v[20:23], v[160:163], v[80:95]
    ds_read_b64_tr_b16 v[48:49], v236 offset:40000
    ds_read_b64_tr_b16 v[50:51], v236 offset:40768
    ds_read_b64_tr_b16 v[52:53], v236 offset:46144
    ds_read_b64_tr_b16 v[54:55], v236 offset:46912
    ds_read_b64_tr_b16 v[56:57], v236 offset:40064
    v_mfma_f32_32x32x16_bf16 v[96:111], v[24:27], v[160:163], v[96:111]
    ds_read_b64_tr_b16 v[58:59], v236 offset:40832
    ds_read_b64_tr_b16 v[60:61], v236 offset:46208
    ds_read_b64_tr_b16 v[62:63], v236 offset:46976
    v_mfma_f32_32x32x16_bf16 v[112:127], v[28:31], v[160:163], v[112:127]
    v_mfma_f32_32x32x16_bf16 v[128:143], v[32:35], v[160:163], v[128:143]
    v_mfma_f32_32x32x16_bf16 v[144:159], v[36:39], v[160:163], v[144:159]
    s_waitcnt lgkmcnt(0)
    v_mfma_f32_32x32x16_bf16 v[64:79], v[40:43], v[164:167], v[64:79]
    s_waitcnt vmcnt(8)
    s_barrier
    v_mfma_f32_32x32x16_bf16 v[80:95], v[44:47], v[164:167], v[80:95]
    ds_read_b128 v[160:163], v242 offset:32768
    ds_read_b64_tr_b16 v[16:17], v236 offset:0
    ds_read_b64_tr_b16 v[18:19], v236 offset:768
    ds_read_b64_tr_b16 v[20:21], v236 offset:6144
    ds_read_b64_tr_b16 v[22:23], v236 offset:6912
    v_mfma_f32_32x32x16_bf16 v[96:111], v[48:51], v[164:167], v[96:111]
    ds_read_b64_tr_b16 v[24:25], v236 offset:64
    ds_read_b64_tr_b16 v[26:27], v236 offset:832
    ds_read_b64_tr_b16 v[28:29], v236 offset:6208
    ds_read_b64_tr_b16 v[30:31], v236 offset:6976
    ds_read_b64_tr_b16 v[32:33], v236 offset:128
    v_mfma_f32_32x32x16_bf16 v[112:127], v[52:55], v[164:167], v[112:127]
    ds_read_b64_tr_b16 v[34:35], v236 offset:896
    ds_read_b64_tr_b16 v[36:37], v236 offset:6272
    ds_read_b64_tr_b16 v[38:39], v236 offset:7040
    v_mfma_f32_32x32x16_bf16 v[128:143], v[56:59], v[164:167], v[128:143]
    v_mfma_f32_32x32x16_bf16 v[144:159], v[60:63], v[164:167], v[144:159]
    s_add_u32 m0, s75, 36864
    s_nop 0
    buffer_load_dwordx4 v239, s[24:27], s67 offen lds
    s_add_u32 m0, s76, 36864
    s_nop 0
    buffer_load_dwordx4 v187, s[28:31], s67 offen lds
    s_add_u32 s67, s67, 98304
    s_cmp_ge_u32 s67, 1966080
    s_cselect_b32 s67, 0, s67
    s_add_u32 s44, s45, s65
    s_add_u32 m0, s57, 16384
    s_nop 0
    buffer_load_dwordx4 v240, s[16:19], s44 offen lds
    s_add_u32 m0, s57, 17408
    s_nop 0
    buffer_load_dwordx4 v241, s[16:19], s44 offen lds
    s_add_u32 s65, s65, 128
    s_cmp_ge_u32 s65, 1280
    s_cselect_b32 s65, 0, s65
    s_waitcnt lgkmcnt(0)
    v_mfma_f32_32x32x16_bf16 v[64:79], v[16:19], v[160:163], v[64:79]
    ds_read_b128 v[164:167], v243 offset:32768
    ds_read_b64_tr_b16 v[40:41], v236 offset:3072
    ds_read_b64_tr_b16 v[42:43], v236 offset:3840
    ds_read_b64_tr_b16 v[44:45], v236 offset:9216
    ds_read_b64_tr_b16 v[46:47], v236 offset:9984
    v_mfma_f32_32x32x16_bf16 v[80:95], v[20:23], v[160:163], v[80:95]
    ds_read_b64_tr_b16 v[48:49], v236 offset:3136
    ds_read_b64_tr_b16 v[50:51], v236 offset:3904
    ds_read_b64_tr_b16 v[52:53], v236 offset:9280
    ds_read_b64_tr_b16 v[54:55], v236 offset:10048
    ds_read_b64_tr_b16 v[56:57], v236 offset:3200
    v_mfma_f32_32x32x16_bf16 v[96:111], v[24:27], v[160:163], v[96:111]
    ds_read_b64_tr_b16 v[58:59], v236 offset:3968
    ds_read_b64_tr_b16 v[60:61], v236 offset:9344
    ds_read_b64_tr_b16 v[62:63], v236 offset:10112
    v_mfma_f32_32x32x16_bf16 v[112:127], v[28:31], v[160:163], v[112:127]
    v_mfma_f32_32x32x16_bf16 v[128:143], v[32:35], v[160:163], v[128:143]
    v_mfma_f32_32x32x16_bf16 v[144:159], v[36:39], v[160:163], v[144:159]
    s_waitcnt lgkmcnt(0)
    v_mfma_f32_32x32x16_bf16 v[64:79], v[40:43], v[164:167], v[64:79]
    s_waitcnt vmcnt(6)
    s_barrier
    v_mfma_f32_32x32x16_bf16 v[80:95], v[44:47], v[164:167], v[80:95]
    ds_read_b128 v[160:163], v244 offset:32768
    ds_read_b64_tr_b16 v[16:17], v236 offset:12288
    ds_read_b64_tr_b16 v[18:19], v236 offset:13056
    ds_read_b64_tr_b16 v[20:21], v236 offset:18432
    ds_read_b64_tr_b16 v[22:23], v236 offset:19200
    v_mfma_f32_32x32x16_bf16 v[96:111], v[48:51], v[164:167], v[96:111]
    ds_read_b64_tr_b16 v[24:25], v236 offset:12352
    ds_read_b64_tr_b16 v[26:27], v236 offset:13120
    ds_read_b64_tr_b16 v[28:29], v236 offset:18496
    ds_read_b64_tr_b16 v[30:31], v236 offset:19264
    ds_read_b64_tr_b16 v[32:33], v236 offset:12416
    v_mfma_f32_32x32x16_bf16 v[112:127], v[52:55], v[164:167], v[112:127]
    ds_read_b64_tr_b16 v[34:35], v236 offset:13184
    ds_read_b64_tr_b16 v[36:37], v236 offset:18560
    ds_read_b64_tr_b16 v[38:39], v236 offset:19328
    v_mfma_f32_32x32x16_bf16 v[128:143], v[56:59], v[164:167], v[128:143]
    v_mfma_f32_32x32x16_bf16 v[144:159], v[60:63], v[164:167], v[144:159]
    s_add_u32 m0, s75, 0
    s_nop 0
    buffer_load_dwordx4 v239, s[24:27], s67 offen lds
    s_add_u32 m0, s76, 0
    s_nop 0
    buffer_load_dwordx4 v187, s[28:31], s67 offen lds
    s_add_u32 s67, s67, 98304
    s_cmp_ge_u32 s67, 1966080
    s_cselect_b32 s67, 0, s67
    s_waitcnt lgkmcnt(0)
    v_mfma_f32_32x32x16_bf16 v[64:79], v[16:19], v[160:163], v[64:79]
    ds_read_b128 v[164:167], v245 offset:32768
    ds_read_b64_tr_b16 v[40:41], v236 offset:15360
    ds_read_b64_tr_b16 v[42:43], v236 offset:16128
    ds_read_b64_tr_b16 v[44:45], v236 offset:21504
    ds_read_b64_tr_b16 v[46:47], v236 offset:22272
    v_mfma_f32_32x32x16_bf16 v[80:95], v[20:23], v[160:163], v[80:95]
    ds_read_b64_tr_b16 v[48:49], v236 offset:15424
    ds_read_b64_tr_b16 v[50:51], v236 offset:16192
    ds_read_b64_tr_b16 v[52:53], v236 offset:21568
    ds_read_b64_tr_b16 v[54:55], v236 offset:22336
    ds_read_b64_tr_b16 v[56:57], v236 offset:15488
    v_mfma_f32_32x32x16_bf16 v[96:111], v[24:27], v[160:163], v[96:111]
    ds_read_b64_tr_b16 v[58:59], v236 offset:16256
    ds_read_b64_tr_b16 v[60:61], v236 offset:21632
    ds_read_b64_tr_b16 v[62:63], v236 offset:22400
    v_mfma_f32_32x32x16_bf16 v[112:127], v[28:31], v[160:163], v[112:127]
    v_mfma_f32_32x32x16_bf16 v[128:143], v[32:35], v[160:163], v[128:143]
    v_mfma_f32_32x32x16_bf16 v[144:159], v[36:39], v[160:163], v[144:159]
    s_waitcnt lgkmcnt(0)
    v_mfma_f32_32x32x16_bf16 v[64:79], v[40:43], v[164:167], v[64:79]
    s_waitcnt vmcnt(6)
    s_barrier
    v_mfma_f32_32x32x16_bf16 v[80:95], v[44:47], v[164:167], v[80:95]
    ds_read_b128 v[160:163], v242 offset:0
    ds_read_b64_tr_b16 v[16:17], v236 offset:24576
    ds_read_b64_tr_b16 v[18:19], v236 offset:25344
    ds_read_b64_tr_b16 v[20:21], v236 offset:30720
    ds_read_b64_tr_b16 v[22:23], v236 offset:31488
    v_mfma_f32_32x32x16_bf16 v[96:111], v[48:51], v[164:167], v[96:111]
    ds_read_b64_tr_b16 v[24:25], v236 offset:24640
    ds_read_b64_tr_b16 v[26:27], v236 offset:25408
    ds_read_b64_tr_b16 v[28:29], v236 offset:30784
    ds_read_b64_tr_b16 v[30:31], v236 offset:31552
    ds_read_b64_tr_b16 v[32:33], v236 offset:24704
    v_mfma_f32_32x32x16_bf16 v[112:127], v[52:55], v[164:167], v[112:127]
    ds_read_b64_tr_b16 v[34:35], v236 offset:25472
    ds_read_b64_tr_b16 v[36:37], v236 offset:30848
    ds_read_b64_tr_b16 v[38:39], v236 offset:31616
    v_mfma_f32_32x32x16_bf16 v[128:143], v[56:59], v[164:167], v[128:143]
    v_mfma_f32_32x32x16_bf16 v[144:159], v[60:63], v[164:167], v[144:159]
    s_add_u32 m0, s75, 12288
    s_nop 0
    buffer_load_dwordx4 v239, s[24:27], s67 offen lds
    s_add_u32 m0, s76, 12288
    s_nop 0
    buffer_load_dwordx4 v187, s[28:31], s67 offen lds
    s_add_u32 s67, s67, 98304
    s_cmp_ge_u32 s67, 1966080
    s_cselect_b32 s67, 0, s67
    s_add_u32 s44, s45, s65
    s_add_u32 m0, s57, 32768
    s_nop 0
    buffer_load_dwordx4 v240, s[16:19], s44 offen lds
    s_add_u32 m0, s57, 33792
    s_nop 0
    buffer_load_dwordx4 v241, s[16:19], s44 offen lds
    s_add_u32 s65, s65, 128
    s_cmp_ge_u32 s65, 1280
    s_cselect_b32 s65, 0, s65
    s_waitcnt lgkmcnt(0)
    v_mfma_f32_32x32x16_bf16 v[64:79], v[16:19], v[160:163], v[64:79]
    ds_read_b128 v[164:167], v243 offset:0
    ds_read_b64_tr_b16 v[40:41], v236 offset:27648
    ds_read_b64_tr_b16 v[42:43], v236 offset:28416
    ds_read_b64_tr_b16 v[44:45], v236 offset:33792
    ds_read_b64_tr_b16 v[46:47], v236 offset:34560
    v_mfma_f32_32x32x16_bf16 v[80:95], v[20:23], v[160:163], v[80:95]
    ds_read_b64_tr_b16 v[48:49], v236 offset:27712
    ds_read_b64_tr_b16 v[50:51], v236 offset:28480
    ds_read_b64_tr_b16 v[52:53], v236 offset:33856
    ds_read_b64_tr_b16 v[54:55], v236 offset:34624
    ds_read_b64_tr_b16 v[56:57], v236 offset:27776
    v_mfma_f32_32x32x16_bf16 v[96:111], v[24:27], v[160:163], v[96:111]
    ds_read_b64_tr_b16 v[58:59], v236 offset:28544
    ds_read_b64_tr_b16 v[60:61], v236 offset:33920
    ds_read_b64_tr_b16 v[62:63], v236 offset:34688
    v_mfma_f32_32x32x16_bf16 v[112:127], v[28:31], v[160:163], v[112:127]
    v_mfma_f32_32x32x16_bf16 v[128:143], v[32:35], v[160:163], v[128:143]
    v_mfma_f32_32x32x16_bf16 v[144:159], v[36:39], v[160:163], v[144:159]
    s_waitcnt lgkmcnt(0)
    v_mfma_f32_32x32x16_bf16 v[64:79], v[40:43], v[164:167], v[64:79]
    s_waitcnt vmcnt(8)
    s_barrier
    v_mfma_f32_32x32x16_bf16 v[80:95], v[44:47], v[164:167], v[80:95]
    ds_read_b128 v[160:163], v244 offset:0
    ds_read_b64_tr_b16 v[16:17], v236 offset:36864
    ds_read_b64_tr_b16 v[18:19], v236 offset:37632
    ds_read_b64_tr_b16 v[20:21], v236 offset:43008
    ds_read_b64_tr_b16 v[22:23], v236 offset:43776
    v_mfma_f32_32x32x16_bf16 v[96:111], v[48:51], v[164:167], v[96:111]
    ds_read_b64_tr_b16 v[24:25], v236 offset:36928
    ds_read_b64_tr_b16 v[26:27], v236 offset:37696
    ds_read_b64_tr_b16 v[28:29], v236 offset:43072
    ds_read_b64_tr_b16 v[30:31], v236 offset:43840
    ds_read_b64_tr_b16 v[32:33], v236 offset:36992
    v_mfma_f32_32x32x16_bf16 v[112:127], v[52:55], v[164:167], v[112:127]
    ds_read_b64_tr_b16 v[34:35], v236 offset:37760
    ds_read_b64_tr_b16 v[36:37], v236 offset:43136
    ds_read_b64_tr_b16 v[38:39], v236 offset:43904
    v_mfma_f32_32x32x16_bf16 v[128:143], v[56:59], v[164:167], v[128:143]
    v_mfma_f32_32x32x16_bf16 v[144:159], v[60:63], v[164:167], v[144:159]
    s_add_u32 m0, s75, 24576
    s_nop 0
    buffer_load_dwordx4 v239, s[24:27], s67 offen lds
    s_add_u32 m0, s76, 24576
    s_nop 0
    buffer_load_dwordx4 v187, s[28:31], s67 offen lds
    s_add_u32 s67, s67, 98304
    s_cmp_ge_u32 s67, 1966080
    s_cselect_b32 s67, 0, s67
    s_waitcnt lgkmcnt(0)
    v_mfma_f32_32x32x16_bf16 v[64:79], v[16:19], v[160:163], v[64:79]
    ds_read_b128 v[164:167], v245 offset:0
    ds_read_b64_tr_b16 v[40:41], v236 offset:39936
    ds_read_b64_tr_b16 v[42:43], v236 offset:40704
    ds_read_b64_tr_b16 v[44:45], v236 offset:46080
    ds_read_b64_tr_b16 v[46:47], v236 offset:46848
    v_mfma_f32_32x32x16_bf16 v[80:95], v[20:23], v[160:163], v[80:95]
    ds_read_b64_tr_b16 v[48:49], v236 offset:40000
    ds_read_b64_tr_b16 v[50:51], v236 offset:40768
    ds_read_b64_tr_b16 v[52:53], v236 offset:46144
    ds_read_b64_tr_b16 v[54:55], v236 offset:46912
    ds_read_b64_tr_b16 v[56:57], v236 offset:40064
    v_mfma_f32_32x32x16_bf16 v[96:111], v[24:27], v[160:163], v[96:111]
    ds_read_b64_tr_b16 v[58:59], v236 offset:40832
    ds_read_b64_tr_b16 v[60:61], v236 offset:46208
    ds_read_b64_tr_b16 v[62:63], v236 offset:46976
    v_mfma_f32_32x32x16_bf16 v[112:127], v[28:31], v[160:163], v[112:127]
    v_mfma_f32_32x32x16_bf16 v[128:143], v[32:35], v[160:163], v[128:143]
    v_mfma_f32_32x32x16_bf16 v[144:159], v[36:39], v[160:163], v[144:159]
    s_waitcnt lgkmcnt(0)
    v_mfma_f32_32x32x16_bf16 v[64:79], v[40:43], v[164:167], v[64:79]
    s_waitcnt vmcnt(6)
    s_barrier
    v_mfma_f32_32x32x16_bf16 v[80:95], v[44:47], v[164:167], v[80:95]
    ds_read_b128 v[160:163], v242 offset:16384
    ds_read_b64_tr_b16 v[16:17], v236 offset:0
    ds_read_b64_tr_b16 v[18:19], v236 offset:768
    ds_read_b64_tr_b16 v[20:21], v236 offset:6144
    ds_read_b64_tr_b16 v[22:23], v236 offset:6912
    v_mfma_f32_32x32x16_bf16 v[96:111], v[48:51], v[164:167], v[96:111]
    ds_read_b64_tr_b16 v[24:25], v236 offset:64
    ds_read_b64_tr_b16 v[26:27], v236 offset:832
    ds_read_b64_tr_b16 v[28:29], v236 offset:6208
    ds_read_b64_tr_b16 v[30:31], v236 offset:6976
    ds_read_b64_tr_b16 v[32:33], v236 offset:128
    v_mfma_f32_32x32x16_bf16 v[112:127], v[52:55], v[164:167], v[112:127]
    ds_read_b64_tr_b16 v[34:35], v236 offset:896
    ds_read_b64_tr_b16 v[36:37], v236 offset:6272
    ds_read_b64_tr_b16 v[38:39], v236 offset:7040
    v_mfma_f32_32x32x16_bf16 v[128:143], v[56:59], v[164:167], v[128:143]
    v_mfma_f32_32x32x16_bf16 v[144:159], v[60:63], v[164:167], v[144:159]
    s_add_u32 m0, s75, 36864
    s_nop 0
    buffer_load_dwordx4 v239, s[24:27], s67 offen lds
    s_add_u32 m0, s76, 36864
    s_nop 0
    buffer_load_dwordx4 v187, s[28:31], s67 offen lds
    s_add_u32 s67, s67, 98304
    s_cmp_ge_u32 s67, 1966080
    s_cselect_b32 s67, 0, s67
    s_add_u32 s44, s45, s65
    s_add_u32 m0, s57, 0
    s_nop 0
    buffer_load_dwordx4 v240, s[16:19], s44 offen lds
    s_add_u32 m0, s57, 1024
    s_nop 0
    buffer_load_dwordx4 v241, s[16:19], s44 offen lds
    s_add_u32 s65, s65, 128
    s_cmp_ge_u32 s65, 1280
    s_cselect_b32 s65, 0, s65
    s_waitcnt lgkmcnt(0)
    v_mfma_f32_32x32x16_bf16 v[64:79], v[16:19], v[160:163], v[64:79]
    ds_read_b128 v[164:167], v243 offset:16384
    ds_read_b64_tr_b16 v[40:41], v236 offset:3072
    ds_read_b64_tr_b16 v[42:43], v236 offset:3840
    ds_read_b64_tr_b16 v[44:45], v236 offset:9216
    ds_read_b64_tr_b16 v[46:47], v236 offset:9984
    v_mfma_f32_32x32x16_bf16 v[80:95], v[20:23], v[160:163], v[80:95]
    ds_read_b64_tr_b16 v[48:49], v236 offset:3136
    ds_read_b64_tr_b16 v[50:51], v236 offset:3904
    ds_read_b64_tr_b16 v[52:53], v236 offset:9280
    ds_read_b64_tr_b16 v[54:55], v236 offset:10048
    ds_read_b64_tr_b16 v[56:57], v236 offset:3200
    v_mfma_f32_32x32x16_bf16 v[96:111], v[24:27], v[160:163], v[96:111]
    ds_read_b64_tr_b16 v[58:59], v236 offset:3968
    ds_read_b64_tr_b16 v[60:61], v236 offset:9344
    ds_read_b64_tr_b16 v[62:63], v236 offset:10112
    v_mfma_f32_32x32x16_bf16 v[112:127], v[28:31], v[160:163], v[112:127]
    v_mfma_f32_32x32x16_bf16 v[128:143], v[32:35], v[160:163], v[128:143]
    v_mfma_f32_32x32x16_bf16 v[144:159], v[36:39], v[160:163], v[144:159]
    s_waitcnt lgkmcnt(0)
    v_mfma_f32_32x32x16_bf16 v[64:79], v[40:43], v[164:167], v[64:79]
    s_waitcnt vmcnt(8)
    s_barrier
    v_mfma_f32_32x32x16_bf16 v[80:95], v[44:47], v[164:167], v[80:95]
    ds_read_b128 v[160:163], v244 offset:16384
    ds_read_b64_tr_b16 v[16:17], v236 offset:12288
    ds_read_b64_tr_b16 v[18:19], v236 offset:13056
    ds_read_b64_tr_b16 v[20:21], v236 offset:18432
    ds_read_b64_tr_b16 v[22:23], v236 offset:19200
    v_mfma_f32_32x32x16_bf16 v[96:111], v[48:51], v[164:167], v[96:111]
    ds_read_b64_tr_b16 v[24:25], v236 offset:12352
    ds_read_b64_tr_b16 v[26:27], v236 offset:13120
    ds_read_b64_tr_b16 v[28:29], v236 offset:18496
    ds_read_b64_tr_b16 v[30:31], v236 offset:19264
    ds_read_b64_tr_b16 v[32:33], v236 offset:12416
    v_mfma_f32_32x32x16_bf16 v[112:127], v[52:55], v[164:167], v[112:127]
    ds_read_b64_tr_b16 v[34:35], v236 offset:13184
    ds_read_b64_tr_b16 v[36:37], v236 offset:18560
    ds_read_b64_tr_b16 v[38:39], v236 offset:19328
    v_mfma_f32_32x32x16_bf16 v[128:143], v[56:59], v[164:167], v[128:143]
    v_mfma_f32_32x32x16_bf16 v[144:159], v[60:63], v[164:167], v[144:159]
    s_add_u32 m0, s75, 0
    s_nop 0
    buffer_load_dwordx4 v239, s[24:27], s67 offen lds
    s_add_u32 m0, s76, 0
    s_nop 0
    buffer_load_dwordx4 v187, s[28:31], s67 offen lds
    s_add_u32 s67, s67, 98304
    s_cmp_ge_u32 s67, 1966080
    s_cselect_b32 s67, 0, s67
    s_waitcnt lgkmcnt(0)
    v_mfma_f32_32x32x16_bf16 v[64:79], v[16:19], v[160:163], v[64:79]
    ds_read_b128 v[164:167], v245 offset:16384
    ds_read_b64_tr_b16 v[40:41], v236 offset:15360
    ds_read_b64_tr_b16 v[42:43], v236 offset:16128
    ds_read_b64_tr_b16 v[44:45], v236 offset:21504
    ds_read_b64_tr_b16 v[46:47], v236 offset:22272
    v_mfma_f32_32x32x16_bf16 v[80:95], v[20:23], v[160:163], v[80:95]
    ds_read_b64_tr_b16 v[48:49], v236 offset:15424
    ds_read_b64_tr_b16 v[50:51], v236 offset:16192
    ds_read_b64_tr_b16 v[52:53], v236 offset:21568
    ds_read_b64_tr_b16 v[54:55], v236 offset:22336
    ds_read_b64_tr_b16 v[56:57], v236 offset:15488
    v_mfma_f32_32x32x16_bf16 v[96:111], v[24:27], v[160:163], v[96:111]
    ds_read_b64_tr_b16 v[58:59], v236 offset:16256
    ds_read_b64_tr_b16 v[60:61], v236 offset:21632
    ds_read_b64_tr_b16 v[62:63], v236 offset:22400
    v_mfma_f32_32x32x16_bf16 v[112:127], v[28:31], v[160:163], v[112:127]
    v_mfma_f32_32x32x16_bf16 v[128:143], v[32:35], v[160:163], v[128:143]
    v_mfma_f32_32x32x16_bf16 v[144:159], v[36:39], v[160:163], v[144:159]
    s_waitcnt lgkmcnt(0)
    v_mfma_f32_32x32x16_bf16 v[64:79], v[40:43], v[164:167], v[64:79]
    s_waitcnt vmcnt(6)
    s_barrier
    v_mfma_f32_32x32x16_bf16 v[80:95], v[44:47], v[164:167], v[80:95]
    ds_read_b128 v[160:163], v242 offset:32768
    ds_read_b64_tr_b16 v[16:17], v236 offset:24576
    ds_read_b64_tr_b16 v[18:19], v236 offset:25344
    ds_read_b64_tr_b16 v[20:21], v236 offset:30720
    ds_read_b64_tr_b16 v[22:23], v236 offset:31488
    v_mfma_f32_32x32x16_bf16 v[96:111], v[48:51], v[164:167], v[96:111]
    ds_read_b64_tr_b16 v[24:25], v236 offset:24640
    ds_read_b64_tr_b16 v[26:27], v236 offset:25408
    ds_read_b64_tr_b16 v[28:29], v236 offset:30784
    ds_read_b64_tr_b16 v[30:31], v236 offset:31552
    ds_read_b64_tr_b16 v[32:33], v236 offset:24704
    v_mfma_f32_32x32x16_bf16 v[112:127], v[52:55], v[164:167], v[112:127]
    ds_read_b64_tr_b16 v[34:35], v236 offset:25472
    ds_read_b64_tr_b16 v[36:37], v236 offset:30848
    ds_read_b64_tr_b16 v[38:39], v236 offset:31616
    v_mfma_f32_32x32x16_bf16 v[128:143], v[56:59], v[164:167], v[128:143]
    v_mfma_f32_32x32x16_bf16 v[144:159], v[60:63], v[164:167], v[144:159]
    s_add_u32 m0, s75, 12288
    s_nop 0
    buffer_load_dwordx4 v239, s[24:27], s67 offen lds
    s_add_u32 m0, s76, 12288
    s_nop 0
    buffer_load_dwordx4 v187, s[28:31], s67 offen lds
    s_add_u32 s67, s67, 98304
    s_cmp_ge_u32 s67, 1966080
    s_cselect_b32 s67, 0, s67
    s_add_u32 s44, s45, s65
    s_add_u32 m0, s57, 16384
    s_nop 0
    buffer_load_dwordx4 v240, s[16:19], s44 offen lds
    s_add_u32 m0, s57, 17408
    s_nop 0
    buffer_load_dwordx4 v241, s[16:19], s44 offen lds
    s_add_u32 s65, s65, 128
    s_cmp_ge_u32 s65, 1280
    s_cselect_b32 s65, 0, s65
    s_waitcnt lgkmcnt(0)
    v_mfma_f32_32x32x16_bf16 v[64:79], v[16:19], v[160:163], v[64:79]
    ds_read_b128 v[164:167], v243 offset:32768
    ds_read_b64_tr_b16 v[40:41], v236 offset:27648
    ds_read_b64_tr_b16 v[42:43], v236 offset:28416
    ds_read_b64_tr_b16 v[44:45], v236 offset:33792
    ds_read_b64_tr_b16 v[46:47], v236 offset:34560
    v_mfma_f32_32x32x16_bf16 v[80:95], v[20:23], v[160:163], v[80:95]
    ds_read_b64_tr_b16 v[48:49], v236 offset:27712
    ds_read_b64_tr_b16 v[50:51], v236 offset:28480
    ds_read_b64_tr_b16 v[52:53], v236 offset:33856
    ds_read_b64_tr_b16 v[54:55], v236 offset:34624
    ds_read_b64_tr_b16 v[56:57], v236 offset:27776
    v_mfma_f32_32x32x16_bf16 v[96:111], v[24:27], v[160:163], v[96:111]
    ds_read_b64_tr_b16 v[58:59], v236 offset:28544
    ds_read_b64_tr_b16 v[60:61], v236 offset:33920
    ds_read_b64_tr_b16 v[62:63], v236 offset:34688
    v_mfma_f32_32x32x16_bf16 v[112:127], v[28:31], v[160:163], v[112:127]
    v_mfma_f32_32x32x16_bf16 v[128:143], v[32:35], v[160:163], v[128:143]
    v_mfma_f32_32x32x16_bf16 v[144:159], v[36:39], v[160:163], v[144:159]
    s_waitcnt lgkmcnt(0)
    v_mfma_f32_32x32x16_bf16 v[64:79], v[40:43], v[164:167], v[64:79]
    s_waitcnt vmcnt(8)
    s_barrier
    v_mfma_f32_32x32x16_bf16 v[80:95], v[44:47], v[164:167], v[80:95]
    ds_read_b128 v[160:163], v244 offset:32768
    ds_read_b64_tr_b16 v[16:17], v236 offset:36864
    ds_read_b64_tr_b16 v[18:19], v236 offset:37632
    ds_read_b64_tr_b16 v[20:21], v236 offset:43008
    ds_read_b64_tr_b16 v[22:23], v236 offset:43776
    v_mfma_f32_32x32x16_bf16 v[96:111], v[48:51], v[164:167], v[96:111]
    ds_read_b64_tr_b16 v[24:25], v236 offset:36928
    ds_read_b64_tr_b16 v[26:27], v236 offset:37696
    ds_read_b64_tr_b16 v[28:29], v236 offset:43072
    ds_read_b64_tr_b16 v[30:31], v236 offset:43840
    ds_read_b64_tr_b16 v[32:33], v236 offset:36992
    v_mfma_f32_32x32x16_bf16 v[112:127], v[52:55], v[164:167], v[112:127]
    ds_read_b64_tr_b16 v[34:35], v236 offset:37760
    ds_read_b64_tr_b16 v[36:37], v236 offset:43136
    ds_read_b64_tr_b16 v[38:39], v236 offset:43904
    v_mfma_f32_32x32x16_bf16 v[128:143], v[56:59], v[164:167], v[128:143]
    v_mfma_f32_32x32x16_bf16 v[144:159], v[60:63], v[164:167], v[144:159]
    s_add_u32 m0, s75, 24576
    s_nop 0
    buffer_load_dwordx4 v239, s[24:27], s67 offen lds
    s_add_u32 m0, s76, 24576
    s_nop 0
    buffer_load_dwordx4 v187, s[28:31], s67 offen lds
    s_add_u32 s67, s67, 98304
    s_cmp_ge_u32 s67, 1966080
    s_cselect_b32 s67, 0, s67
    s_waitcnt lgkmcnt(0)
    v_mfma_f32_32x32x16_bf16 v[64:79], v[16:19], v[160:163], v[64:79]
    ds_read_b128 v[164:167], v245 offset:32768
    ds_read_b64_tr_b16 v[40:41], v236 offset:39936
    ds_read_b64_tr_b16 v[42:43], v236 offset:40704
    ds_read_b64_tr_b16 v[44:45], v236 offset:46080
    ds_read_b64_tr_b16 v[46:47], v236 offset:46848
    v_mfma_f32_32x32x16_bf16 v[80:95], v[20:23], v[160:163], v[80:95]
    ds_read_b64_tr_b16 v[48:49], v236 offset:40000
    ds_read_b64_tr_b16 v[50:51], v236 offset:40768
    ds_read_b64_tr_b16 v[52:53], v236 offset:46144
    ds_read_b64_tr_b16 v[54:55], v236 offset:46912
    ds_read_b64_tr_b16 v[56:57], v236 offset:40064
    v_mfma_f32_32x32x16_bf16 v[96:111], v[24:27], v[160:163], v[96:111]
    ds_read_b64_tr_b16 v[58:59], v236 offset:40832
    ds_read_b64_tr_b16 v[60:61], v236 offset:46208
    ds_read_b64_tr_b16 v[62:63], v236 offset:46976
    v_mfma_f32_32x32x16_bf16 v[112:127], v[28:31], v[160:163], v[112:127]
    v_mfma_f32_32x32x16_bf16 v[128:143], v[32:35], v[160:163], v[128:143]
    v_mfma_f32_32x32x16_bf16 v[144:159], v[36:39], v[160:163], v[144:159]
    s_waitcnt lgkmcnt(0)
    v_mfma_f32_32x32x16_bf16 v[64:79], v[40:43], v[164:167], v[64:79]
    s_waitcnt vmcnt(6)
    s_barrier
    v_mfma_f32_32x32x16_bf16 v[80:95], v[44:47], v[164:167], v[80:95]
    ds_read_b128 v[160:163], v242 offset:0
    ds_read_b64_tr_b16 v[16:17], v236 offset:0
    ds_read_b64_tr_b16 v[18:19], v236 offset:768
    ds_read_b64_tr_b16 v[20:21], v236 offset:6144
    ds_read_b64_tr_b16 v[22:23], v236 offset:6912
    v_mfma_f32_32x32x16_bf16 v[96:111], v[48:51], v[164:167], v[96:111]
    ds_read_b64_tr_b16 v[24:25], v236 offset:64
    ds_read_b64_tr_b16 v[26:27], v236 offset:832
    ds_read_b64_tr_b16 v[28:29], v236 offset:6208
    ds_read_b64_tr_b16 v[30:31], v236 offset:6976
    ds_read_b64_tr_b16 v[32:33], v236 offset:128
    v_mfma_f32_32x32x16_bf16 v[112:127], v[52:55], v[164:167], v[112:127]
    ds_read_b64_tr_b16 v[34:35], v236 offset:896
    ds_read_b64_tr_b16 v[36:37], v236 offset:6272
    ds_read_b64_tr_b16 v[38:39], v236 offset:7040
    v_mfma_f32_32x32x16_bf16 v[128:143], v[56:59], v[164:167], v[128:143]
    v_mfma_f32_32x32x16_bf16 v[144:159], v[60:63], v[164:167], v[144:159]
    s_add_u32 m0, s75, 36864
    s_nop 0
    buffer_load_dwordx4 v239, s[24:27], s67 offen lds
    s_add_u32 m0, s76, 36864
    s_nop 0
    buffer_load_dwordx4 v187, s[28:31], s67 offen lds
    s_add_u32 s67, s67, 98304
    s_cmp_ge_u32 s67, 1966080
    s_cselect_b32 s67, 0, s67
    s_add_u32 s44, s45, s65
    s_add_u32 m0, s57, 32768
    s_nop 0
    buffer_load_dwordx4 v240, s[16:19], s44 offen lds
    s_add_u32 m0, s57, 33792
    s_nop 0
    buffer_load_dwordx4 v241, s[16:19], s44 offen lds
    s_add_u32 s65, s65, 128
    s_cmp_ge_u32 s65, 1280
    s_cselect_b32 s65, 0, s65
    s_waitcnt lgkmcnt(0)
    v_mfma_f32_32x32x16_bf16 v[64:79], v[16:19], v[160:163], v[64:79]
    ds_read_b128 v[164:167], v243 offset:0
    ds_read_b64_tr_b16 v[40:41], v236 offset:3072
    ds_read_b64_tr_b16 v[42:43], v236 offset:3840
    ds_read_b64_tr_b16 v[44:45], v236 offset:9216
    ds_read_b64_tr_b16 v[46:47], v236 offset:9984
    v_mfma_f32_32x32x16_bf16 v[80:95], v[20:23], v[160:163], v[80:95]
    ds_read_b64_tr_b16 v[48:49], v236 offset:3136
    ds_read_b64_tr_b16 v[50:51], v236 offset:3904
    ds_read_b64_tr_b16 v[52:53], v236 offset:9280
    ds_read_b64_tr_b16 v[54:55], v236 offset:10048
    ds_read_b64_tr_b16 v[56:57], v236 offset:3200
    v_mfma_f32_32x32x16_bf16 v[96:111], v[24:27], v[160:163], v[96:111]
    ds_read_b64_tr_b16 v[58:59], v236 offset:3968
    ds_read_b64_tr_b16 v[60:61], v236 offset:9344
    ds_read_b64_tr_b16 v[62:63], v236 offset:10112
    v_mfma_f32_32x32x16_bf16 v[112:127], v[28:31], v[160:163], v[112:127]
    v_mfma_f32_32x32x16_bf16 v[128:143], v[32:35], v[160:163], v[128:143]
    v_mfma_f32_32x32x16_bf16 v[144:159], v[36:39], v[160:163], v[144:159]
    s_waitcnt lgkmcnt(0)
    v_mfma_f32_32x32x16_bf16 v[64:79], v[40:43], v[164:167], v[64:79]
    s_waitcnt vmcnt(8)
    s_barrier
    v_mfma_f32_32x32x16_bf16 v[80:95], v[44:47], v[164:167], v[80:95]
    ds_read_b128 v[160:163], v244 offset:0
    ds_read_b64_tr_b16 v[16:17], v236 offset:12288
    ds_read_b64_tr_b16 v[18:19], v236 offset:13056
    ds_read_b64_tr_b16 v[20:21], v236 offset:18432
    ds_read_b64_tr_b16 v[22:23], v236 offset:19200
    v_mfma_f32_32x32x16_bf16 v[96:111], v[48:51], v[164:167], v[96:111]
    ds_read_b64_tr_b16 v[24:25], v236 offset:12352
    ds_read_b64_tr_b16 v[26:27], v236 offset:13120
    ds_read_b64_tr_b16 v[28:29], v236 offset:18496
    ds_read_b64_tr_b16 v[30:31], v236 offset:19264
    ds_read_b64_tr_b16 v[32:33], v236 offset:12416
    v_mfma_f32_32x32x16_bf16 v[112:127], v[52:55], v[164:167], v[112:127]
    ds_read_b64_tr_b16 v[34:35], v236 offset:13184
    ds_read_b64_tr_b16 v[36:37], v236 offset:18560
    ds_read_b64_tr_b16 v[38:39], v236 offset:19328
    v_mfma_f32_32x32x16_bf16 v[128:143], v[56:59], v[164:167], v[128:143]
    v_mfma_f32_32x32x16_bf16 v[144:159], v[60:63], v[164:167], v[144:159]
    s_add_u32 m0, s75, 0
    s_nop 0
    buffer_load_dwordx4 v239, s[24:27], s67 offen lds
    s_add_u32 m0, s76, 0
    s_nop 0
    buffer_load_dwordx4 v187, s[28:31], s67 offen lds
    s_add_u32 s67, s67, 98304
    s_cmp_ge_u32 s67, 1966080
    s_cselect_b32 s67, 0, s67
    s_waitcnt lgkmcnt(0)
    v_mfma_f32_32x32x16_bf16 v[64:79], v[16:19], v[160:163], v[64:79]
    ds_read_b128 v[164:167], v245 offset:0
    ds_read_b64_tr_b16 v[40:41], v236 offset:15360
    ds_read_b64_tr_b16 v[42:43], v236 offset:16128
    ds_read_b64_tr_b16 v[44:45], v236 offset:21504
    ds_read_b64_tr_b16 v[46:47], v236 offset:22272
    v_mfma_f32_32x32x16_bf16 v[80:95], v[20:23], v[160:163], v[80:95]
    ds_read_b64_tr_b16 v[48:49], v236 offset:15424
    ds_read_b64_tr_b16 v[50:51], v236 offset:16192
    ds_read_b64_tr_b16 v[52:53], v236 offset:21568
    ds_read_b64_tr_b16 v[54:55], v236 offset:22336
    ds_read_b64_tr_b16 v[56:57], v236 offset:15488
    v_mfma_f32_32x32x16_bf16 v[96:111], v[24:27], v[160:163], v[96:111]
    ds_read_b64_tr_b16 v[58:59], v236 offset:16256
    ds_read_b64_tr_b16 v[60:61], v236 offset:21632
    ds_read_b64_tr_b16 v[62:63], v236 offset:22400
    v_mfma_f32_32x32x16_bf16 v[112:127], v[28:31], v[160:163], v[112:127]
    v_mfma_f32_32x32x16_bf16 v[128:143], v[32:35], v[160:163], v[128:143]
    v_mfma_f32_32x32x16_bf16 v[144:159], v[36:39], v[160:163], v[144:159]
    s_waitcnt lgkmcnt(0)
    v_mfma_f32_32x32x16_bf16 v[64:79], v[40:43], v[164:167], v[64:79]
    s_waitcnt vmcnt(6)
    s_barrier
    v_mfma_f32_32x32x16_bf16 v[80:95], v[44:47], v[164:167], v[80:95]
    ds_read_b128 v[160:163], v242 offset:16384
    ds_read_b64_tr_b16 v[16:17], v236 offset:24576
    ds_read_b64_tr_b16 v[18:19], v236 offset:25344
    ds_read_b64_tr_b16 v[20:21], v236 offset:30720
    ds_read_b64_tr_b16 v[22:23], v236 offset:31488
    v_mfma_f32_32x32x16_bf16 v[96:111], v[48:51], v[164:167], v[96:111]
    ds_read_b64_tr_b16 v[24:25], v236 offset:24640
    ds_read_b64_tr_b16 v[26:27], v236 offset:25408
    ds_read_b64_tr_b16 v[28:29], v236 offset:30784
    ds_read_b64_tr_b16 v[30:31], v236 offset:31552
    ds_read_b64_tr_b16 v[32:33], v236 offset:24704
    v_mfma_f32_32x32x16_bf16 v[112:127], v[52:55], v[164:167], v[112:127]
    ds_read_b64_tr_b16 v[34:35], v236 offset:25472
    ds_read_b64_tr_b16 v[36:37], v236 offset:30848
    ds_read_b64_tr_b16 v[38:39], v236 offset:31616
    v_mfma_f32_32x32x16_bf16 v[128:143], v[56:59], v[164:167], v[128:143]
    v_mfma_f32_32x32x16_bf16 v[144:159], v[60:63], v[164:167], v[144:159]
    s_add_u32 m0, s75, 12288
    s_nop 0
    buffer_load_dwordx4 v239, s[24:27], s67 offen lds
    s_add_u32 m0, s76, 12288
    s_nop 0
    buffer_load_dwordx4 v187, s[28:31], s67 offen lds
    s_add_u32 s67, s67, 98304
    s_cmp_ge_u32 s67, 1966080
    s_cselect_b32 s67, 0, s67
    s_add_u32 s44, s45, s65
    s_add_u32 m0, s57, 0
    s_nop 0
    buffer_load_dwordx4 v240, s[16:19], s44 offen lds
    s_add_u32 m0, s57, 1024
    s_nop 0
    buffer_load_dwordx4 v241, s[16:19], s44 offen lds
    s_add_u32 s65, s65, 128
    s_cmp_ge_u32 s65, 1280
    s_cselect_b32 s65, 0, s65
    s_waitcnt lgkmcnt(0)
    v_mfma_f32_32x32x16_bf16 v[64:79], v[16:19], v[160:163], v[64:79]
    ds_read_b128 v[164:167], v243 offset:16384
    ds_read_b64_tr_b16 v[40:41], v236 offset:27648
    ds_read_b64_tr_b16 v[42:43], v236 offset:28416
    ds_read_b64_tr_b16 v[44:45], v236 offset:33792
    ds_read_b64_tr_b16 v[46:47], v236 offset:34560
    v_mfma_f32_32x32x16_bf16 v[80:95], v[20:23], v[160:163], v[80:95]
    ds_read_b64_tr_b16 v[48:49], v236 offset:27712
    ds_read_b64_tr_b16 v[50:51], v236 offset:28480
    ds_read_b64_tr_b16 v[52:53], v236 offset:33856
    ds_read_b64_tr_b16 v[54:55], v236 offset:34624
    ds_read_b64_tr_b16 v[56:57], v236 offset:27776
    v_mfma_f32_32x32x16_bf16 v[96:111], v[24:27], v[160:163], v[96:111]
    ds_read_b64_tr_b16 v[58:59], v236 offset:28544
    ds_read_b64_tr_b16 v[60:61], v236 offset:33920
    ds_read_b64_tr_b16 v[62:63], v236 offset:34688
    v_mfma_f32_32x32x16_bf16 v[112:127], v[28:31], v[160:163], v[112:127]
    v_mfma_f32_32x32x16_bf16 v[128:143], v[32:35], v[160:163], v[128:143]
    v_mfma_f32_32x32x16_bf16 v[144:159], v[36:39], v[160:163], v[144:159]
    s_waitcnt lgkmcnt(0)
    v_mfma_f32_32x32x16_bf16 v[64:79], v[40:43], v[164:167], v[64:79]
    s_waitcnt vmcnt(8)
    s_barrier
    v_mfma_f32_32x32x16_bf16 v[80:95], v[44:47], v[164:167], v[80:95]
    ds_read_b128 v[160:163], v244 offset:16384
    ds_read_b64_tr_b16 v[16:17], v236 offset:36864
    ds_read_b64_tr_b16 v[18:19], v236 offset:37632
    ds_read_b64_tr_b16 v[20:21], v236 offset:43008
    ds_read_b64_tr_b16 v[22:23], v236 offset:43776
    v_mfma_f32_32x32x16_bf16 v[96:111], v[48:51], v[164:167], v[96:111]
    ds_read_b64_tr_b16 v[24:25], v236 offset:36928
    ds_read_b64_tr_b16 v[26:27], v236 offset:37696
    ds_read_b64_tr_b16 v[28:29], v236 offset:43072
    ds_read_b64_tr_b16 v[30:31], v236 offset:43840
    ds_read_b64_tr_b16 v[32:33], v236 offset:36992
    v_mfma_f32_32x32x16_bf16 v[112:127], v[52:55], v[164:167], v[112:127]
    ds_read_b64_tr_b16 v[34:35], v236 offset:37760
    ds_read_b64_tr_b16 v[36:37], v236 offset:43136
    ds_read_b64_tr_b16 v[38:39], v236 offset:43904
    v_mfma_f32_32x32x16_bf16 v[128:143], v[56:59], v[164:167], v[128:143]
    v_mfma_f32_32x32x16_bf16 v[144:159], v[60:63], v[164:167], v[144:159]
    v_mov_b32 v253, 0
    buffer_load_dword v234, v253, s[52:55], s56 offen sc1
    s_add_u32 m0, s75, 24576
    s_nop 0
    buffer_load_dwordx4 v239, s[24:27], s67 offen lds
    s_add_u32 m0, s76, 24576
    s_nop 0
    buffer_load_dwordx4 v187, s[28:31], s67 offen lds
    s_add_u32 s67, s67, 98304
    s_cmp_ge_u32 s67, 1966080
    s_cselect_b32 s67, 0, s67
    s_waitcnt lgkmcnt(0)
    v_mfma_f32_32x32x16_bf16 v[64:79], v[16:19], v[160:163], v[64:79]
    ds_read_b128 v[164:167], v245 offset:16384
    ds_read_b64_tr_b16 v[40:41], v236 offset:39936
    ds_read_b64_tr_b16 v[42:43], v236 offset:40704
    ds_read_b64_tr_b16 v[44:45], v236 offset:46080
    ds_read_b64_tr_b16 v[46:47], v236 offset:46848
    v_mfma_f32_32x32x16_bf16 v[80:95], v[20:23], v[160:163], v[80:95]
    ds_read_b64_tr_b16 v[48:49], v236 offset:40000
    ds_read_b64_tr_b16 v[50:51], v236 offset:40768
    ds_read_b64_tr_b16 v[52:53], v236 offset:46144
    ds_read_b64_tr_b16 v[54:55], v236 offset:46912
    ds_read_b64_tr_b16 v[56:57], v236 offset:40064
    v_mfma_f32_32x32x16_bf16 v[96:111], v[24:27], v[160:163], v[96:111]
    ds_read_b64_tr_b16 v[58:59], v236 offset:40832
    ds_read_b64_tr_b16 v[60:61], v236 offset:46208
    ds_read_b64_tr_b16 v[62:63], v236 offset:46976
    v_mfma_f32_32x32x16_bf16 v[112:127], v[28:31], v[160:163], v[112:127]
    v_mfma_f32_32x32x16_bf16 v[128:143], v[32:35], v[160:163], v[128:143]
    v_mfma_f32_32x32x16_bf16 v[144:159], v[36:39], v[160:163], v[144:159]
    s_waitcnt lgkmcnt(0)
    v_mfma_f32_32x32x16_bf16 v[64:79], v[40:43], v[164:167], v[64:79]
    s_waitcnt vmcnt(7)
    s_barrier
    v_mfma_f32_32x32x16_bf16 v[80:95], v[44:47], v[164:167], v[80:95]
    ds_read_b128 v[160:163], v242 offset:32768
    ds_read_b64_tr_b16 v[16:17], v236 offset:0
    ds_read_b64_tr_b16 v[18:19], v236 offset:768
    ds_read_b64_tr_b16 v[20:21], v236 offset:6144
    ds_read_b64_tr_b16 v[22:23], v236 offset:6912
    v_mfma_f32_32x32x16_bf16 v[96:111], v[48:51], v[164:167], v[96:111]
    ds_read_b64_tr_b16 v[24:25], v236 offset:64
    ds_read_b64_tr_b16 v[26:27], v236 offset:832
    ds_read_b64_tr_b16 v[28:29], v236 offset:6208
    ds_read_b64_tr_b16 v[30:31], v236 offset:6976
    ds_read_b64_tr_b16 v[32:33], v236 offset:128
    v_mfma_f32_32x32x16_bf16 v[112:127], v[52:55], v[164:167], v[112:127]
    ds_read_b64_tr_b16 v[34:35], v236 offset:896
    ds_read_b64_tr_b16 v[36:37], v236 offset:6272
    ds_read_b64_tr_b16 v[38:39], v236 offset:7040
    v_mfma_f32_32x32x16_bf16 v[128:143], v[56:59], v[164:167], v[128:143]
    v_mfma_f32_32x32x16_bf16 v[144:159], v[60:63], v[164:167], v[144:159]
    s_add_u32 m0, s75, 36864
    s_nop 0
    buffer_load_dwordx4 v239, s[24:27], s67 offen lds
    s_add_u32 m0, s76, 36864
    s_nop 0
    buffer_load_dwordx4 v187, s[28:31], s67 offen lds
    s_add_u32 s67, s67, 98304
    s_cmp_ge_u32 s67, 1966080
    s_cselect_b32 s67, 0, s67
    s_waitcnt lgkmcnt(0)
    v_mfma_f32_32x32x16_bf16 v[64:79], v[16:19], v[160:163], v[64:79]
    ds_read_b128 v[164:167], v243 offset:32768
    ds_read_b64_tr_b16 v[40:41], v236 offset:3072
    ds_read_b64_tr_b16 v[42:43], v236 offset:3840
    ds_read_b64_tr_b16 v[44:45], v236 offset:9216
    ds_read_b64_tr_b16 v[46:47], v236 offset:9984
    v_mfma_f32_32x32x16_bf16 v[80:95], v[20:23], v[160:163], v[80:95]
    ds_read_b64_tr_b16 v[48:49], v236 offset:3136
    ds_read_b64_tr_b16 v[50:51], v236 offset:3904
    ds_read_b64_tr_b16 v[52:53], v236 offset:9280
    ds_read_b64_tr_b16 v[54:55], v236 offset:10048
    ds_read_b64_tr_b16 v[56:57], v236 offset:3200
    v_mfma_f32_32x32x16_bf16 v[96:111], v[24:27], v[160:163], v[96:111]
    ds_read_b64_tr_b16 v[58:59], v236 offset:3968
    ds_read_b64_tr_b16 v[60:61], v236 offset:9344
    ds_read_b64_tr_b16 v[62:63], v236 offset:10112
    v_mfma_f32_32x32x16_bf16 v[112:127], v[28:31], v[160:163], v[112:127]
    v_mfma_f32_32x32x16_bf16 v[128:143], v[32:35], v[160:163], v[128:143]
    v_mfma_f32_32x32x16_bf16 v[144:159], v[36:39], v[160:163], v[144:159]
    s_waitcnt lgkmcnt(0)
    v_mfma_f32_32x32x16_bf16 v[64:79], v[40:43], v[164:167], v[64:79]
    s_waitcnt vmcnt(7)
    s_barrier
    v_mfma_f32_32x32x16_bf16 v[80:95], v[44:47], v[164:167], v[80:95]
    ds_read_b128 v[160:163], v244 offset:32768
    ds_read_b64_tr_b16 v[16:17], v236 offset:12288
    ds_read_b64_tr_b16 v[18:19], v236 offset:13056
    ds_read_b64_tr_b16 v[20:21], v236 offset:18432
    ds_read_b64_tr_b16 v[22:23], v236 offset:19200
    v_mfma_f32_32x32x16_bf16 v[96:111], v[48:51], v[164:167], v[96:111]
    ds_read_b64_tr_b16 v[24:25], v236 offset:12352
    ds_read_b64_tr_b16 v[26:27], v236 offset:13120
    ds_read_b64_tr_b16 v[28:29], v236 offset:18496
    ds_read_b64_tr_b16 v[30:31], v236 offset:19264
    ds_read_b64_tr_b16 v[32:33], v236 offset:12416
    v_mfma_f32_32x32x16_bf16 v[112:127], v[52:55], v[164:167], v[112:127]
    ds_read_b64_tr_b16 v[34:35], v236 offset:13184
    ds_read_b64_tr_b16 v[36:37], v236 offset:18560
    ds_read_b64_tr_b16 v[38:39], v236 offset:19328
    v_mfma_f32_32x32x16_bf16 v[128:143], v[56:59], v[164:167], v[128:143]
    v_mfma_f32_32x32x16_bf16 v[144:159], v[60:63], v[164:167], v[144:159]
    s_waitcnt vmcnt(4)
    s_nop 0
    v_readfirstlane_b32 s47, v234
    s_mov_b32 s43, s50
    buffer_load_dword v224, v235, s[32:35], s43 offen sc1
    s_add_u32 s43, s43, 1536
    buffer_load_dword v225, v235, s[32:35], s43 offen sc1
    s_add_u32 s43, s43, 1536
    buffer_load_dword v226, v235, s[32:35], s43 offen sc1
    s_add_u32 s43, s43, 1536
    buffer_load_dword v227, v235, s[32:35], s43 offen sc1
    s_add_u32 s43, s43, 1536
    buffer_load_dword v228, v235, s[32:35], s43 offen sc1
    s_add_u32 s43, s43, 1536
    buffer_load_dword v229, v235, s[32:35], s43 offen sc1
    s_add_u32 s43, s43, 1536
    buffer_load_dword v230, v235, s[32:35], s43 offen sc1
    s_add_u32 s43, s43, 1536
    buffer_load_dword v231, v235, s[32:35], s43 offen sc1
    s_add_u32 s43, s43, 1536
    buffer_load_dword v232, v235, s[32:35], s43 offen sc1
    s_add_u32 s43, s43, 1536
    buffer_load_dword v233, v235, s[32:35], s43 offen sc1
    s_waitcnt lgkmcnt(0)
    v_mfma_f32_32x32x16_bf16 v[64:79], v[16:19], v[160:163], v[64:79]
    ds_read_b128 v[164:167], v245 offset:32768
    ds_read_b64_tr_b16 v[40:41], v236 offset:15360
    ds_read_b64_tr_b16 v[42:43], v236 offset:16128
    ds_read_b64_tr_b16 v[44:45], v236 offset:21504
    ds_read_b64_tr_b16 v[46:47], v236 offset:22272
    v_mfma_f32_32x32x16_bf16 v[80:95], v[20:23], v[160:163], v[80:95]
    ds_read_b64_tr_b16 v[48:49], v236 offset:15424
    ds_read_b64_tr_b16 v[50:51], v236 offset:16192
    ds_read_b64_tr_b16 v[52:53], v236 offset:21568
    ds_read_b64_tr_b16 v[54:55], v236 offset:22336
    ds_read_b64_tr_b16 v[56:57], v236 offset:15488
    v_mfma_f32_32x32x16_bf16 v[96:111], v[24:27], v[160:163], v[96:111]
    ds_read_b64_tr_b16 v[58:59], v236 offset:16256
    ds_read_b64_tr_b16 v[60:61], v236 offset:21632
    ds_read_b64_tr_b16 v[62:63], v236 offset:22400
    v_mfma_f32_32x32x16_bf16 v[112:127], v[28:31], v[160:163], v[112:127]
    v_mfma_f32_32x32x16_bf16 v[128:143], v[32:35], v[160:163], v[128:143]
    v_mfma_f32_32x32x16_bf16 v[144:159], v[36:39], v[160:163], v[144:159]
    s_waitcnt lgkmcnt(0)
    v_mfma_f32_32x32x16_bf16 v[64:79], v[40:43], v[164:167], v[64:79]
    s_waitcnt vmcnt(12)
    s_barrier
    v_mfma_f32_32x32x16_bf16 v[80:95], v[44:47], v[164:167], v[80:95]
    ds_read_b128 v[160:163], v242 offset:0
    ds_read_b64_tr_b16 v[16:17], v236 offset:24576
    ds_read_b64_tr_b16 v[18:19], v236 offset:25344
    ds_read_b64_tr_b16 v[20:21], v236 offset:30720
    ds_read_b64_tr_b16 v[22:23], v236 offset:31488
    v_mfma_f32_32x32x16_bf16 v[96:111], v[48:51], v[164:167], v[96:111]
    ds_read_b64_tr_b16 v[24:25], v236 offset:24640
    ds_read_b64_tr_b16 v[26:27], v236 offset:25408
    ds_read_b64_tr_b16 v[28:29], v236 offset:30784
    ds_read_b64_tr_b16 v[30:31], v236 offset:31552
    ds_read_b64_tr_b16 v[32:33], v236 offset:24704
    v_mfma_f32_32x32x16_bf16 v[112:127], v[52:55], v[164:167], v[112:127]
    ds_read_b64_tr_b16 v[34:35], v236 offset:25472
    ds_read_b64_tr_b16 v[36:37], v236 offset:30848
    ds_read_b64_tr_b16 v[38:39], v236 offset:31616
    v_mfma_f32_32x32x16_bf16 v[128:143], v[56:59], v[164:167], v[128:143]
    v_mfma_f32_32x32x16_bf16 v[144:159], v[60:63], v[164:167], v[144:159]
    s_waitcnt lgkmcnt(0)
    v_mfma_f32_32x32x16_bf16 v[64:79], v[16:19], v[160:163], v[64:79]
    ds_read_b128 v[164:167], v243 offset:0
    ds_read_b64_tr_b16 v[40:41], v236 offset:27648
    ds_read_b64_tr_b16 v[42:43], v236 offset:28416
    ds_read_b64_tr_b16 v[44:45], v236 offset:33792
    ds_read_b64_tr_b16 v[46:47], v236 offset:34560
    v_mfma_f32_32x32x16_bf16 v[80:95], v[20:23], v[160:163], v[80:95]
    ds_read_b64_tr_b16 v[48:49], v236 offset:27712
    ds_read_b64_tr_b16 v[50:51], v236 offset:28480
    ds_read_b64_tr_b16 v[52:53], v236 offset:33856
    ds_read_b64_tr_b16 v[54:55], v236 offset:34624
    ds_read_b64_tr_b16 v[56:57], v236 offset:27776
    v_mfma_f32_32x32x16_bf16 v[96:111], v[24:27], v[160:163], v[96:111]
    ds_read_b64_tr_b16 v[58:59], v236 offset:28544
    ds_read_b64_tr_b16 v[60:61], v236 offset:33920
    ds_read_b64_tr_b16 v[62:63], v236 offset:34688
    v_mfma_f32_32x32x16_bf16 v[112:127], v[28:31], v[160:163], v[112:127]
    v_mfma_f32_32x32x16_bf16 v[128:143], v[32:35], v[160:163], v[128:143]
    v_mfma_f32_32x32x16_bf16 v[144:159], v[36:39], v[160:163], v[144:159]
    s_waitcnt lgkmcnt(0)
    v_mfma_f32_32x32x16_bf16 v[64:79], v[40:43], v[164:167], v[64:79]
    s_waitcnt vmcnt(10)
    s_barrier
    v_mfma_f32_32x32x16_bf16 v[80:95], v[44:47], v[164:167], v[80:95]
    ds_read_b128 v[160:163], v244 offset:0
    ds_read_b64_tr_b16 v[16:17], v236 offset:36864
    ds_read_b64_tr_b16 v[18:19], v236 offset:37632
    ds_read_b64_tr_b16 v[20:21], v236 offset:43008
    ds_read_b64_tr_b16 v[22:23], v236 offset:43776
    v_mfma_f32_32x32x16_bf16 v[96:111], v[48:51], v[164:167], v[96:111]
    ds_read_b64_tr_b16 v[24:25], v236 offset:36928
    ds_read_b64_tr_b16 v[26:27], v236 offset:37696
    ds_read_b64_tr_b16 v[28:29], v236 offset:43072
    ds_read_b64_tr_b16 v[30:31], v236 offset:43840
    ds_read_b64_tr_b16 v[32:33], v236 offset:36992
    v_mfma_f32_32x32x16_bf16 v[112:127], v[52:55], v[164:167], v[112:127]
    ds_read_b64_tr_b16 v[34:35], v236 offset:37760
    ds_read_b64_tr_b16 v[36:37], v236 offset:43136
    ds_read_b64_tr_b16 v[38:39], v236 offset:43904
    v_mfma_f32_32x32x16_bf16 v[128:143], v[56:59], v[164:167], v[128:143]
    v_mfma_f32_32x32x16_bf16 v[144:159], v[60:63], v[164:167], v[144:159]
    s_waitcnt lgkmcnt(0)
    v_mfma_f32_32x32x16_bf16 v[64:79], v[16:19], v[160:163], v[64:79]
    ds_read_b128 v[164:167], v245 offset:0
    ds_read_b64_tr_b16 v[40:41], v236 offset:39936
    ds_read_b64_tr_b16 v[42:43], v236 offset:40704
    ds_read_b64_tr_b16 v[44:45], v236 offset:46080
    ds_read_b64_tr_b16 v[46:47], v236 offset:46848
    v_mfma_f32_32x32x16_bf16 v[80:95], v[20:23], v[160:163], v[80:95]
    ds_read_b64_tr_b16 v[48:49], v236 offset:40000
    ds_read_b64_tr_b16 v[50:51], v236 offset:40768
    ds_read_b64_tr_b16 v[52:53], v236 offset:46144
    ds_read_b64_tr_b16 v[54:55], v236 offset:46912
    ds_read_b64_tr_b16 v[56:57], v236 offset:40064
    v_mfma_f32_32x32x16_bf16 v[96:111], v[24:27], v[160:163], v[96:111]
    ds_read_b64_tr_b16 v[58:59], v236 offset:40832
    ds_read_b64_tr_b16 v[60:61], v236 offset:46208
    ds_read_b64_tr_b16 v[62:63], v236 offset:46976
    v_mfma_f32_32x32x16_bf16 v[112:127], v[28:31], v[160:163], v[112:127]
    v_mfma_f32_32x32x16_bf16 v[128:143], v[32:35], v[160:163], v[128:143]
    v_mfma_f32_32x32x16_bf16 v[144:159], v[36:39], v[160:163], v[144:159]
    s_waitcnt lgkmcnt(0)
    v_mfma_f32_32x32x16_bf16 v[64:79], v[40:43], v[164:167], v[64:79]
    v_mfma_f32_32x32x16_bf16 v[80:95], v[44:47], v[164:167], v[80:95]
    v_mfma_f32_32x32x16_bf16 v[96:111], v[48:51], v[164:167], v[96:111]
    v_mfma_f32_32x32x16_bf16 v[112:127], v[52:55], v[164:167], v[112:127]
    v_mfma_f32_32x32x16_bf16 v[128:143], v[56:59], v[164:167], v[128:143]
    v_mfma_f32_32x32x16_bf16 v[144:159], v[60:63], v[164:167], v[144:159]
    s_cmp_ge_u32 s47, 10
    s_cbranch_scc1 L_gok_8
L_gpoll_9:
    v_mov_b32 v253, 0
    buffer_load_dword v234, v253, s[52:55], s56 offen sc1
    s_waitcnt vmcnt(0)
    s_nop 0
    v_readfirstlane_b32 s47, v234
    s_nop 3
    s_cmp_ge_u32 s47, 10
    s_cbranch_scc0 L_gpoll_9
    s_mov_b32 s43, s50
    buffer_load_dword v224, v235, s[32:35], s43 offen sc1
    s_add_u32 s43, s43, 1536
    buffer_load_dword v225, v235, s[32:35], s43 offen sc1
    s_add_u32 s43, s43, 1536
    buffer_load_dword v226, v235, s[32:35], s43 offen sc1
    s_add_u32 s43, s43, 1536
    buffer_load_dword v227, v235, s[32:35], s43 offen sc1
    s_add_u32 s43, s43, 1536
    buffer_load_dword v228, v235, s[32:35], s43 offen sc1
    s_add_u32 s43, s43, 1536
    buffer_load_dword v229, v235, s[32:35], s43 offen sc1
    s_add_u32 s43, s43, 1536
    buffer_load_dword v230, v235, s[32:35], s43 offen sc1
    s_add_u32 s43, s43, 1536
    buffer_load_dword v231, v235, s[32:35], s43 offen sc1
    s_add_u32 s43, s43, 1536
    buffer_load_dword v232, v235, s[32:35], s43 offen sc1
    s_add_u32 s43, s43, 1536
    buffer_load_dword v233, v235, s[32:35], s43 offen sc1
L_gok_8:
    s_waitcnt vmcnt(0)
    v_add_f32 v224, v224, v225
    v_add_f32 v226, v226, v227
    v_add_f32 v228, v228, v229
    v_add_f32 v230, v230, v231
    v_add_f32 v232, v232, v233
    v_add_f32 v224, v224, v226
    v_add_f32 v228, v228, v230
    v_add_f32 v224, v224, v232
    v_add_f32 v224, v224, v228
    v_add_u32 v9, 146432, v235
    ds_write_b32 v9, v224
    s_lshl_b32 s43, s60, 8
    s_add_u32 s43, s43, 147968
    v_lshlrev_b32 v11, 3, v4
    v_add_u32 v11, s43, v11
    v_lshlrev_b32 v10, 4, v3
    v_add_u32 v10, 146944, v10
    s_waitcnt lgkmcnt(0)
    s_barrier
    ds_read_b32 v12, v11
    ds_read_b32 v14, v11 offset:4
    ds_read_b128 v[160:163], v10 offset:0
    ds_read_b128 v[164:167], v10 offset:32
    ds_read_b128 v[168:171], v10 offset:64
    ds_read_b128 v[172:175], v10 offset:96
    ds_read_b128 v[176:179], v10 offset:128
    ds_read_b128 v[180:183], v10 offset:160
    ds_read_b128 v[184:187], v10 offset:192
    ds_read_b128 v[188:191], v10 offset:224
    ds_read_b128 v[192:195], v10 offset:256
    ds_read_b128 v[196:199], v10 offset:288
    ds_read_b128 v[200:203], v10 offset:320
    ds_read_b128 v[204:207], v10 offset:352
    ds_read_b128 v[208:211], v10 offset:384
    ds_read_b128 v[212:215], v10 offset:416
    ds_read_b128 v[216:219], v10 offset:448
    ds_read_b128 v[220:223], v10 offset:480
    ds_read_b128 v[16:19], v10 offset:512
    ds_read_b128 v[20:23], v10 offset:544
    ds_read_b128 v[24:27], v10 offset:576
    ds_read_b128 v[28:31], v10 offset:608
    ds_read_b128 v[32:35], v10 offset:640
    ds_read_b128 v[36:39], v10 offset:672
    ds_read_b128 v[40:43], v10 offset:704
    ds_read_b128 v[44:47], v10 offset:736
    s_lshl_b32 s43, s41, 1
    s_lshr_b32 s47, s60, 1
    s_add_u32 s43, s43, s47
    s_mul_i32 s43, s43, 68
    s_mul_i32 s47, s42, 3
    s_add_u32 s43, s43, s47
    s_add_u32 s43, s43, 20
    s_lshl_b32 s43, s43, 12
    s_and_b32 s47, s60, 1
    s_lshl_b32 s47, s47, 11
    s_add_u32 s47, s47, s43
    v_lshlrev_b32 v5, 6, v4
    v_lshl_add_u32 v5, v3, 3, v5
    v_mov_b32 v48, 0xc0135761
    v_mov_b32 v49, 0xc0135761
    v_mov_b32 v50, 0x3d372713
    v_mov_b32 v51, 0x3d372713
    v_mov_b32 v52, 1.0
    v_mov_b32 v53, 1.0
    s_waitcnt lgkmcnt(0)
    v_mov_b32 v13, v12
    v_mov_b32 v15, v14
    v_pk_fma_f32 v[64:65], v[12:13], v[160:161], v[64:65]
    v_pk_fma_f32 v[66:67], v[12:13], v[162:163], v[66:67]
    v_pk_fma_f32 v[68:69], v[12:13], v[164:165], v[68:69]
    v_pk_fma_f32 v[70:71], v[12:13], v[166:167], v[70:71]
    v_pk_fma_f32 v[72:73], v[12:13], v[168:169], v[72:73]
    v_pk_fma_f32 v[74:75], v[12:13], v[170:171], v[74:75]
    v_pk_fma_f32 v[76:77], v[12:13], v[172:173], v[76:77]
    v_pk_fma_f32 v[78:79], v[12:13], v[174:175], v[78:79]
    v_pk_mul_f32 v[64:65], v[14:15], v[64:65]
    v_pk_mul_f32 v[66:67], v[14:15], v[66:67]
    v_pk_mul_f32 v[68:69], v[14:15], v[68:69]
    v_pk_mul_f32 v[70:71], v[14:15], v[70:71]
    v_pk_mul_f32 v[72:73], v[14:15], v[72:73]
    v_pk_mul_f32 v[74:75], v[14:15], v[74:75]
    v_pk_mul_f32 v[76:77], v[14:15], v[76:77]
    v_pk_mul_f32 v[78:79], v[14:15], v[78:79]
    v_pk_fma_f32 v[80:81], v[12:13], v[176:177], v[80:81]
    v_pk_fma_f32 v[82:83], v[12:13], v[178:179], v[82:83]
    v_pk_fma_f32 v[84:85], v[12:13], v[180:181], v[84:85]
    v_pk_fma_f32 v[86:87], v[12:13], v[182:183], v[86:87]
    v_pk_fma_f32 v[88:89], v[12:13], v[184:185], v[88:89]
    v_pk_fma_f32 v[90:91], v[12:13], v[186:187], v[90:91]
    v_pk_fma_f32 v[92:93], v[12:13], v[188:189], v[92:93]
    v_pk_fma_f32 v[94:95], v[12:13], v[190:191], v[94:95]
    v_pk_mul_f32 v[80:81], v[14:15], v[80:81]
    v_pk_mul_f32 v[82:83], v[14:15], v[82:83]
    v_pk_mul_f32 v[84:85], v[14:15], v[84:85]
    v_pk_mul_f32 v[86:87], v[14:15], v[86:87]
    v_pk_mul_f32 v[88:89], v[14:15], v[88:89]
    v_pk_mul_f32 v[90:91], v[14:15], v[90:91]
    v_pk_mul_f32 v[92:93], v[14:15], v[92:93]
    v_pk_mul_f32 v[94:95], v[14:15], v[94:95]
    v_pk_fma_f32 v[96:97], v[12:13], v[192:193], v[96:97]
    v_pk_fma_f32 v[98:99], v[12:13], v[194:195], v[98:99]
    v_pk_fma_f32 v[100:101], v[12:13], v[196:197], v[100:101]
    v_pk_fma_f32 v[102:103], v[12:13], v[198:199], v[102:103]
    v_pk_fma_f32 v[104:105], v[12:13], v[200:201], v[104:105]
    v_pk_fma_f32 v[106:107], v[12:13], v[202:203], v[106:107]
    v_pk_fma_f32 v[108:109], v[12:13], v[204:205], v[108:109]
    v_pk_fma_f32 v[110:111], v[12:13], v[206:207], v[110:111]
    v_pk_mul_f32 v[96:97], v[14:15], v[96:97]
    v_pk_mul_f32 v[98:99], v[14:15], v[98:99]
    v_pk_mul_f32 v[100:101], v[14:15], v[100:101]
    v_pk_mul_f32 v[102:103], v[14:15], v[102:103]
    v_pk_mul_f32 v[104:105], v[14:15], v[104:105]
    v_pk_mul_f32 v[106:107], v[14:15], v[106:107]
    v_pk_mul_f32 v[108:109], v[14:15], v[108:109]
    v_pk_mul_f32 v[110:111], v[14:15], v[110:111]
    v_pk_fma_f32 v[112:113], v[12:13], v[208:209], v[112:113]
    v_pk_fma_f32 v[114:115], v[12:13], v[210:211], v[114:115]
    v_pk_fma_f32 v[116:117], v[12:13], v[212:213], v[116:117]
    v_pk_fma_f32 v[118:119], v[12:13], v[214:215], v[118:119]
    v_pk_fma_f32 v[120:121], v[12:13], v[216:217], v[120:121]
    v_pk_fma_f32 v[122:123], v[12:13], v[218:219], v[122:123]
    v_pk_fma_f32 v[124:125], v[12:13], v[220:221], v[124:125]
    v_pk_fma_f32 v[126:127], v[12:13], v[222:223], v[126:127]
    v_pk_mul_f32 v[112:113], v[14:15], v[112:113]
    v_pk_mul_f32 v[114:115], v[14:15], v[114:115]
    v_pk_mul_f32 v[116:117], v[14:15], v[116:117]
    v_pk_mul_f32 v[118:119], v[14:15], v[118:119]
    v_pk_mul_f32 v[120:121], v[14:15], v[120:121]
    v_pk_mul_f32 v[122:123], v[14:15], v[122:123]
    v_pk_mul_f32 v[124:125], v[14:15], v[124:125]
    v_pk_mul_f32 v[126:127], v[14:15], v[126:127]
    v_pk_fma_f32 v[128:129], v[12:13], v[16:17], v[128:129]
    v_pk_fma_f32 v[130:131], v[12:13], v[18:19], v[130:131]
    v_pk_fma_f32 v[132:133], v[12:13], v[20:21], v[132:133]
    v_pk_fma_f32 v[134:135], v[12:13], v[22:23], v[134:135]
    v_pk_fma_f32 v[136:137], v[12:13], v[24:25], v[136:137]
    v_pk_fma_f32 v[138:139], v[12:13], v[26:27], v[138:139]
    v_pk_fma_f32 v[140:141], v[12:13], v[28:29], v[140:141]
    v_pk_fma_f32 v[142:143], v[12:13], v[30:31], v[142:143]
    v_pk_mul_f32 v[128:129], v[14:15], v[128:129]
    v_pk_mul_f32 v[130:131], v[14:15], v[130:131]
    v_pk_mul_f32 v[132:133], v[14:15], v[132:133]
    v_pk_mul_f32 v[134:135], v[14:15], v[134:135]
    v_pk_mul_f32 v[136:137], v[14:15], v[136:137]
    v_pk_mul_f32 v[138:139], v[14:15], v[138:139]
    v_pk_mul_f32 v[140:141], v[14:15], v[140:141]
    v_pk_mul_f32 v[142:143], v[14:15], v[142:143]
    v_pk_fma_f32 v[144:145], v[12:13], v[32:33], v[144:145]
    v_pk_fma_f32 v[146:147], v[12:13], v[34:35], v[146:147]
    v_pk_fma_f32 v[148:149], v[12:13], v[36:37], v[148:149]
    v_pk_fma_f32 v[150:151], v[12:13], v[38:39], v[150:151]
    v_pk_fma_f32 v[152:153], v[12:13], v[40:41], v[152:153]
    v_pk_fma_f32 v[154:155], v[12:13], v[42:43], v[154:155]
    v_pk_fma_f32 v[156:157], v[12:13], v[44:45], v[156:157]
    v_pk_fma_f32 v[158:159], v[12:13], v[46:47], v[158:159]
    v_pk_mul_f32 v[144:145], v[14:15], v[144:145]
    v_pk_mul_f32 v[146:147], v[14:15], v[146:147]
    v_pk_mul_f32 v[148:149], v[14:15], v[148:149]
    v_pk_mul_f32 v[150:151], v[14:15], v[150:151]
    v_pk_mul_f32 v[152:153], v[14:15], v[152:153]
    v_pk_mul_f32 v[154:155], v[14:15], v[154:155]
    v_pk_mul_f32 v[156:157], v[14:15], v[156:157]
    v_pk_mul_f32 v[158:159], v[14:15], v[158:159]
    v_cvt_pk_bf16_f32 v160, v64, v65
    v_cvt_pk_bf16_f32 v161, v66, v67
    v_cvt_pk_bf16_f32 v162, v68, v69
    v_cvt_pk_bf16_f32 v163, v70, v71
    v_cvt_pk_bf16_f32 v164, v72, v73
    v_cvt_pk_bf16_f32 v165, v74, v75
    v_cvt_pk_bf16_f32 v166, v76, v77
    v_cvt_pk_bf16_f32 v167, v78, v79
    v_cvt_pk_bf16_f32 v168, v80, v81
    v_cvt_pk_bf16_f32 v169, v82, v83
    v_cvt_pk_bf16_f32 v170, v84, v85
    v_cvt_pk_bf16_f32 v171, v86, v87
    v_cvt_pk_bf16_f32 v172, v88, v89
    v_cvt_pk_bf16_f32 v173, v90, v91
    v_cvt_pk_bf16_f32 v174, v92, v93
    v_cvt_pk_bf16_f32 v175, v94, v95
    v_cvt_pk_bf16_f32 v176, v96, v97
    v_cvt_pk_bf16_f32 v177, v98, v99
    v_cvt_pk_bf16_f32 v178, v100, v101
    v_cvt_pk_bf16_f32 v179, v102, v103
    v_cvt_pk_bf16_f32 v180, v104, v105
    v_cvt_pk_bf16_f32 v181, v106, v107
    v_cvt_pk_bf16_f32 v182, v108, v109
    v_cvt_pk_bf16_f32 v183, v110, v111
    v_cvt_pk_bf16_f32 v184, v112, v113
    v_cvt_pk_bf16_f32 v185, v114, v115
    v_cvt_pk_bf16_f32 v186, v116, v117
    v_cvt_pk_bf16_f32 v187, v118, v119
    v_cvt_pk_bf16_f32 v188, v120, v121
    v_cvt_pk_bf16_f32 v189, v122, v123
    v_cvt_pk_bf16_f32 v190, v124, v125
    v_cvt_pk_bf16_f32 v191, v126, v127
    v_cvt_pk_bf16_f32 v192, v128, v129
    v_cvt_pk_bf16_f32 v193, v130, v131
    v_cvt_pk_bf16_f32 v194, v132, v133
    v_cvt_pk_bf16_f32 v195, v134, v135
    v_cvt_pk_bf16_f32 v196, v136, v137
    v_cvt_pk_bf16_f32 v197, v138, v139
    v_cvt_pk_bf16_f32 v198, v140, v141
    v_cvt_pk_bf16_f32 v199, v142, v143
    v_cvt_pk_bf16_f32 v200, v144, v145
    v_cvt_pk_bf16_f32 v201, v146, v147
    v_cvt_pk_bf16_f32 v202, v148, v149
    v_cvt_pk_bf16_f32 v203, v150, v151
    v_cvt_pk_bf16_f32 v204, v152, v153
    v_cvt_pk_bf16_f32 v205, v154, v155
    v_cvt_pk_bf16_f32 v206, v156, v157
    v_cvt_pk_bf16_f32 v207, v158, v159
    v_lshlrev_b32 v64, 16, v160
    v_and_b32 v65, 0xffff0000, v160
    v_lshlrev_b32 v66, 16, v161
    v_and_b32 v67, 0xffff0000, v161
    v_lshlrev_b32 v68, 16, v162
    v_and_b32 v69, 0xffff0000, v162
    v_lshlrev_b32 v70, 16, v163
    v_and_b32 v71, 0xffff0000, v163
    v_lshlrev_b32 v72, 16, v164
    v_and_b32 v73, 0xffff0000, v164
    v_lshlrev_b32 v74, 16, v165
    v_and_b32 v75, 0xffff0000, v165
    v_lshlrev_b32 v76, 16, v166
    v_and_b32 v77, 0xffff0000, v166
    v_lshlrev_b32 v78, 16, v167
    v_and_b32 v79, 0xffff0000, v167
    v_lshlrev_b32 v80, 16, v168
    v_and_b32 v81, 0xffff0000, v168
    v_lshlrev_b32 v82, 16, v169
    v_and_b32 v83, 0xffff0000, v169
    v_lshlrev_b32 v84, 16, v170
    v_and_b32 v85, 0xffff0000, v170
    v_lshlrev_b32 v86, 16, v171
    v_and_b32 v87, 0xffff0000, v171
    v_lshlrev_b32 v88, 16, v172
    v_and_b32 v89, 0xffff0000, v172
    v_lshlrev_b32 v90, 16, v173
    v_and_b32 v91, 0xffff0000, v173
    v_lshlrev_b32 v92, 16, v174
    v_and_b32 v93, 0xffff0000, v174
    v_lshlrev_b32 v94, 16, v175
    v_and_b32 v95, 0xffff0000, v175
    v_lshlrev_b32 v96, 16, v176
    v_and_b32 v97, 0xffff0000, v176
    v_lshlrev_b32 v98, 16, v177
    v_and_b32 v99, 0xffff0000, v177
    v_lshlrev_b32 v100, 16, v178
    v_and_b32 v101, 0xffff0000, v178
    v_lshlrev_b32 v102, 16, v179
    v_and_b32 v103, 0xffff0000, v179
    v_lshlrev_b32 v104, 16, v180
    v_and_b32 v105, 0xffff0000, v180
    v_lshlrev_b32 v106, 16, v181
    v_and_b32 v107, 0xffff0000, v181
    v_lshlrev_b32 v108, 16, v182
    v_and_b32 v109, 0xffff0000, v182
    v_lshlrev_b32 v110, 16, v183
    v_and_b32 v111, 0xffff0000, v183
    v_lshlrev_b32 v112, 16, v184
    v_and_b32 v113, 0xffff0000, v184
    v_lshlrev_b32 v114, 16, v185
    v_and_b32 v115, 0xffff0000, v185
    v_lshlrev_b32 v116, 16, v186
    v_and_b32 v117, 0xffff0000, v186
    v_lshlrev_b32 v118, 16, v187
    v_and_b32 v119, 0xffff0000, v187
    v_lshlrev_b32 v120, 16, v188
    v_and_b32 v121, 0xffff0000, v188
    v_lshlrev_b32 v122, 16, v189
    v_and_b32 v123, 0xffff0000, v189
    v_lshlrev_b32 v124, 16, v190
    v_and_b32 v125, 0xffff0000, v190
    v_lshlrev_b32 v126, 16, v191
    v_and_b32 v127, 0xffff0000, v191
    v_lshlrev_b32 v128, 16, v192
    v_and_b32 v129, 0xffff0000, v192
    v_lshlrev_b32 v130, 16, v193
    v_and_b32 v131, 0xffff0000, v193
    v_lshlrev_b32 v132, 16, v194
    v_and_b32 v133, 0xffff0000, v194
    v_lshlrev_b32 v134, 16, v195
    v_and_b32 v135, 0xffff0000, v195
    v_lshlrev_b32 v136, 16, v196
    v_and_b32 v137, 0xffff0000, v196
    v_lshlrev_b32 v138, 16, v197
    v_and_b32 v139, 0xffff0000, v197
    v_lshlrev_b32 v140, 16, v198
    v_and_b32 v141, 0xffff0000, v198
    v_lshlrev_b32 v142, 16, v199
    v_and_b32 v143, 0xffff0000, v199
    v_lshlrev_b32 v144, 16, v200
    v_and_b32 v145, 0xffff0000, v200
    v_lshlrev_b32 v146, 16, v201
    v_and_b32 v147, 0xffff0000, v201
    v_lshlrev_b32 v148, 16, v202
    v_and_b32 v149, 0xffff0000, v202
    v_lshlrev_b32 v150, 16, v203
    v_and_b32 v151, 0xffff0000, v203
    v_lshlrev_b32 v152, 16, v204
    v_and_b32 v153, 0xffff0000, v204
    v_lshlrev_b32 v154, 16, v205
    v_and_b32 v155, 0xffff0000, v205
    v_lshlrev_b32 v156, 16, v206
    v_and_b32 v157, 0xffff0000, v206
    v_lshlrev_b32 v158, 16, v207
    v_and_b32 v159, 0xffff0000, v207
    v_pk_mul_f32 v[160:161], v[64:65], v[64:65]
    v_pk_mul_f32 v[162:163], v[66:67], v[66:67]
    v_pk_mul_f32 v[164:165], v[68:69], v[68:69]
    v_pk_mul_f32 v[166:167], v[70:71], v[70:71]
    v_pk_mul_f32 v[168:169], v[72:73], v[72:73]
    v_pk_mul_f32 v[170:171], v[74:75], v[74:75]
    v_pk_mul_f32 v[172:173], v[76:77], v[76:77]
    v_pk_mul_f32 v[174:175], v[78:79], v[78:79]
    v_pk_fma_f32 v[160:161], v[160:161], v[50:51], v[52:53]
    v_pk_fma_f32 v[162:163], v[162:163], v[50:51], v[52:53]
    v_pk_fma_f32 v[164:165], v[164:165], v[50:51], v[52:53]
    v_pk_fma_f32 v[166:167], v[166:167], v[50:51], v[52:53]
    v_pk_fma_f32 v[168:169], v[168:169], v[50:51], v[52:53]
    v_pk_fma_f32 v[170:171], v[170:171], v[50:51], v[52:53]
    v_pk_fma_f32 v[172:173], v[172:173], v[50:51], v[52:53]
    v_pk_fma_f32 v[174:175], v[174:175], v[50:51], v[52:53]
    v_pk_mul_f32 v[160:161], v[160:161], v[64:65]
    v_pk_mul_f32 v[162:163], v[162:163], v[66:67]
    v_pk_mul_f32 v[164:165], v[164:165], v[68:69]
    v_pk_mul_f32 v[166:167], v[166:167], v[70:71]
    v_pk_mul_f32 v[168:169], v[168:169], v[72:73]
    v_pk_mul_f32 v[170:171], v[170:171], v[74:75]
    v_pk_mul_f32 v[172:173], v[172:173], v[76:77]
    v_pk_mul_f32 v[174:175], v[174:175], v[78:79]
    v_pk_mul_f32 v[160:161], v[160:161], v[48:49]
    v_pk_mul_f32 v[162:163], v[162:163], v[48:49]
    v_pk_mul_f32 v[164:165], v[164:165], v[48:49]
    v_pk_mul_f32 v[166:167], v[166:167], v[48:49]
    v_pk_mul_f32 v[168:169], v[168:169], v[48:49]
    v_pk_mul_f32 v[170:171], v[170:171], v[48:49]
    v_pk_mul_f32 v[172:173], v[172:173], v[48:49]
    v_pk_mul_f32 v[174:175], v[174:175], v[48:49]
    v_pk_mul_f32 v[176:177], v[96:97], v[96:97]
    v_pk_mul_f32 v[178:179], v[98:99], v[98:99]
    v_pk_mul_f32 v[180:181], v[100:101], v[100:101]
    v_pk_mul_f32 v[182:183], v[102:103], v[102:103]
    v_pk_mul_f32 v[184:185], v[104:105], v[104:105]
    v_pk_mul_f32 v[186:187], v[106:107], v[106:107]
    v_pk_mul_f32 v[188:189], v[108:109], v[108:109]
    v_pk_mul_f32 v[190:191], v[110:111], v[110:111]
    v_pk_fma_f32 v[176:177], v[176:177], v[50:51], v[52:53]
    v_pk_fma_f32 v[178:179], v[178:179], v[50:51], v[52:53]
    v_pk_fma_f32 v[180:181], v[180:181], v[50:51], v[52:53]
    v_pk_fma_f32 v[182:183], v[182:183], v[50:51], v[52:53]
    v_pk_fma_f32 v[184:185], v[184:185], v[50:51], v[52:53]
    v_pk_fma_f32 v[186:187], v[186:187], v[50:51], v[52:53]
    v_pk_fma_f32 v[188:189], v[188:189], v[50:51], v[52:53]
    v_pk_fma_f32 v[190:191], v[190:191], v[50:51], v[52:53]
    v_pk_mul_f32 v[176:177], v[176:177], v[96:97]
    v_pk_mul_f32 v[178:179], v[178:179], v[98:99]
    v_pk_mul_f32 v[180:181], v[180:181], v[100:101]
    v_pk_mul_f32 v[182:183], v[182:183], v[102:103]
    v_pk_mul_f32 v[184:185], v[184:185], v[104:105]
    v_pk_mul_f32 v[186:187], v[186:187], v[106:107]
    v_pk_mul_f32 v[188:189], v[188:189], v[108:109]
    v_pk_mul_f32 v[190:191], v[190:191], v[110:111]
    v_pk_mul_f32 v[176:177], v[176:177], v[48:49]
    v_pk_mul_f32 v[178:179], v[178:179], v[48:49]
    v_pk_mul_f32 v[180:181], v[180:181], v[48:49]
    v_pk_mul_f32 v[182:183], v[182:183], v[48:49]
    v_pk_mul_f32 v[184:185], v[184:185], v[48:49]
    v_pk_mul_f32 v[186:187], v[186:187], v[48:49]
    v_pk_mul_f32 v[188:189], v[188:189], v[48:49]
    v_pk_mul_f32 v[190:191], v[190:191], v[48:49]
    v_pk_mul_f32 v[192:193], v[128:129], v[128:129]
    v_pk_mul_f32 v[194:195], v[130:131], v[130:131]
    v_pk_mul_f32 v[196:197], v[132:133], v[132:133]
    v_pk_mul_f32 v[198:199], v[134:135], v[134:135]
    v_pk_mul_f32 v[200:201], v[136:137], v[136:137]
    v_pk_mul_f32 v[202:203], v[138:139], v[138:139]
    v_pk_mul_f32 v[204:205], v[140:141], v[140:141]
    v_pk_mul_f32 v[206:207], v[142:143], v[142:143]
    v_pk_fma_f32 v[192:193], v[192:193], v[50:51], v[52:53]
    v_pk_fma_f32 v[194:195], v[194:195], v[50:51], v[52:53]
    v_pk_fma_f32 v[196:197], v[196:197], v[50:51], v[52:53]
    v_pk_fma_f32 v[198:199], v[198:199], v[50:51], v[52:53]
    v_pk_fma_f32 v[200:201], v[200:201], v[50:51], v[52:53]
    v_pk_fma_f32 v[202:203], v[202:203], v[50:51], v[52:53]
    v_pk_fma_f32 v[204:205], v[204:205], v[50:51], v[52:53]
    v_pk_fma_f32 v[206:207], v[206:207], v[50:51], v[52:53]
    v_pk_mul_f32 v[192:193], v[192:193], v[128:129]
    v_pk_mul_f32 v[194:195], v[194:195], v[130:131]
    v_pk_mul_f32 v[196:197], v[196:197], v[132:133]
    v_pk_mul_f32 v[198:199], v[198:199], v[134:135]
    v_pk_mul_f32 v[200:201], v[200:201], v[136:137]
    v_pk_mul_f32 v[202:203], v[202:203], v[138:139]
    v_pk_mul_f32 v[204:205], v[204:205], v[140:141]
    v_pk_mul_f32 v[206:207], v[206:207], v[142:143]
    v_pk_mul_f32 v[192:193], v[192:193], v[48:49]
    v_pk_mul_f32 v[194:195], v[194:195], v[48:49]
    v_pk_mul_f32 v[196:197], v[196:197], v[48:49]
    v_pk_mul_f32 v[198:199], v[198:199], v[48:49]
    v_pk_mul_f32 v[200:201], v[200:201], v[48:49]
    v_pk_mul_f32 v[202:203], v[202:203], v[48:49]
    v_pk_mul_f32 v[204:205], v[204:205], v[48:49]
    v_pk_mul_f32 v[206:207], v[206:207], v[48:49]
    v_exp_f32 v160, v160
    v_exp_f32 v161, v161
    v_exp_f32 v162, v162
    v_exp_f32 v163, v163
    v_exp_f32 v164, v164
    v_exp_f32 v165, v165
    v_exp_f32 v166, v166
    v_exp_f32 v167, v167
    v_exp_f32 v168, v168
    v_exp_f32 v169, v169
    v_exp_f32 v170, v170
    v_exp_f32 v171, v171
    v_exp_f32 v172, v172
    v_exp_f32 v173, v173
    v_exp_f32 v174, v174
    v_exp_f32 v175, v175
    v_exp_f32 v176, v176
    v_exp_f32 v177, v177
    v_exp_f32 v178, v178
    v_exp_f32 v179, v179
    v_exp_f32 v180, v180
    v_exp_f32 v181, v181
    v_exp_f32 v182, v182
    v_exp_f32 v183, v183
    v_exp_f32 v184, v184
    v_exp_f32 v185, v185
    v_exp_f32 v186, v186
    v_exp_f32 v187, v187
    v_exp_f32 v188, v188
    v_exp_f32 v189, v189
    v_exp_f32 v190, v190
    v_exp_f32 v191, v191
    v_exp_f32 v192, v192
    v_exp_f32 v193, v193
    v_exp_f32 v194, v194
    v_exp_f32 v195, v195
    v_exp_f32 v196, v196
    v_exp_f32 v197, v197
    v_exp_f32 v198, v198
    v_exp_f32 v199, v199
    v_exp_f32 v200, v200
    v_exp_f32 v201, v201
    v_exp_f32 v202, v202
    v_exp_f32 v203, v203
    v_exp_f32 v204, v204
    v_exp_f32 v205, v205
    v_exp_f32 v206, v206
    v_exp_f32 v207, v207
    s_nop 0
    v_pk_add_f32 v[160:161], v[160:161], v[52:53]
    v_pk_add_f32 v[162:163], v[162:163], v[52:53]
    v_pk_add_f32 v[164:165], v[164:165], v[52:53]
    v_pk_add_f32 v[166:167], v[166:167], v[52:53]
    v_pk_add_f32 v[168:169], v[168:169], v[52:53]
    v_pk_add_f32 v[170:171], v[170:171], v[52:53]
    v_pk_add_f32 v[172:173], v[172:173], v[52:53]
    v_pk_add_f32 v[174:175], v[174:175], v[52:53]
    v_pk_add_f32 v[176:177], v[176:177], v[52:53]
    v_pk_add_f32 v[178:179], v[178:179], v[52:53]
    v_pk_add_f32 v[180:181], v[180:181], v[52:53]
    v_pk_add_f32 v[182:183], v[182:183], v[52:53]
    v_pk_add_f32 v[184:185], v[184:185], v[52:53]
    v_pk_add_f32 v[186:187], v[186:187], v[52:53]
    v_pk_add_f32 v[188:189], v[188:189], v[52:53]
    v_pk_add_f32 v[190:191], v[190:191], v[52:53]
    v_pk_add_f32 v[192:193], v[192:193], v[52:53]
    v_pk_add_f32 v[194:195], v[194:195], v[52:53]
    v_pk_add_f32 v[196:197], v[196:197], v[52:53]
    v_pk_add_f32 v[198:199], v[198:199], v[52:53]
    v_pk_add_f32 v[200:201], v[200:201], v[52:53]
    v_pk_add_f32 v[202:203], v[202:203], v[52:53]
    v_pk_add_f32 v[204:205], v[204:205], v[52:53]
    v_pk_add_f32 v[206:207], v[206:207], v[52:53]
    v_rcp_f32 v160, v160
    v_rcp_f32 v161, v161
    v_rcp_f32 v162, v162
    v_rcp_f32 v163, v163
    v_rcp_f32 v164, v164
    v_rcp_f32 v165, v165
    v_rcp_f32 v166, v166
    v_rcp_f32 v167, v167
    v_rcp_f32 v168, v168
    v_rcp_f32 v169, v169
    v_rcp_f32 v170, v170
    v_rcp_f32 v171, v171
    v_rcp_f32 v172, v172
    v_rcp_f32 v173, v173
    v_rcp_f32 v174, v174
    v_rcp_f32 v175, v175
    v_rcp_f32 v176, v176
    v_rcp_f32 v177, v177
    v_rcp_f32 v178, v178
    v_rcp_f32 v179, v179
    v_rcp_f32 v180, v180
    v_rcp_f32 v181, v181
    v_rcp_f32 v182, v182
    v_rcp_f32 v183, v183
    v_rcp_f32 v184, v184
    v_rcp_f32 v185, v185
    v_rcp_f32 v186, v186
    v_rcp_f32 v187, v187
    v_rcp_f32 v188, v188
    v_rcp_f32 v189, v189
    v_rcp_f32 v190, v190
    v_rcp_f32 v191, v191
    v_rcp_f32 v192, v192
    v_rcp_f32 v193, v193
    v_rcp_f32 v194, v194
    v_rcp_f32 v195, v195
    v_rcp_f32 v196, v196
    v_rcp_f32 v197, v197
    v_rcp_f32 v198, v198
    v_rcp_f32 v199, v199
    v_rcp_f32 v200, v200
    v_rcp_f32 v201, v201
    v_rcp_f32 v202, v202
    v_rcp_f32 v203, v203
    v_rcp_f32 v204, v204
    v_rcp_f32 v205, v205
    v_rcp_f32 v206, v206
    v_rcp_f32 v207, v207
    s_nop 0
    v_pk_mul_f32 v[160:161], v[160:161], v[64:65]
    v_pk_mul_f32 v[162:163], v[162:163], v[66:67]
    v_pk_mul_f32 v[164:165], v[164:165], v[68:69]
    v_pk_mul_f32 v[166:167], v[166:167], v[70:71]
    v_pk_mul_f32 v[168:169], v[168:169], v[72:73]
    v_pk_mul_f32 v[170:171], v[170:171], v[74:75]
    v_pk_mul_f32 v[172:173], v[172:173], v[76:77]
    v_pk_mul_f32 v[174:175], v[174:175], v[78:79]
    v_pk_mul_f32 v[176:177], v[176:177], v[96:97]
    v_pk_mul_f32 v[178:179], v[178:179], v[98:99]
    v_pk_mul_f32 v[180:181], v[180:181], v[100:101]
    v_pk_mul_f32 v[182:183], v[182:183], v[102:103]
    v_pk_mul_f32 v[184:185], v[184:185], v[104:105]
    v_pk_mul_f32 v[186:187], v[186:187], v[106:107]
    v_pk_mul_f32 v[188:189], v[188:189], v[108:109]
    v_pk_mul_f32 v[190:191], v[190:191], v[110:111]
    v_pk_mul_f32 v[192:193], v[192:193], v[128:129]
    v_pk_mul_f32 v[194:195], v[194:195], v[130:131]
    v_pk_mul_f32 v[196:197], v[196:197], v[132:133]
    v_pk_mul_f32 v[198:199], v[198:199], v[134:135]
    v_pk_mul_f32 v[200:201], v[200:201], v[136:137]
    v_pk_mul_f32 v[202:203], v[202:203], v[138:139]
    v_pk_mul_f32 v[204:205], v[204:205], v[140:141]
    v_pk_mul_f32 v[206:207], v[206:207], v[142:143]
    v_cvt_pk_bf16_f32 v16, v160, v161
    v_cvt_pk_bf16_f32 v17, v162, v163
    v_cvt_pk_bf16_f32 v18, v164, v165
    v_cvt_pk_bf16_f32 v19, v166, v167
    v_cvt_pk_bf16_f32 v20, v168, v169
    v_cvt_pk_bf16_f32 v21, v170, v171
    v_cvt_pk_bf16_f32 v22, v172, v173
    v_cvt_pk_bf16_f32 v23, v174, v175
    v_cvt_pk_bf16_f32 v24, v176, v177
    v_cvt_pk_bf16_f32 v25, v178, v179
    v_cvt_pk_bf16_f32 v26, v180, v181
    v_cvt_pk_bf16_f32 v27, v182, v183
    v_cvt_pk_bf16_f32 v28, v184, v185
    v_cvt_pk_bf16_f32 v29, v186, v187
    v_cvt_pk_bf16_f32 v30, v188, v189
    v_cvt_pk_bf16_f32 v31, v190, v191
    v_cvt_pk_bf16_f32 v32, v192, v193
    v_cvt_pk_bf16_f32 v33, v194, v195
    v_cvt_pk_bf16_f32 v34, v196, v197
    v_cvt_pk_bf16_f32 v35, v198, v199
    v_cvt_pk_bf16_f32 v36, v200, v201
    v_cvt_pk_bf16_f32 v37, v202, v203
    v_cvt_pk_bf16_f32 v38, v204, v205
    v_cvt_pk_bf16_f32 v39, v206, v207
    v_lshlrev_b32 v160, 16, v16
    v_and_b32 v161, 0xffff0000, v16
    v_lshlrev_b32 v162, 16, v17
    v_and_b32 v163, 0xffff0000, v17
    v_lshlrev_b32 v164, 16, v18
    v_and_b32 v165, 0xffff0000, v18
    v_lshlrev_b32 v166, 16, v19
    v_and_b32 v167, 0xffff0000, v19
    v_lshlrev_b32 v168, 16, v20
    v_and_b32 v169, 0xffff0000, v20
    v_lshlrev_b32 v170, 16, v21
    v_and_b32 v171, 0xffff0000, v21
    v_lshlrev_b32 v172, 16, v22
    v_and_b32 v173, 0xffff0000, v22
    v_lshlrev_b32 v174, 16, v23
    v_and_b32 v175, 0xffff0000, v23
    v_lshlrev_b32 v176, 16, v24
    v_and_b32 v177, 0xffff0000, v24
    v_lshlrev_b32 v178, 16, v25
    v_and_b32 v179, 0xffff0000, v25
    v_lshlrev_b32 v180, 16, v26
    v_and_b32 v181, 0xffff0000, v26
    v_lshlrev_b32 v182, 16, v27
    v_and_b32 v183, 0xffff0000, v27
    v_lshlrev_b32 v184, 16, v28
    v_and_b32 v185, 0xffff0000, v28
    v_lshlrev_b32 v186, 16, v29
    v_and_b32 v187, 0xffff0000, v29
    v_lshlrev_b32 v188, 16, v30
    v_and_b32 v189, 0xffff0000, v30
    v_lshlrev_b32 v190, 16, v31
    v_and_b32 v191, 0xffff0000, v31
    v_lshlrev_b32 v192, 16, v32
    v_and_b32 v193, 0xffff0000, v32
    v_lshlrev_b32 v194, 16, v33
    v_and_b32 v195, 0xffff0000, v33
    v_lshlrev_b32 v196, 16, v34
    v_and_b32 v197, 0xffff0000, v34
    v_lshlrev_b32 v198, 16, v35
    v_and_b32 v199, 0xffff0000, v35
    v_lshlrev_b32 v200, 16, v36
    v_and_b32 v201, 0xffff0000, v36
    v_lshlrev_b32 v202, 16, v37
    v_and_b32 v203, 0xffff0000, v37
    v_lshlrev_b32 v204, 16, v38
    v_and_b32 v205, 0xffff0000, v38
    v_lshlrev_b32 v206, 16, v39
    v_and_b32 v207, 0xffff0000, v39
    v_pk_mul_f32 v[160:161], v[160:161], v[80:81]
    v_pk_mul_f32 v[162:163], v[162:163], v[82:83]
    v_pk_mul_f32 v[164:165], v[164:165], v[84:85]
    v_pk_mul_f32 v[166:167], v[166:167], v[86:87]
    v_pk_mul_f32 v[168:169], v[168:169], v[88:89]
    v_pk_mul_f32 v[170:171], v[170:171], v[90:91]
    v_pk_mul_f32 v[172:173], v[172:173], v[92:93]
    v_pk_mul_f32 v[174:175], v[174:175], v[94:95]
    v_pk_mul_f32 v[176:177], v[176:177], v[112:113]
    v_pk_mul_f32 v[178:179], v[178:179], v[114:115]
    v_pk_mul_f32 v[180:181], v[180:181], v[116:117]
    v_pk_mul_f32 v[182:183], v[182:183], v[118:119]
    v_pk_mul_f32 v[184:185], v[184:185], v[120:121]
    v_pk_mul_f32 v[186:187], v[186:187], v[122:123]
    v_pk_mul_f32 v[188:189], v[188:189], v[124:125]
    v_pk_mul_f32 v[190:191], v[190:191], v[126:127]
    v_pk_mul_f32 v[192:193], v[192:193], v[144:145]
    v_pk_mul_f32 v[194:195], v[194:195], v[146:147]
    v_pk_mul_f32 v[196:197], v[196:197], v[148:149]
    v_pk_mul_f32 v[198:199], v[198:199], v[150:151]
    v_pk_mul_f32 v[200:201], v[200:201], v[152:153]
    v_pk_mul_f32 v[202:203], v[202:203], v[154:155]
    v_pk_mul_f32 v[204:205], v[204:205], v[156:157]
    v_pk_mul_f32 v[206:207], v[206:207], v[158:159]
    v_cvt_pk_bf16_f32 v16, v160, v161
    v_cvt_pk_bf16_f32 v17, v162, v163
    v_cvt_pk_bf16_f32 v18, v164, v165
    v_cvt_pk_bf16_f32 v19, v166, v167
    v_cvt_pk_bf16_f32 v20, v168, v169
    v_cvt_pk_bf16_f32 v21, v170, v171
    v_cvt_pk_bf16_f32 v22, v172, v173
    v_cvt_pk_bf16_f32 v23, v174, v175
    v_cvt_pk_bf16_f32 v24, v176, v177
    v_cvt_pk_bf16_f32 v25, v178, v179
    v_cvt_pk_bf16_f32 v26, v180, v181
    v_cvt_pk_bf16_f32 v27, v182, v183
    v_cvt_pk_bf16_f32 v28, v184, v185
    v_cvt_pk_bf16_f32 v29, v186, v187
    v_cvt_pk_bf16_f32 v30, v188, v189
    v_cvt_pk_bf16_f32 v31, v190, v191
    v_cvt_pk_bf16_f32 v32, v192, v193
    v_cvt_pk_bf16_f32 v33, v194, v195
    v_cvt_pk_bf16_f32 v34, v196, v197
    v_cvt_pk_bf16_f32 v35, v198, v199
    v_cvt_pk_bf16_f32 v36, v200, v201
    v_cvt_pk_bf16_f32 v37, v202, v203
    v_cvt_pk_bf16_f32 v38, v204, v205
    v_cvt_pk_bf16_f32 v39, v206, v207
    buffer_store_dwordx2 v[16:17], v5, s[32:35], s47 offen offset:0
    buffer_store_dwordx2 v[18:19], v5, s[32:35], s47 offen offset:16
    buffer_store_dwordx2 v[20:21], v5, s[32:35], s47 offen offset:32
    buffer_store_dwordx2 v[22:23], v5, s[32:35], s47 offen offset:48
    s_add_u32 s47, s47, 4096
    buffer_store_dwordx2 v[24:25], v5, s[32:35], s47 offen offset:0
    buffer_store_dwordx2 v[26:27], v5, s[32:35], s47 offen offset:16
    buffer_store_dwordx2 v[28:29], v5, s[32:35], s47 offen offset:32
    buffer_store_dwordx2 v[30:31], v5, s[32:35], s47 offen offset:48
    s_add_u32 s47, s47, 4096
    buffer_store_dwordx2 v[32:33], v5, s[32:35], s47 offen offset:0
    buffer_store_dwordx2 v[34:35], v5, s[32:35], s47 offen offset:16
    buffer_store_dwordx2 v[36:37], v5, s[32:35], s47 offen offset:32
    buffer_store_dwordx2 v[38:39], v5, s[32:35], s47 offen offset:48
    s_add_u32 s47, s47, 4096
    s_load_dwordx2 s[4:5], s[0:1], 24
    s_load_dwordx2 s[6:7], s[0:1], 56
    v_subrev_u32 v7, 256, v0
    v_add_u32 v9, 0, v7
    v_min_u32 v9, 319, v9
    v_mul_u32_u24 v10, 6554, v9
    v_lshrrev_b32 v10, 16, v10
    v_mul_u32_u24 v11, 10, v10
    v_sub_u32 v11, v9, v11
    v_bfe_u32 v12, v10, 2, 2
    v_lshlrev_b32 v12, 3, v12
    v_lshrrev_b32 v13, 4, v10
    v_lshlrev_b32 v13, 2, v13
    v_and_b32 v14, 3, v10
    v_add3_u32 v12, v12, v13, v14
    v_mul_u32_u24 v12, 1280, v12
    v_lshl_add_u32 v60, v11, 4, v12
    v_lshlrev_b32 v62, 4, v9
    v_add_u32 v9, 256, v7
    v_min_u32 v9, 319, v9
    v_mul_u32_u24 v10, 6554, v9
    v_lshrrev_b32 v10, 16, v10
    v_mul_u32_u24 v11, 10, v10
    v_sub_u32 v11, v9, v11
    v_bfe_u32 v12, v10, 2, 2
    v_lshlrev_b32 v12, 3, v12
    v_lshrrev_b32 v13, 4, v10
    v_lshlrev_b32 v13, 2, v13
    v_and_b32 v14, 3, v10
    v_add3_u32 v12, v12, v13, v14
    v_mul_u32_u24 v12, 1280, v12
    v_lshl_add_u32 v61, v11, 4, v12
    v_lshlrev_b32 v63, 4, v9
    s_waitcnt lgkmcnt(0)
    s_mov_b32 s23, 0x00020000
    s_add_u32 s43, s2, 0
    s_min_u32 s43, s43, 543
    s_lshr_b32 s44, s43, 3
    s_and_b32 s46, s43, 7
    s_cmp_lt_u32 s44, 20
    s_cselect_b32 s20, s4, s6
    s_cselect_b32 s21, s5, s7
    s_cselect_b32 s47, 0, 20
    s_and_b32 s21, s21, 0xffff
    s_mov_b32 s22, 1966080
    s_sub_u32 s47, s44, s47
    s_mul_i32 s47, s47, 40960
    s_mul_i32 s43, s46, 160
    s_add_u32 s47, s47, s43
    buffer_load_dwordx4 v[64:67], v60, s[20:23], s47 offen
    buffer_load_dwordx4 v[68:71], v61, s[20:23], s47 offen
    s_mul_i32 s43, s46, 68
    s_add_u32 s43, s43, s44
    s_mul_i32 s43, s43, 5120
    s_add_u32 s68, s43, 20971520
    s_add_u32 s43, s2, 256
    s_min_u32 s43, s43, 543
    s_lshr_b32 s44, s43, 3
    s_and_b32 s46, s43, 7
    s_cmp_lt_u32 s44, 20
    s_cselect_b32 s20, s4, s6
    s_cselect_b32 s21, s5, s7
    s_cselect_b32 s47, 0, 20
    s_and_b32 s21, s21, 0xffff
    s_mov_b32 s22, 1966080
    s_sub_u32 s47, s44, s47
    s_mul_i32 s47, s47, 40960
    s_mul_i32 s43, s46, 160
    s_add_u32 s47, s47, s43
    buffer_load_dwordx4 v[72:75], v60, s[20:23], s47 offen
    buffer_load_dwordx4 v[76:79], v61, s[20:23], s47 offen
    s_mul_i32 s43, s46, 68
    s_add_u32 s43, s43, s44
    s_mul_i32 s43, s43, 5120
    s_add_u32 s69, s43, 20971520
    s_add_u32 s43, s2, 512
    s_min_u32 s43, s43, 543
    s_lshr_b32 s44, s43, 3
    s_and_b32 s46, s43, 7
    s_cmp_lt_u32 s44, 20
    s_cselect_b32 s20, s4, s6
    s_cselect_b32 s21, s5, s7
    s_cselect_b32 s47, 0, 20
    s_and_b32 s21, s21, 0xffff
    s_mov_b32 s22, 1966080
    s_sub_u32 s47, s44, s47
    s_mul_i32 s47, s47, 40960
    s_mul_i32 s43, s46, 160
    s_add_u32 s47, s47, s43
    buffer_load_dwordx4 v[80:83], v60, s[20:23], s47 offen
    buffer_load_dwordx4 v[84:87], v61, s[20:23], s47 offen
    s_mul_i32 s43, s46, 68
    s_add_u32 s43, s43, s44
    s_mul_i32 s43, s43, 5120
    s_add_u32 s70, s43, 20971520
    s_waitcnt vmcnt(4)
    buffer_store_dwordx4 v[64:67], v62, s[32:35], s68 offen
    buffer_store_dwordx4 v[68:71], v63, s[32:35], s68 offen
    s_waitcnt vmcnt(4)
    buffer_store_dwordx4 v[72:75], v62, s[32:35], s69 offen
    buffer_store_dwordx4 v[76:79], v63, s[32:35], s69 offen
    s_waitcnt vmcnt(4)
    buffer_store_dwordx4 v[80:83], v62, s[32:35], s70 offen
    buffer_store_dwordx4 v[84:87], v63, s[32:35], s70 offen
    s_mul_i32 s46, s42, 122880
    s_add_u32 s46, s46, 9437184
    v_lshlrev_b32 v8, 3, v1
    s_add_u32 s54, s40, 0
    s_min_u32 s54, s54, 14
    s_lshl_b32 s62, s54, 9
    s_add_u32 s62, s62, s46
    s_mul_i32 s55, s54, 11
    s_lshr_b32 s55, s55, 5
    s_mul_i32 s56, s55, 3
    s_sub_u32 s56, s54, s56
    s_lshl_b32 s55, s55, 4
    s_lshl_b32 s56, s56, 4
    v_and_b32 v39, 15, v1
    v_add_u32 v39, s56, v39
    v_lshrrev_b32 v40, 4, v1
    v_lshlrev_b32 v40, 2, v40
    v_add_u32 v40, s55, v40
    v_cmp_le_u32 vcc, 40, v40
    s_nop 1
    v_cndmask_b32 v41, 0, 1, vcc
    v_mul_u32_u24 v42, 40, v41
    v_sub_u32 v40, v40, v42
    v_mul_u32_u24 v42, 20, v41
    v_sub_u32 v42, v39, v42
    v_cmp_gt_u32 s[64:65], 20, v42
    v_cmp_eq_u32 s[48:49], 40, v39
    s_nop 1
    v_cndmask_b32 v42, v42, 20, s[48:49]
    s_or_b64 s[64:65], s[64:65], s[48:49]
    v_lshrrev_b32 v43, 2, v42
    v_lshlrev_b32 v43, 3, v43
    v_lshl_add_u32 v43, v41, 2, v43
    v_and_b32 v44, 3, v42
    v_add_u32 v43, v43, v44
    v_mul_u32_u24 v43, 160, v43
    v_lshrrev_b32 v44, 3, v40
    v_lshlrev_b32 v44, 4, v44
    v_lshl_add_u32 v44, v41, 3, v44
    v_and_b32 v45, 7, v40
    v_add_u32 v44, v44, v45
    v_lshl_add_u32 v43, v44, 1, v43
    v_add_u32 v36, 131072, v43
    s_add_u32 s54, s40, 8
    s_min_u32 s54, s54, 14
    s_lshl_b32 s63, s54, 9
    s_add_u32 s63, s63, s46
    s_mul_i32 s55, s54, 11
    s_lshr_b32 s55, s55, 5
    s_mul_i32 s56, s55, 3
    s_sub_u32 s56, s54, s56
    s_lshl_b32 s55, s55, 4
    s_lshl_b32 s56, s56, 4
    v_and_b32 v39, 15, v1
    v_add_u32 v39, s56, v39
    v_lshrrev_b32 v40, 4, v1
    v_lshlrev_b32 v40, 2, v40
    v_add_u32 v40, s55, v40
    v_cmp_le_u32 vcc, 40, v40
    s_nop 1
    v_cndmask_b32 v41, 0, 1, vcc
    v_mul_u32_u24 v42, 40, v41
    v_sub_u32 v40, v40, v42
    v_mul_u32_u24 v42, 20, v41
    v_sub_u32 v42, v39, v42
    v_cmp_gt_u32 s[66:67], 20, v42
    v_cmp_eq_u32 s[48:49], 40, v39
    s_nop 1
    v_cndmask_b32 v42, v42, 20, s[48:49]
    s_or_b64 s[66:67], s[66:67], s[48:49]
    v_lshrrev_b32 v43, 2, v42
    v_lshlrev_b32 v43, 3, v43
    v_lshl_add_u32 v43, v41, 2, v43
    v_and_b32 v44, 3, v42
    v_add_u32 v43, v43, v44
    v_mul_u32_u24 v43, 160, v43
    v_lshrrev_b32 v44, 3, v40
    v_lshlrev_b32 v44, 4, v44
    v_lshl_add_u32 v44, v41, 3, v44
    v_and_b32 v45, 7, v40
    v_add_u32 v44, v44, v45
    v_lshl_add_u32 v43, v44, 1, v43
    v_add_u32 v37, 131072, v43
    s_barrier
    buffer_load_dwordx2 v[106:107], v8, s[32:35], s62 offen sc1
    s_add_u32 s62, s62, 7680
    buffer_load_dwordx2 v[110:111], v8, s[32:35], s62 offen sc1
    s_add_u32 s62, s62, 7680
    buffer_load_dwordx2 v[114:115], v8, s[32:35], s62 offen sc1
    s_add_u32 s62, s62, 7680
    buffer_load_dwordx2 v[118:119], v8, s[32:35], s62 offen sc1
    s_add_u32 s62, s62, 7680
    buffer_load_dwordx2 v[122:123], v8, s[32:35], s62 offen sc1
    s_add_u32 s62, s62, 7680
    buffer_load_dwordx2 v[126:127], v8, s[32:35], s62 offen sc1
    s_add_u32 s62, s62, 7680
    buffer_load_dwordx2 v[130:131], v8, s[32:35], s62 offen sc1
    s_add_u32 s62, s62, 7680
    buffer_load_dwordx2 v[134:135], v8, s[32:35], s62 offen sc1
    s_add_u32 s62, s62, 7680
    buffer_load_dwordx2 v[138:139], v8, s[32:35], s62 offen sc1
    s_add_u32 s62, s62, 7680
    buffer_load_dwordx2 v[142:143], v8, s[32:35], s62 offen sc1
    s_add_u32 s62, s62, 7680
    buffer_load_dwordx2 v[146:147], v8, s[32:35], s62 offen sc1
    s_add_u32 s62, s62, 7680
    buffer_load_dwordx2 v[150:151], v8, s[32:35], s62 offen sc1
    s_add_u32 s62, s62, 7680
    buffer_load_dwordx2 v[154:155], v8, s[32:35], s62 offen sc1
    s_add_u32 s62, s62, 7680
    buffer_load_dwordx2 v[158:159], v8, s[32:35], s62 offen sc1
    s_add_u32 s62, s62, 7680
    buffer_load_dwordx2 v[162:163], v8, s[32:35], s62 offen sc1
    s_add_u32 s62, s62, 7680
    buffer_load_dwordx2 v[166:167], v8, s[32:35], s62 offen sc1
    buffer_load_dwordx2 v[170:171], v8, s[32:35], s63 offen sc1
    s_add_u32 s63, s63, 7680
    buffer_load_dwordx2 v[174:175], v8, s[32:35], s63 offen sc1
    s_add_u32 s63, s63, 7680
    buffer_load_dwordx2 v[178:179], v8, s[32:35], s63 offen sc1
    s_add_u32 s63, s63, 7680
    buffer_load_dwordx2 v[182:183], v8, s[32:35], s63 offen sc1
    s_add_u32 s63, s63, 7680
    buffer_load_dwordx2 v[186:187], v8, s[32:35], s63 offen sc1
    s_add_u32 s63, s63, 7680
    buffer_load_dwordx2 v[190:191], v8, s[32:35], s63 offen sc1
    s_add_u32 s63, s63, 7680
    buffer_load_dwordx2 v[194:195], v8, s[32:35], s63 offen sc1
    s_add_u32 s63, s63, 7680
    buffer_load_dwordx2 v[198:199], v8, s[32:35], s63 offen sc1
    s_add_u32 s63, s63, 7680
    buffer_load_dwordx2 v[202:203], v8, s[32:35], s63 offen sc1
    s_add_u32 s63, s63, 7680
    buffer_load_dwordx2 v[206:207], v8, s[32:35], s63 offen sc1
    s_add_u32 s63, s63, 7680
    buffer_load_dwordx2 v[210:211], v8, s[32:35], s63 offen sc1
    s_add_u32 s63, s63, 7680
    buffer_load_dwordx2 v[214:215], v8, s[32:35], s63 offen sc1
    s_add_u32 s63, s63, 7680
    buffer_load_dwordx2 v[218:219], v8, s[32:35], s63 offen sc1
    s_add_u32 s63, s63, 7680
    buffer_load_dwordx2 v[222:223], v8, s[32:35], s63 offen sc1
    s_add_u32 s63, s63, 7680
    buffer_load_dwordx2 v[226:227], v8, s[32:35], s63 offen sc1
    s_add_u32 s63, s63, 7680
    buffer_load_dwordx2 v[230:231], v8, s[32:35], s63 offen sc1
    s_waitcnt vmcnt(16)
    v_lshlrev_b32 v104, 16, v106
    v_and_b32 v105, 0xffff0000, v106
    v_lshlrev_b32 v106, 16, v107
    v_and_b32 v107, 0xffff0000, v107
    v_lshlrev_b32 v108, 16, v110
    v_and_b32 v109, 0xffff0000, v110
    v_lshlrev_b32 v110, 16, v111
    v_and_b32 v111, 0xffff0000, v111
    v_lshlrev_b32 v112, 16, v114
    v_and_b32 v113, 0xffff0000, v114
    v_lshlrev_b32 v114, 16, v115
    v_and_b32 v115, 0xffff0000, v115
    v_lshlrev_b32 v116, 16, v118
    v_and_b32 v117, 0xffff0000, v118
    v_lshlrev_b32 v118, 16, v119
    v_and_b32 v119, 0xffff0000, v119
    v_lshlrev_b32 v120, 16, v122
    v_and_b32 v121, 0xffff0000, v122
    v_lshlrev_b32 v122, 16, v123
    v_and_b32 v123, 0xffff0000, v123
    v_lshlrev_b32 v124, 16, v126
    v_and_b32 v125, 0xffff0000, v126
    v_lshlrev_b32 v126, 16, v127
    v_and_b32 v127, 0xffff0000, v127
    v_lshlrev_b32 v128, 16, v130
    v_and_b32 v129, 0xffff0000, v130
    v_lshlrev_b32 v130, 16, v131
    v_and_b32 v131, 0xffff0000, v131
    v_lshlrev_b32 v132, 16, v134
    v_and_b32 v133, 0xffff0000, v134
    v_lshlrev_b32 v134, 16, v135
    v_and_b32 v135, 0xffff0000, v135
    v_lshlrev_b32 v136, 16, v138
    v_and_b32 v137, 0xffff0000, v138
    v_lshlrev_b32 v138, 16, v139
    v_and_b32 v139, 0xffff0000, v139
    v_lshlrev_b32 v140, 16, v142
    v_and_b32 v141, 0xffff0000, v142
    v_lshlrev_b32 v142, 16, v143
    v_and_b32 v143, 0xffff0000, v143
    v_lshlrev_b32 v144, 16, v146
    v_and_b32 v145, 0xffff0000, v146
    v_lshlrev_b32 v146, 16, v147
    v_and_b32 v147, 0xffff0000, v147
    v_lshlrev_b32 v148, 16, v150
    v_and_b32 v149, 0xffff0000, v150
    v_lshlrev_b32 v150, 16, v151
    v_and_b32 v151, 0xffff0000, v151
    v_lshlrev_b32 v152, 16, v154
    v_and_b32 v153, 0xffff0000, v154
    v_lshlrev_b32 v154, 16, v155
    v_and_b32 v155, 0xffff0000, v155
    v_lshlrev_b32 v156, 16, v158
    v_and_b32 v157, 0xffff0000, v158
    v_lshlrev_b32 v158, 16, v159
    v_and_b32 v159, 0xffff0000, v159
    v_lshlrev_b32 v160, 16, v162
    v_and_b32 v161, 0xffff0000, v162
    v_lshlrev_b32 v162, 16, v163
    v_and_b32 v163, 0xffff0000, v163
    v_lshlrev_b32 v164, 16, v166
    v_and_b32 v165, 0xffff0000, v166
    v_lshlrev_b32 v166, 16, v167
    v_and_b32 v167, 0xffff0000, v167
    v_pk_add_f32 v[104:105], v[104:105], v[136:137]
    v_pk_add_f32 v[106:107], v[106:107], v[138:139]
    v_pk_add_f32 v[108:109], v[108:109], v[140:141]
    v_pk_add_f32 v[110:111], v[110:111], v[142:143]
    v_pk_add_f32 v[112:113], v[112:113], v[144:145]
    v_pk_add_f32 v[114:115], v[114:115], v[146:147]
    v_pk_add_f32 v[116:117], v[116:117], v[148:149]
    v_pk_add_f32 v[118:119], v[118:119], v[150:151]
    v_pk_add_f32 v[120:121], v[120:121], v[152:153]
    v_pk_add_f32 v[122:123], v[122:123], v[154:155]
    v_pk_add_f32 v[124:125], v[124:125], v[156:157]
    v_pk_add_f32 v[126:127], v[126:127], v[158:159]
    v_pk_add_f32 v[128:129], v[128:129], v[160:161]
    v_pk_add_f32 v[130:131], v[130:131], v[162:163]
    v_pk_add_f32 v[132:133], v[132:133], v[164:165]
    v_pk_add_f32 v[134:135], v[134:135], v[166:167]
    v_pk_add_f32 v[104:105], v[104:105], v[120:121]
    v_pk_add_f32 v[106:107], v[106:107], v[122:123]
    v_pk_add_f32 v[108:109], v[108:109], v[124:125]
    v_pk_add_f32 v[110:111], v[110:111], v[126:127]
    v_pk_add_f32 v[112:113], v[112:113], v[128:129]
    v_pk_add_f32 v[114:115], v[114:115], v[130:131]
    v_pk_add_f32 v[116:117], v[116:117], v[132:133]
    v_pk_add_f32 v[118:119], v[118:119], v[134:135]
    v_pk_add_f32 v[104:105], v[104:105], v[112:113]
    v_pk_add_f32 v[106:107], v[106:107], v[114:115]
    v_pk_add_f32 v[108:109], v[108:109], v[116:117]
    v_pk_add_f32 v[110:111], v[110:111], v[118:119]
    v_pk_add_f32 v[104:105], v[104:105], v[108:109]
    v_pk_add_f32 v[106:107], v[106:107], v[110:111]
    v_cvt_pk_bf16_f32 v44, v104, v105
    v_cvt_pk_bf16_f32 v45, v106, v107
    s_and_saveexec_b64 s[48:49], s[64:65]
    ds_write_b64 v36, v[44:45]
    s_mov_b64 exec, s[48:49]
    s_waitcnt vmcnt(0)
    v_lshlrev_b32 v168, 16, v170
    v_and_b32 v169, 0xffff0000, v170
    v_lshlrev_b32 v170, 16, v171
    v_and_b32 v171, 0xffff0000, v171
    v_lshlrev_b32 v172, 16, v174
    v_and_b32 v173, 0xffff0000, v174
    v_lshlrev_b32 v174, 16, v175
    v_and_b32 v175, 0xffff0000, v175
    v_lshlrev_b32 v176, 16, v178
    v_and_b32 v177, 0xffff0000, v178
    v_lshlrev_b32 v178, 16, v179
    v_and_b32 v179, 0xffff0000, v179
    v_lshlrev_b32 v180, 16, v182
    v_and_b32 v181, 0xffff0000, v182
    v_lshlrev_b32 v182, 16, v183
    v_and_b32 v183, 0xffff0000, v183
    v_lshlrev_b32 v184, 16, v186
    v_and_b32 v185, 0xffff0000, v186
    v_lshlrev_b32 v186, 16, v187
    v_and_b32 v187, 0xffff0000, v187
    v_lshlrev_b32 v188, 16, v190
    v_and_b32 v189, 0xffff0000, v190
    v_lshlrev_b32 v190, 16, v191
    v_and_b32 v191, 0xffff0000, v191
    v_lshlrev_b32 v192, 16, v194
    v_and_b32 v193, 0xffff0000, v194
    v_lshlrev_b32 v194, 16, v195
    v_and_b32 v195, 0xffff0000, v195
    v_lshlrev_b32 v196, 16, v198
    v_and_b32 v197, 0xffff0000, v198
    v_lshlrev_b32 v198, 16, v199
    v_and_b32 v199, 0xffff0000, v199
    v_lshlrev_b32 v200, 16, v202
    v_and_b32 v201, 0xffff0000, v202
    v_lshlrev_b32 v202, 16, v203
    v_and_b32 v203, 0xffff0000, v203
    v_lshlrev_b32 v204, 16, v206
    v_and_b32 v205, 0xffff0000, v206
    v_lshlrev_b32 v206, 16, v207
    v_and_b32 v207, 0xffff0000, v207
    v_lshlrev_b32 v208, 16, v210
    v_and_b32 v209, 0xffff0000, v210
    v_lshlrev_b32 v210, 16, v211
    v_and_b32 v211, 0xffff0000, v211
    v_lshlrev_b32 v212, 16, v214
    v_and_b32 v213, 0xffff0000, v214
    v_lshlrev_b32 v214, 16, v215
    v_and_b32 v215, 0xffff0000, v215
    v_lshlrev_b32 v216, 16, v218
    v_and_b32 v217, 0xffff0000, v218
    v_lshlrev_b32 v218, 16, v219
    v_and_b32 v219, 0xffff0000, v219
    v_lshlrev_b32 v220, 16, v222
    v_and_b32 v221, 0xffff0000, v222
    v_lshlrev_b32 v222, 16, v223
    v_and_b32 v223, 0xffff0000, v223
    v_lshlrev_b32 v224, 16, v226
    v_and_b32 v225, 0xffff0000, v226
    v_lshlrev_b32 v226, 16, v227
    v_and_b32 v227, 0xffff0000, v227
    v_lshlrev_b32 v228, 16, v230
    v_and_b32 v229, 0xffff0000, v230
    v_lshlrev_b32 v230, 16, v231
    v_and_b32 v231, 0xffff0000, v231
    v_pk_add_f32 v[168:169], v[168:169], v[200:201]
    v_pk_add_f32 v[170:171], v[170:171], v[202:203]
    v_pk_add_f32 v[172:173], v[172:173], v[204:205]
    v_pk_add_f32 v[174:175], v[174:175], v[206:207]
    v_pk_add_f32 v[176:177], v[176:177], v[208:209]
    v_pk_add_f32 v[178:179], v[178:179], v[210:211]
    v_pk_add_f32 v[180:181], v[180:181], v[212:213]
    v_pk_add_f32 v[182:183], v[182:183], v[214:215]
    v_pk_add_f32 v[184:185], v[184:185], v[216:217]
    v_pk_add_f32 v[186:187], v[186:187], v[218:219]
    v_pk_add_f32 v[188:189], v[188:189], v[220:221]
    v_pk_add_f32 v[190:191], v[190:191], v[222:223]
    v_pk_add_f32 v[192:193], v[192:193], v[224:225]
    v_pk_add_f32 v[194:195], v[194:195], v[226:227]
    v_pk_add_f32 v[196:197], v[196:197], v[228:229]
    v_pk_add_f32 v[198:199], v[198:199], v[230:231]
    v_pk_add_f32 v[168:169], v[168:169], v[184:185]
    v_pk_add_f32 v[170:171], v[170:171], v[186:187]
    v_pk_add_f32 v[172:173], v[172:173], v[188:189]
    v_pk_add_f32 v[174:175], v[174:175], v[190:191]
    v_pk_add_f32 v[176:177], v[176:177], v[192:193]
    v_pk_add_f32 v[178:179], v[178:179], v[194:195]
    v_pk_add_f32 v[180:181], v[180:181], v[196:197]
    v_pk_add_f32 v[182:183], v[182:183], v[198:199]
    v_pk_add_f32 v[168:169], v[168:169], v[176:177]
    v_pk_add_f32 v[170:171], v[170:171], v[178:179]
    v_pk_add_f32 v[172:173], v[172:173], v[180:181]
    v_pk_add_f32 v[174:175], v[174:175], v[182:183]
    v_pk_add_f32 v[168:169], v[168:169], v[172:173]
    v_pk_add_f32 v[170:171], v[170:171], v[174:175]
    v_cvt_pk_bf16_f32 v44, v168, v169
    v_cvt_pk_bf16_f32 v45, v170, v171
    s_and_saveexec_b64 s[48:49], s[66:67]
    ds_write_b64 v37, v[44:45]
    s_mov_b64 exec, s[48:49]
    s_waitcnt lgkmcnt(0)
    s_barrier
L_k1_end:
    s_endpgm
.globl k2_kernel
.p2align 8
.type k2_kernel,@function
k2_kernel:
    s_cmp_ge_u32 s2, 256
    s_cbranch_scc1 L_k2_end
    s_load_dwordx2 s[12:13], s[0:1], 80
    s_load_dwordx2 s[4:5], s[0:1], 0
    s_load_dwordx2 s[10:11], s[0:1], 64
    s_load_dwordx2 s[58:59], s[0:1], 72
    v_lshrrev_b32 v1, 6, v0
    v_and_b32 v2, 63, v0
    s_nop 0
    v_readfirstlane_b32 s32, v1
    s_and_b32 s33, s2, 7
    s_lshr_b32 s39, s2, 6
    s_lshl_b32 s39, s39, 3
    s_add_u32 s33, s33, s39
    s_lshr_b32 s34, s2, 3
    s_and_b32 s34, s34, 7
    s_mul_i32 s38, s32, 36864
    v_lshrrev_b32 v3, 4, v2
    v_and_b32 v8, 1, v3
    v_lshlrev_b32 v8, 1, v8
    v_lshrrev_b32 v9, 1, v3
    v_mul_u32_u24 v9, 3, v9
    v_xor_b32 v8, v8, v9
    v_and_b32 v9, 3, v2
    v_xor_b32 v9, v9, v8
    v_lshlrev_b32 v9, 4, v9
    v_lshrrev_b32 v10, 2, v2
    v_lshlrev_b32 v10, 6, v10
    v_add_u32 v4, v10, v9
    v_add_u32 v5, 1024, v4
    v_add_u32 v6, 2048, v4
    v_add_u32 v7, 3072, v4
    v_lshlrev_b32 v12, 4, v2
    v_add_u32 v13, 1024, v12
    v_add_u32 v14, 2048, v12
    v_add_u32 v15, 3072, v12
    v_add_u32 v16, 4096, v12
    s_mul_i32 s37, s32, 17
    s_mul_i32 s40, s33, 68
    s_add_u32 s35, s40, s37
    s_lshl_b32 s35, s35, 12
    s_mul_i32 s41, s34, 68
    s_add_u32 s36, s41, s37
    s_mul_i32 s36, s36, 5120
    s_add_u32 s36, s36, 20971520
    s_waitcnt lgkmcnt(0)
    s_mov_b32 s16, s12
    s_and_b32 s17, s13, 0xffff
    s_mov_b32 s18, 0x2000000
    s_mov_b32 s19, 0x00020000
    s_add_u32 m0, s38, 0
    s_nop 0
    buffer_load_dwordx4 v4, s[16:19], s35 offen lds
    s_add_u32 m0, s38, 1024
    s_nop 0
    buffer_load_dwordx4 v5, s[16:19], s35 offen lds
    s_add_u32 m0, s38, 2048
    s_nop 0
    buffer_load_dwordx4 v6, s[16:19], s35 offen lds
    s_add_u32 m0, s38, 3072
    s_nop 0
    buffer_load_dwordx4 v7, s[16:19], s35 offen lds
    s_add_u32 m0, s38, 4096
    s_nop 0
    buffer_load_dwordx4 v12, s[16:19], s36 offen lds
    s_add_u32 m0, s38, 5120
    s_nop 0
    buffer_load_dwordx4 v13, s[16:19], s36 offen lds
    s_add_u32 m0, s38, 6144
    s_nop 0
    buffer_load_dwordx4 v14, s[16:19], s36 offen lds
    s_add_u32 m0, s38, 7168
    s_nop 0
    buffer_load_dwordx4 v15, s[16:19], s36 offen lds
    s_add_u32 m0, s38, 8192
    s_nop 0
    buffer_load_dwordx4 v16, s[16:19], s36 offen lds
    s_add_u32 s35, s35, 4096
    s_add_u32 s36, s36, 5120
    s_mov_b32 s24, s4
    s_and_b32 s25, s5, 0xffff
    s_mov_b32 s26, 0x280000
    s_mov_b32 s27, 0x00020000
    s_mov_b32 s28, s10
    s_and_b32 s29, s11, 0xffff
    s_mov_b32 s30, 0x280000
    s_mov_b32 s31, 0x00020000
    v_bfe_u32 v9, v2, 2, 2
    v_and_b32 v10, 1, v9
    v_lshlrev_b32 v10, 1, v10
    v_lshrrev_b32 v11, 1, v9
    v_mul_u32_u24 v11, 3, v11
    v_xor_b32 v10, v10, v11
    v_xor_b32 v10, v10, v3
    v_and_b32 v11, 15, v2
    v_lshlrev_b32 v11, 6, v11
    v_lshl_add_u32 v20, v10, 4, v11
    v_add_u32 v20, s38, v20
    v_lshlrev_b32 v10, 2, v3
    v_add_u32 v10, v10, v9
    v_mul_u32_u24 v10, 160, v10
    v_and_b32 v11, 3, v2
    v_lshl_add_u32 v21, v11, 3, v10
    v_add_u32 v21, s38, v21
    v_add_u32 v21, 4096, v21
    s_add_u32 m0, s38, 9216
    s_nop 0
    buffer_load_dwordx4 v4, s[16:19], s35 offen lds
    s_add_u32 m0, s38, 10240
    s_nop 0
    buffer_load_dwordx4 v5, s[16:19], s35 offen lds
    s_add_u32 m0, s38, 11264
    s_nop 0
    buffer_load_dwordx4 v6, s[16:19], s35 offen lds
    s_add_u32 m0, s38, 12288
    s_nop 0
    buffer_load_dwordx4 v7, s[16:19], s35 offen lds
    s_add_u32 m0, s38, 13312
    s_nop 0
    buffer_load_dwordx4 v12, s[16:19], s36 offen lds
    s_add_u32 m0, s38, 14336
    s_nop 0
    buffer_load_dwordx4 v13, s[16:19], s36 offen lds
    s_add_u32 m0, s38, 15360
    s_nop 0
    buffer_load_dwordx4 v14, s[16:19], s36 offen lds
    s_add_u32 m0, s38, 16384
    s_nop 0
    buffer_load_dwordx4 v15, s[16:19], s36 offen lds
    s_add_u32 m0, s38, 17408
    s_nop 0
    buffer_load_dwordx4 v16, s[16:19], s36 offen lds
    s_add_u32 s35, s35, 4096
    s_add_u32 s36, s36, 5120
    s_waitcnt vmcnt(9)
    ds_read_b64_tr_b16 v[112:113], v21 offset:0
    ds_read_b64_tr_b16 v[114:115], v21 offset:2560
    ds_read_b64_tr_b16 v[116:117], v21 offset:32
    ds_read_b64_tr_b16 v[118:119], v21 offset:2592
    ds_read_b64_tr_b16 v[120:121], v21 offset:64
    ds_read_b64_tr_b16 v[122:123], v21 offset:2624
    ds_read_b64_tr_b16 v[124:125], v21 offset:96
    ds_read_b64_tr_b16 v[126:127], v21 offset:2656
    ds_read_b64_tr_b16 v[128:129], v21 offset:128
    ds_read_b64_tr_b16 v[130:131], v21 offset:2688
    ds_read_b128 v[132:135], v20 offset:0
    ds_read_b128 v[136:139], v20 offset:1024
    ds_read_b128 v[140:143], v20 offset:2048
    ds_read_b128 v[144:147], v20 offset:3072
    s_add_u32 m0, s38, 18432
    s_nop 0
    buffer_load_dwordx4 v4, s[16:19], s35 offen lds
    s_add_u32 m0, s38, 19456
    s_nop 0
    buffer_load_dwordx4 v5, s[16:19], s35 offen lds
    s_add_u32 m0, s38, 20480
    s_nop 0
    buffer_load_dwordx4 v6, s[16:19], s35 offen lds
    s_add_u32 m0, s38, 21504
    s_nop 0
    buffer_load_dwordx4 v7, s[16:19], s35 offen lds
    s_add_u32 m0, s38, 22528
    s_nop 0
    buffer_load_dwordx4 v12, s[16:19], s36 offen lds
    s_add_u32 m0, s38, 23552
    s_nop 0
    buffer_load_dwordx4 v13, s[16:19], s36 offen lds
    s_add_u32 m0, s38, 24576
    s_nop 0
    buffer_load_dwordx4 v14, s[16:19], s36 offen lds
    s_add_u32 m0, s38, 25600
    s_nop 0
    buffer_load_dwordx4 v15, s[16:19], s36 offen lds
    s_add_u32 m0, s38, 26624
    s_nop 0
    buffer_load_dwordx4 v16, s[16:19], s36 offen lds
    s_add_u32 s35, s35, 4096
    s_add_u32 s36, s36, 5120
    s_add_u32 m0, s38, 27648
    s_nop 0
    buffer_load_dwordx4 v4, s[16:19], s35 offen lds
    s_add_u32 m0, s38, 28672
    s_nop 0
    buffer_load_dwordx4 v5, s[16:19], s35 offen lds
    s_add_u32 m0, s38, 29696
    s_nop 0
    buffer_load_dwordx4 v6, s[16:19], s35 offen lds
    s_add_u32 m0, s38, 30720
    s_nop 0
    buffer_load_dwordx4 v7, s[16:19], s35 offen lds
    s_add_u32 m0, s38, 31744
    s_nop 0
    buffer_load_dwordx4 v12, s[16:19], s36 offen lds
    s_add_u32 m0, s38, 32768
    s_nop 0
    buffer_load_dwordx4 v13, s[16:19], s36 offen lds
    s_add_u32 m0, s38, 33792
    s_nop 0
    buffer_load_dwordx4 v14, s[16:19], s36 offen lds
    s_add_u32 m0, s38, 34816
    s_nop 0
    buffer_load_dwordx4 v15, s[16:19], s36 offen lds
    s_add_u32 m0, s38, 35840
    s_nop 0
    buffer_load_dwordx4 v16, s[16:19], s36 offen lds
    s_add_u32 s35, s35, 4096
    s_add_u32 s36, s36, 5120
    s_waitcnt vmcnt(18)
    ds_read_b64_tr_b16 v[148:149], v21 offset:9216
    ds_read_b64_tr_b16 v[150:151], v21 offset:11776
    ds_read_b64_tr_b16 v[152:153], v21 offset:9248
    ds_read_b64_tr_b16 v[154:155], v21 offset:11808
    ds_read_b64_tr_b16 v[156:157], v21 offset:9280
    ds_read_b64_tr_b16 v[158:159], v21 offset:11840
    ds_read_b64_tr_b16 v[160:161], v21 offset:9312
    ds_read_b64_tr_b16 v[162:163], v21 offset:11872
    ds_read_b64_tr_b16 v[164:165], v21 offset:9344
    ds_read_b64_tr_b16 v[166:167], v21 offset:11904
    ds_read_b128 v[168:171], v20 offset:9216
    ds_read_b128 v[172:175], v20 offset:10240
    ds_read_b128 v[176:179], v20 offset:11264
    ds_read_b128 v[180:183], v20 offset:12288
    s_waitcnt lgkmcnt(14)
    v_mfma_f32_16x16x32_bf16 v[32:35], v[112:115], v[132:135], 0
    s_add_u32 m0, s38, 0
    s_nop 0
    v_mfma_f32_16x16x32_bf16 v[36:39], v[116:119], v[132:135], 0
    buffer_load_dwordx4 v4, s[16:19], s35 offen lds
    s_add_u32 m0, s38, 1024
    v_mfma_f32_16x16x32_bf16 v[40:43], v[120:123], v[132:135], 0
    s_nop 0
    buffer_load_dwordx4 v5, s[16:19], s35 offen lds
    v_mfma_f32_16x16x32_bf16 v[44:47], v[124:127], v[132:135], 0
    s_add_u32 m0, s38, 2048
    s_nop 0
    v_mfma_f32_16x16x32_bf16 v[48:51], v[128:131], v[132:135], 0
    buffer_load_dwordx4 v6, s[16:19], s35 offen lds
    s_add_u32 m0, s38, 3072
    v_mfma_f32_16x16x32_bf16 v[52:55], v[112:115], v[136:139], 0
    s_nop 0
    buffer_load_dwordx4 v7, s[16:19], s35 offen lds
    v_mfma_f32_16x16x32_bf16 v[56:59], v[116:119], v[136:139], 0
    s_add_u32 m0, s38, 4096
    s_nop 0
    v_mfma_f32_16x16x32_bf16 v[60:63], v[120:123], v[136:139], 0
    buffer_load_dwordx4 v12, s[16:19], s36 offen lds
    s_add_u32 m0, s38, 5120
    v_mfma_f32_16x16x32_bf16 v[64:67], v[124:127], v[136:139], 0
    s_nop 0
    buffer_load_dwordx4 v13, s[16:19], s36 offen lds
    v_mfma_f32_16x16x32_bf16 v[68:71], v[128:131], v[136:139], 0
    s_add_u32 m0, s38, 6144
    s_nop 0
    v_mfma_f32_16x16x32_bf16 v[72:75], v[112:115], v[140:143], 0
    buffer_load_dwordx4 v14, s[16:19], s36 offen lds
    s_add_u32 m0, s38, 7168
    v_mfma_f32_16x16x32_bf16 v[76:79], v[116:119], v[140:143], 0
    s_nop 0
    buffer_load_dwordx4 v15, s[16:19], s36 offen lds
    v_mfma_f32_16x16x32_bf16 v[80:83], v[120:123], v[140:143], 0
    s_add_u32 m0, s38, 8192
    s_nop 0
    v_mfma_f32_16x16x32_bf16 v[84:87], v[124:127], v[140:143], 0
    buffer_load_dwordx4 v16, s[16:19], s36 offen lds
    s_add_u32 s35, s35, 4096
    v_mfma_f32_16x16x32_bf16 v[88:91], v[128:131], v[140:143], 0
    s_add_u32 s36, s36, 5120
    v_mfma_f32_16x16x32_bf16 v[92:95], v[112:115], v[144:147], 0
    v_mfma_f32_16x16x32_bf16 v[96:99], v[116:119], v[144:147], 0
    v_mfma_f32_16x16x32_bf16 v[100:103], v[120:123], v[144:147], 0
    v_mfma_f32_16x16x32_bf16 v[104:107], v[124:127], v[144:147], 0
    v_mfma_f32_16x16x32_bf16 v[108:111], v[128:131], v[144:147], 0
    s_waitcnt vmcnt(18)
    ds_read_b64_tr_b16 v[112:113], v21 offset:18432
    ds_read_b64_tr_b16 v[114:115], v21 offset:20992
    ds_read_b64_tr_b16 v[116:117], v21 offset:18464
    ds_read_b64_tr_b16 v[118:119], v21 offset:21024
    ds_read_b64_tr_b16 v[120:121], v21 offset:18496
    ds_read_b64_tr_b16 v[122:123], v21 offset:21056
    ds_read_b64_tr_b16 v[124:125], v21 offset:18528
    ds_read_b64_tr_b16 v[126:127], v21 offset:21088
    ds_read_b64_tr_b16 v[128:129], v21 offset:18560
    ds_read_b64_tr_b16 v[130:131], v21 offset:21120
    ds_read_b128 v[132:135], v20 offset:18432
    ds_read_b128 v[136:139], v20 offset:19456
    ds_read_b128 v[140:143], v20 offset:20480
    ds_read_b128 v[144:147], v20 offset:21504
    s_waitcnt lgkmcnt(14)
    v_mfma_f32_16x16x32_bf16 v[32:35], v[148:151], v[168:171], v[32:35]
    s_add_u32 m0, s38, 9216
    s_nop 0
    v_mfma_f32_16x16x32_bf16 v[36:39], v[152:155], v[168:171], v[36:39]
    buffer_load_dwordx4 v4, s[16:19], s35 offen lds
    s_add_u32 m0, s38, 10240
    v_mfma_f32_16x16x32_bf16 v[40:43], v[156:159], v[168:171], v[40:43]
    s_nop 0
    buffer_load_dwordx4 v5, s[16:19], s35 offen lds
    v_mfma_f32_16x16x32_bf16 v[44:47], v[160:163], v[168:171], v[44:47]
    s_add_u32 m0, s38, 11264
    s_nop 0
    v_mfma_f32_16x16x32_bf16 v[48:51], v[164:167], v[168:171], v[48:51]
    buffer_load_dwordx4 v6, s[16:19], s35 offen lds
    s_add_u32 m0, s38, 12288
    v_mfma_f32_16x16x32_bf16 v[52:55], v[148:151], v[172:175], v[52:55]
    s_nop 0
    buffer_load_dwordx4 v7, s[16:19], s35 offen lds
    v_mfma_f32_16x16x32_bf16 v[56:59], v[152:155], v[172:175], v[56:59]
    s_add_u32 m0, s38, 13312
    s_nop 0
    v_mfma_f32_16x16x32_bf16 v[60:63], v[156:159], v[172:175], v[60:63]
    buffer_load_dwordx4 v12, s[16:19], s36 offen lds
    s_add_u32 m0, s38, 14336
    v_mfma_f32_16x16x32_bf16 v[64:67], v[160:163], v[172:175], v[64:67]
    s_nop 0
    buffer_load_dwordx4 v13, s[16:19], s36 offen lds
    v_mfma_f32_16x16x32_bf16 v[68:71], v[164:167], v[172:175], v[68:71]
    s_add_u32 m0, s38, 15360
    s_nop 0
    v_mfma_f32_16x16x32_bf16 v[72:75], v[148:151], v[176:179], v[72:75]
    buffer_load_dwordx4 v14, s[16:19], s36 offen lds
    s_add_u32 m0, s38, 16384
    v_mfma_f32_16x16x32_bf16 v[76:79], v[152:155], v[176:179], v[76:79]
    s_nop 0
    buffer_load_dwordx4 v15, s[16:19], s36 offen lds
    v_mfma_f32_16x16x32_bf16 v[80:83], v[156:159], v[176:179], v[80:83]
    s_add_u32 m0, s38, 17408
    s_nop 0
    v_mfma_f32_16x16x32_bf16 v[84:87], v[160:163], v[176:179], v[84:87]
    buffer_load_dwordx4 v16, s[16:19], s36 offen lds
    s_add_u32 s35, s35, 4096
    v_mfma_f32_16x16x32_bf16 v[88:91], v[164:167], v[176:179], v[88:91]
    s_add_u32 s36, s36, 5120
    v_mfma_f32_16x16x32_bf16 v[92:95], v[148:151], v[180:183], v[92:95]
    v_mfma_f32_16x16x32_bf16 v[96:99], v[152:155], v[180:183], v[96:99]
    v_mfma_f32_16x16x32_bf16 v[100:103], v[156:159], v[180:183], v[100:103]
    v_mfma_f32_16x16x32_bf16 v[104:107], v[160:163], v[180:183], v[104:107]
    v_mfma_f32_16x16x32_bf16 v[108:111], v[164:167], v[180:183], v[108:111]
    s_waitcnt vmcnt(18)
    ds_read_b64_tr_b16 v[148:149], v21 offset:27648
    ds_read_b64_tr_b16 v[150:151], v21 offset:30208
    ds_read_b64_tr_b16 v[152:153], v21 offset:27680
    ds_read_b64_tr_b16 v[154:155], v21 offset:30240
    ds_read_b64_tr_b16 v[156:157], v21 offset:27712
    ds_read_b64_tr_b16 v[158:159], v21 offset:30272
    ds_read_b64_tr_b16 v[160:161], v21 offset:27744
    ds_read_b64_tr_b16 v[162:163], v21 offset:30304
    ds_read_b64_tr_b16 v[164:165], v21 offset:27776
    ds_read_b64_tr_b16 v[166:167], v21 offset:30336
    ds_read_b128 v[168:171], v20 offset:27648
    ds_read_b128 v[172:175], v20 offset:28672
    ds_read_b128 v[176:179], v20 offset:29696
    ds_read_b128 v[180:183], v20 offset:30720
    s_waitcnt lgkmcnt(14)
    v_mfma_f32_16x16x32_bf16 v[32:35], v[112:115], v[132:135], v[32:35]
    s_add_u32 m0, s38, 18432
    s_nop 0
    v_mfma_f32_16x16x32_bf16 v[36:39], v[116:119], v[132:135], v[36:39]
    buffer_load_dwordx4 v4, s[16:19], s35 offen lds
    s_add_u32 m0, s38, 19456
    v_mfma_f32_16x16x32_bf16 v[40:43], v[120:123], v[132:135], v[40:43]
    s_nop 0
    buffer_load_dwordx4 v5, s[16:19], s35 offen lds
    v_mfma_f32_16x16x32_bf16 v[44:47], v[124:127], v[132:135], v[44:47]
    s_add_u32 m0, s38, 20480
    s_nop 0
    v_mfma_f32_16x16x32_bf16 v[48:51], v[128:131], v[132:135], v[48:51]
    buffer_load_dwordx4 v6, s[16:19], s35 offen lds
    s_add_u32 m0, s38, 21504
    v_mfma_f32_16x16x32_bf16 v[52:55], v[112:115], v[136:139], v[52:55]
    s_nop 0
    buffer_load_dwordx4 v7, s[16:19], s35 offen lds
    v_mfma_f32_16x16x32_bf16 v[56:59], v[116:119], v[136:139], v[56:59]
    s_add_u32 m0, s38, 22528
    s_nop 0
    v_mfma_f32_16x16x32_bf16 v[60:63], v[120:123], v[136:139], v[60:63]
    buffer_load_dwordx4 v12, s[16:19], s36 offen lds
    s_add_u32 m0, s38, 23552
    v_mfma_f32_16x16x32_bf16 v[64:67], v[124:127], v[136:139], v[64:67]
    s_nop 0
    buffer_load_dwordx4 v13, s[16:19], s36 offen lds
    v_mfma_f32_16x16x32_bf16 v[68:71], v[128:131], v[136:139], v[68:71]
    s_add_u32 m0, s38, 24576
    s_nop 0
    v_mfma_f32_16x16x32_bf16 v[72:75], v[112:115], v[140:143], v[72:75]
    buffer_load_dwordx4 v14, s[16:19], s36 offen lds
    s_add_u32 m0, s38, 25600
    v_mfma_f32_16x16x32_bf16 v[76:79], v[116:119], v[140:143], v[76:79]
    s_nop 0
    buffer_load_dwordx4 v15, s[16:19], s36 offen lds
    v_mfma_f32_16x16x32_bf16 v[80:83], v[120:123], v[140:143], v[80:83]
    s_add_u32 m0, s38, 26624
    s_nop 0
    v_mfma_f32_16x16x32_bf16 v[84:87], v[124:127], v[140:143], v[84:87]
    buffer_load_dwordx4 v16, s[16:19], s36 offen lds
    s_add_u32 s35, s35, 4096
    v_mfma_f32_16x16x32_bf16 v[88:91], v[128:131], v[140:143], v[88:91]
    s_add_u32 s36, s36, 5120
    v_mfma_f32_16x16x32_bf16 v[92:95], v[112:115], v[144:147], v[92:95]
    v_mfma_f32_16x16x32_bf16 v[96:99], v[116:119], v[144:147], v[96:99]
    v_mfma_f32_16x16x32_bf16 v[100:103], v[120:123], v[144:147], v[100:103]
    v_mfma_f32_16x16x32_bf16 v[104:107], v[124:127], v[144:147], v[104:107]
    v_mfma_f32_16x16x32_bf16 v[108:111], v[128:131], v[144:147], v[108:111]
    s_waitcnt vmcnt(18)
    ds_read_b64_tr_b16 v[112:113], v21 offset:0
    ds_read_b64_tr_b16 v[114:115], v21 offset:2560
    ds_read_b64_tr_b16 v[116:117], v21 offset:32
    ds_read_b64_tr_b16 v[118:119], v21 offset:2592
    ds_read_b64_tr_b16 v[120:121], v21 offset:64
    ds_read_b64_tr_b16 v[122:123], v21 offset:2624
    ds_read_b64_tr_b16 v[124:125], v21 offset:96
    ds_read_b64_tr_b16 v[126:127], v21 offset:2656
    ds_read_b64_tr_b16 v[128:129], v21 offset:128
    ds_read_b64_tr_b16 v[130:131], v21 offset:2688
    ds_read_b128 v[132:135], v20 offset:0
    ds_read_b128 v[136:139], v20 offset:1024
    ds_read_b128 v[140:143], v20 offset:2048
    ds_read_b128 v[144:147], v20 offset:3072
    s_waitcnt lgkmcnt(14)
    v_mfma_f32_16x16x32_bf16 v[32:35], v[148:151], v[168:171], v[32:35]
    s_add_u32 m0, s38, 27648
    s_nop 0
    v_mfma_f32_16x16x32_bf16 v[36:39], v[152:155], v[168:171], v[36:39]
    buffer_load_dwordx4 v4, s[16:19], s35 offen lds
    s_add_u32 m0, s38, 28672
    v_mfma_f32_16x16x32_bf16 v[40:43], v[156:159], v[168:171], v[40:43]
    s_nop 0
    buffer_load_dwordx4 v5, s[16:19], s35 offen lds
    v_mfma_f32_16x16x32_bf16 v[44:47], v[160:163], v[168:171], v[44:47]
    s_add_u32 m0, s38, 29696
    s_nop 0
    v_mfma_f32_16x16x32_bf16 v[48:51], v[164:167], v[168:171], v[48:51]
    buffer_load_dwordx4 v6, s[16:19], s35 offen lds
    s_add_u32 m0, s38, 30720
    v_mfma_f32_16x16x32_bf16 v[52:55], v[148:151], v[172:175], v[52:55]
    s_nop 0
    buffer_load_dwordx4 v7, s[16:19], s35 offen lds
    v_mfma_f32_16x16x32_bf16 v[56:59], v[152:155], v[172:175], v[56:59]
    s_add_u32 m0, s38, 31744
    s_nop 0
    v_mfma_f32_16x16x32_bf16 v[60:63], v[156:159], v[172:175], v[60:63]
    buffer_load_dwordx4 v12, s[16:19], s36 offen lds
    s_add_u32 m0, s38, 32768
    v_mfma_f32_16x16x32_bf16 v[64:67], v[160:163], v[172:175], v[64:67]
    s_nop 0
    buffer_load_dwordx4 v13, s[16:19], s36 offen lds
    v_mfma_f32_16x16x32_bf16 v[68:71], v[164:167], v[172:175], v[68:71]
    s_add_u32 m0, s38, 33792
    s_nop 0
    v_mfma_f32_16x16x32_bf16 v[72:75], v[148:151], v[176:179], v[72:75]
    buffer_load_dwordx4 v14, s[16:19], s36 offen lds
    s_add_u32 m0, s38, 34816
    v_mfma_f32_16x16x32_bf16 v[76:79], v[152:155], v[176:179], v[76:79]
    s_nop 0
    buffer_load_dwordx4 v15, s[16:19], s36 offen lds
    v_mfma_f32_16x16x32_bf16 v[80:83], v[156:159], v[176:179], v[80:83]
    s_add_u32 m0, s38, 35840
    s_nop 0
    v_mfma_f32_16x16x32_bf16 v[84:87], v[160:163], v[176:179], v[84:87]
    buffer_load_dwordx4 v16, s[16:19], s36 offen lds
    s_add_u32 s35, s35, 4096
    v_mfma_f32_16x16x32_bf16 v[88:91], v[164:167], v[176:179], v[88:91]
    s_add_u32 s36, s36, 5120
    v_mfma_f32_16x16x32_bf16 v[92:95], v[148:151], v[180:183], v[92:95]
    v_mfma_f32_16x16x32_bf16 v[96:99], v[152:155], v[180:183], v[96:99]
    v_mfma_f32_16x16x32_bf16 v[100:103], v[156:159], v[180:183], v[100:103]
    v_mfma_f32_16x16x32_bf16 v[104:107], v[160:163], v[180:183], v[104:107]
    v_mfma_f32_16x16x32_bf16 v[108:111], v[164:167], v[180:183], v[108:111]
    s_waitcnt vmcnt(18)
    ds_read_b64_tr_b16 v[148:149], v21 offset:9216
    ds_read_b64_tr_b16 v[150:151], v21 offset:11776
    ds_read_b64_tr_b16 v[152:153], v21 offset:9248
    ds_read_b64_tr_b16 v[154:155], v21 offset:11808
    ds_read_b64_tr_b16 v[156:157], v21 offset:9280
    ds_read_b64_tr_b16 v[158:159], v21 offset:11840
    ds_read_b64_tr_b16 v[160:161], v21 offset:9312
    ds_read_b64_tr_b16 v[162:163], v21 offset:11872
    ds_read_b64_tr_b16 v[164:165], v21 offset:9344
    ds_read_b64_tr_b16 v[166:167], v21 offset:11904
    ds_read_b128 v[168:171], v20 offset:9216
    ds_read_b128 v[172:175], v20 offset:10240
    ds_read_b128 v[176:179], v20 offset:11264
    ds_read_b128 v[180:183], v20 offset:12288
    s_waitcnt lgkmcnt(14)
    v_mfma_f32_16x16x32_bf16 v[32:35], v[112:115], v[132:135], v[32:35]
    s_add_u32 m0, s38, 0
    s_nop 0
    v_mfma_f32_16x16x32_bf16 v[36:39], v[116:119], v[132:135], v[36:39]
    buffer_load_dwordx4 v4, s[16:19], s35 offen lds
    s_add_u32 m0, s38, 1024
    v_mfma_f32_16x16x32_bf16 v[40:43], v[120:123], v[132:135], v[40:43]
    s_nop 0
    buffer_load_dwordx4 v5, s[16:19], s35 offen lds
    v_mfma_f32_16x16x32_bf16 v[44:47], v[124:127], v[132:135], v[44:47]
    s_add_u32 m0, s38, 2048
    s_nop 0
    v_mfma_f32_16x16x32_bf16 v[48:51], v[128:131], v[132:135], v[48:51]
    buffer_load_dwordx4 v6, s[16:19], s35 offen lds
    s_add_u32 m0, s38, 3072
    v_mfma_f32_16x16x32_bf16 v[52:55], v[112:115], v[136:139], v[52:55]
    s_nop 0
    buffer_load_dwordx4 v7, s[16:19], s35 offen lds
    v_mfma_f32_16x16x32_bf16 v[56:59], v[116:119], v[136:139], v[56:59]
    s_add_u32 m0, s38, 4096
    s_nop 0
    v_mfma_f32_16x16x32_bf16 v[60:63], v[120:123], v[136:139], v[60:63]
    buffer_load_dwordx4 v12, s[16:19], s36 offen lds
    s_add_u32 m0, s38, 5120
    v_mfma_f32_16x16x32_bf16 v[64:67], v[124:127], v[136:139], v[64:67]
    s_nop 0
    buffer_load_dwordx4 v13, s[16:19], s36 offen lds
    v_mfma_f32_16x16x32_bf16 v[68:71], v[128:131], v[136:139], v[68:71]
    s_add_u32 m0, s38, 6144
    s_nop 0
    v_mfma_f32_16x16x32_bf16 v[72:75], v[112:115], v[140:143], v[72:75]
    buffer_load_dwordx4 v14, s[16:19], s36 offen lds
    s_add_u32 m0, s38, 7168
    v_mfma_f32_16x16x32_bf16 v[76:79], v[116:119], v[140:143], v[76:79]
    s_nop 0
    buffer_load_dwordx4 v15, s[16:19], s36 offen lds
    v_mfma_f32_16x16x32_bf16 v[80:83], v[120:123], v[140:143], v[80:83]
    s_add_u32 m0, s38, 8192
    s_nop 0
    v_mfma_f32_16x16x32_bf16 v[84:87], v[124:127], v[140:143], v[84:87]
    buffer_load_dwordx4 v16, s[16:19], s36 offen lds
    s_add_u32 s35, s35, 4096
    v_mfma_f32_16x16x32_bf16 v[88:91], v[128:131], v[140:143], v[88:91]
    s_add_u32 s36, s36, 5120
    v_mfma_f32_16x16x32_bf16 v[92:95], v[112:115], v[144:147], v[92:95]
    v_mfma_f32_16x16x32_bf16 v[96:99], v[116:119], v[144:147], v[96:99]
    v_mfma_f32_16x16x32_bf16 v[100:103], v[120:123], v[144:147], v[100:103]
    v_mfma_f32_16x16x32_bf16 v[104:107], v[124:127], v[144:147], v[104:107]
    v_mfma_f32_16x16x32_bf16 v[108:111], v[128:131], v[144:147], v[108:111]
    s_waitcnt vmcnt(18)
    ds_read_b64_tr_b16 v[112:113], v21 offset:18432
    ds_read_b64_tr_b16 v[114:115], v21 offset:20992
    ds_read_b64_tr_b16 v[116:117], v21 offset:18464
    ds_read_b64_tr_b16 v[118:119], v21 offset:21024
    ds_read_b64_tr_b16 v[120:121], v21 offset:18496
    ds_read_b64_tr_b16 v[122:123], v21 offset:21056
    ds_read_b64_tr_b16 v[124:125], v21 offset:18528
    ds_read_b64_tr_b16 v[126:127], v21 offset:21088
    ds_read_b64_tr_b16 v[128:129], v21 offset:18560
    ds_read_b64_tr_b16 v[130:131], v21 offset:21120
    ds_read_b128 v[132:135], v20 offset:18432
    ds_read_b128 v[136:139], v20 offset:19456
    ds_read_b128 v[140:143], v20 offset:20480
    ds_read_b128 v[144:147], v20 offset:21504
    s_waitcnt lgkmcnt(14)
    v_mfma_f32_16x16x32_bf16 v[32:35], v[148:151], v[168:171], v[32:35]
    s_add_u32 m0, s38, 9216
    s_nop 0
    v_mfma_f32_16x16x32_bf16 v[36:39], v[152:155], v[168:171], v[36:39]
    buffer_load_dwordx4 v4, s[16:19], s35 offen lds
    s_add_u32 m0, s38, 10240
    v_mfma_f32_16x16x32_bf16 v[40:43], v[156:159], v[168:171], v[40:43]
    s_nop 0
    buffer_load_dwordx4 v5, s[16:19], s35 offen lds
    v_mfma_f32_16x16x32_bf16 v[44:47], v[160:163], v[168:171], v[44:47]
    s_add_u32 m0, s38, 11264
    s_nop 0
    v_mfma_f32_16x16x32_bf16 v[48:51], v[164:167], v[168:171], v[48:51]
    buffer_load_dwordx4 v6, s[16:19], s35 offen lds
    s_add_u32 m0, s38, 12288
    v_mfma_f32_16x16x32_bf16 v[52:55], v[148:151], v[172:175], v[52:55]
    s_nop 0
    buffer_load_dwordx4 v7, s[16:19], s35 offen lds
    v_mfma_f32_16x16x32_bf16 v[56:59], v[152:155], v[172:175], v[56:59]
    s_add_u32 m0, s38, 13312
    s_nop 0
    v_mfma_f32_16x16x32_bf16 v[60:63], v[156:159], v[172:175], v[60:63]
    buffer_load_dwordx4 v12, s[16:19], s36 offen lds
    s_add_u32 m0, s38, 14336
    v_mfma_f32_16x16x32_bf16 v[64:67], v[160:163], v[172:175], v[64:67]
    s_nop 0
    buffer_load_dwordx4 v13, s[16:19], s36 offen lds
    v_mfma_f32_16x16x32_bf16 v[68:71], v[164:167], v[172:175], v[68:71]
    s_add_u32 m0, s38, 15360
    s_nop 0
    v_mfma_f32_16x16x32_bf16 v[72:75], v[148:151], v[176:179], v[72:75]
    buffer_load_dwordx4 v14, s[16:19], s36 offen lds
    s_add_u32 m0, s38, 16384
    v_mfma_f32_16x16x32_bf16 v[76:79], v[152:155], v[176:179], v[76:79]
    s_nop 0
    buffer_load_dwordx4 v15, s[16:19], s36 offen lds
    v_mfma_f32_16x16x32_bf16 v[80:83], v[156:159], v[176:179], v[80:83]
    s_add_u32 m0, s38, 17408
    s_nop 0
    v_mfma_f32_16x16x32_bf16 v[84:87], v[160:163], v[176:179], v[84:87]
    buffer_load_dwordx4 v16, s[16:19], s36 offen lds
    s_add_u32 s35, s35, 4096
    v_mfma_f32_16x16x32_bf16 v[88:91], v[164:167], v[176:179], v[88:91]
    s_add_u32 s36, s36, 5120
    v_mfma_f32_16x16x32_bf16 v[92:95], v[148:151], v[180:183], v[92:95]
    v_mfma_f32_16x16x32_bf16 v[96:99], v[152:155], v[180:183], v[96:99]
    v_mfma_f32_16x16x32_bf16 v[100:103], v[156:159], v[180:183], v[100:103]
    v_mfma_f32_16x16x32_bf16 v[104:107], v[160:163], v[180:183], v[104:107]
    v_mfma_f32_16x16x32_bf16 v[108:111], v[164:167], v[180:183], v[108:111]
    s_waitcnt vmcnt(18)
    ds_read_b64_tr_b16 v[148:149], v21 offset:27648
    ds_read_b64_tr_b16 v[150:151], v21 offset:30208
    ds_read_b64_tr_b16 v[152:153], v21 offset:27680
    ds_read_b64_tr_b16 v[154:155], v21 offset:30240
    ds_read_b64_tr_b16 v[156:157], v21 offset:27712
    ds_read_b64_tr_b16 v[158:159], v21 offset:30272
    ds_read_b64_tr_b16 v[160:161], v21 offset:27744
    ds_read_b64_tr_b16 v[162:163], v21 offset:30304
    ds_read_b64_tr_b16 v[164:165], v21 offset:27776
    ds_read_b64_tr_b16 v[166:167], v21 offset:30336
    ds_read_b128 v[168:171], v20 offset:27648
    ds_read_b128 v[172:175], v20 offset:28672
    ds_read_b128 v[176:179], v20 offset:29696
    ds_read_b128 v[180:183], v20 offset:30720
    s_waitcnt lgkmcnt(14)
    v_mfma_f32_16x16x32_bf16 v[32:35], v[112:115], v[132:135], v[32:35]
    s_add_u32 m0, s38, 18432
    s_nop 0
    v_mfma_f32_16x16x32_bf16 v[36:39], v[116:119], v[132:135], v[36:39]
    buffer_load_dwordx4 v4, s[16:19], s35 offen lds
    s_add_u32 m0, s38, 19456
    v_mfma_f32_16x16x32_bf16 v[40:43], v[120:123], v[132:135], v[40:43]
    s_nop 0
    buffer_load_dwordx4 v5, s[16:19], s35 offen lds
    v_mfma_f32_16x16x32_bf16 v[44:47], v[124:127], v[132:135], v[44:47]
    s_add_u32 m0, s38, 20480
    s_nop 0
    v_mfma_f32_16x16x32_bf16 v[48:51], v[128:131], v[132:135], v[48:51]
    buffer_load_dwordx4 v6, s[16:19], s35 offen lds
    s_add_u32 m0, s38, 21504
    v_mfma_f32_16x16x32_bf16 v[52:55], v[112:115], v[136:139], v[52:55]
    s_nop 0
    buffer_load_dwordx4 v7, s[16:19], s35 offen lds
    v_mfma_f32_16x16x32_bf16 v[56:59], v[116:119], v[136:139], v[56:59]
    s_add_u32 m0, s38, 22528
    s_nop 0
    v_mfma_f32_16x16x32_bf16 v[60:63], v[120:123], v[136:139], v[60:63]
    buffer_load_dwordx4 v12, s[16:19], s36 offen lds
    s_add_u32 m0, s38, 23552
    v_mfma_f32_16x16x32_bf16 v[64:67], v[124:127], v[136:139], v[64:67]
    s_nop 0
    buffer_load_dwordx4 v13, s[16:19], s36 offen lds
    v_mfma_f32_16x16x32_bf16 v[68:71], v[128:131], v[136:139], v[68:71]
    s_add_u32 m0, s38, 24576
    s_nop 0
    v_mfma_f32_16x16x32_bf16 v[72:75], v[112:115], v[140:143], v[72:75]
    buffer_load_dwordx4 v14, s[16:19], s36 offen lds
    s_add_u32 m0, s38, 25600
    v_mfma_f32_16x16x32_bf16 v[76:79], v[116:119], v[140:143], v[76:79]
    s_nop 0
    buffer_load_dwordx4 v15, s[16:19], s36 offen lds
    v_mfma_f32_16x16x32_bf16 v[80:83], v[120:123], v[140:143], v[80:83]
    s_add_u32 m0, s38, 26624
    s_nop 0
    v_mfma_f32_16x16x32_bf16 v[84:87], v[124:127], v[140:143], v[84:87]
    buffer_load_dwordx4 v16, s[16:19], s36 offen lds
    s_add_u32 s35, s35, 4096
    v_mfma_f32_16x16x32_bf16 v[88:91], v[128:131], v[140:143], v[88:91]
    s_add_u32 s36, s36, 5120
    v_mfma_f32_16x16x32_bf16 v[92:95], v[112:115], v[144:147], v[92:95]
    v_mfma_f32_16x16x32_bf16 v[96:99], v[116:119], v[144:147], v[96:99]
    v_mfma_f32_16x16x32_bf16 v[100:103], v[120:123], v[144:147], v[100:103]
    v_mfma_f32_16x16x32_bf16 v[104:107], v[124:127], v[144:147], v[104:107]
    v_mfma_f32_16x16x32_bf16 v[108:111], v[128:131], v[144:147], v[108:111]
    s_waitcnt vmcnt(18)
    ds_read_b64_tr_b16 v[112:113], v21 offset:0
    ds_read_b64_tr_b16 v[114:115], v21 offset:2560
    ds_read_b64_tr_b16 v[116:117], v21 offset:32
    ds_read_b64_tr_b16 v[118:119], v21 offset:2592
    ds_read_b64_tr_b16 v[120:121], v21 offset:64
    ds_read_b64_tr_b16 v[122:123], v21 offset:2624
    ds_read_b64_tr_b16 v[124:125], v21 offset:96
    ds_read_b64_tr_b16 v[126:127], v21 offset:2656
    ds_read_b64_tr_b16 v[128:129], v21 offset:128
    ds_read_b64_tr_b16 v[130:131], v21 offset:2688
    ds_read_b128 v[132:135], v20 offset:0
    ds_read_b128 v[136:139], v20 offset:1024
    ds_read_b128 v[140:143], v20 offset:2048
    ds_read_b128 v[144:147], v20 offset:3072
    s_waitcnt lgkmcnt(14)
    v_mfma_f32_16x16x32_bf16 v[32:35], v[148:151], v[168:171], v[32:35]
    s_add_u32 m0, s38, 27648
    s_nop 0
    v_mfma_f32_16x16x32_bf16 v[36:39], v[152:155], v[168:171], v[36:39]
    buffer_load_dwordx4 v4, s[16:19], s35 offen lds
    s_add_u32 m0, s38, 28672
    v_mfma_f32_16x16x32_bf16 v[40:43], v[156:159], v[168:171], v[40:43]
    s_nop 0
    buffer_load_dwordx4 v5, s[16:19], s35 offen lds
    v_mfma_f32_16x16x32_bf16 v[44:47], v[160:163], v[168:171], v[44:47]
    s_add_u32 m0, s38, 29696
    s_nop 0
    v_mfma_f32_16x16x32_bf16 v[48:51], v[164:167], v[168:171], v[48:51]
    buffer_load_dwordx4 v6, s[16:19], s35 offen lds
    s_add_u32 m0, s38, 30720
    v_mfma_f32_16x16x32_bf16 v[52:55], v[148:151], v[172:175], v[52:55]
    s_nop 0
    buffer_load_dwordx4 v7, s[16:19], s35 offen lds
    v_mfma_f32_16x16x32_bf16 v[56:59], v[152:155], v[172:175], v[56:59]
    s_add_u32 m0, s38, 31744
    s_nop 0
    v_mfma_f32_16x16x32_bf16 v[60:63], v[156:159], v[172:175], v[60:63]
    buffer_load_dwordx4 v12, s[16:19], s36 offen lds
    s_add_u32 m0, s38, 32768
    v_mfma_f32_16x16x32_bf16 v[64:67], v[160:163], v[172:175], v[64:67]
    s_nop 0
    buffer_load_dwordx4 v13, s[16:19], s36 offen lds
    v_mfma_f32_16x16x32_bf16 v[68:71], v[164:167], v[172:175], v[68:71]
    s_add_u32 m0, s38, 33792
    s_nop 0
    v_mfma_f32_16x16x32_bf16 v[72:75], v[148:151], v[176:179], v[72:75]
    buffer_load_dwordx4 v14, s[16:19], s36 offen lds
    s_add_u32 m0, s38, 34816
    v_mfma_f32_16x16x32_bf16 v[76:79], v[152:155], v[176:179], v[76:79]
    s_nop 0
    buffer_load_dwordx4 v15, s[16:19], s36 offen lds
    v_mfma_f32_16x16x32_bf16 v[80:83], v[156:159], v[176:179], v[80:83]
    s_add_u32 m0, s38, 35840
    s_nop 0
    v_mfma_f32_16x16x32_bf16 v[84:87], v[160:163], v[176:179], v[84:87]
    buffer_load_dwordx4 v16, s[16:19], s36 offen lds
    s_add_u32 s35, s35, 4096
    v_mfma_f32_16x16x32_bf16 v[88:91], v[164:167], v[176:179], v[88:91]
    s_add_u32 s36, s36, 5120
    v_mfma_f32_16x16x32_bf16 v[92:95], v[148:151], v[180:183], v[92:95]
    v_mfma_f32_16x16x32_bf16 v[96:99], v[152:155], v[180:183], v[96:99]
    v_mfma_f32_16x16x32_bf16 v[100:103], v[156:159], v[180:183], v[100:103]
    v_mfma_f32_16x16x32_bf16 v[104:107], v[160:163], v[180:183], v[104:107]
    v_mfma_f32_16x16x32_bf16 v[108:111], v[164:167], v[180:183], v[108:111]
    s_waitcnt vmcnt(18)
    ds_read_b64_tr_b16 v[148:149], v21 offset:9216
    ds_read_b64_tr_b16 v[150:151], v21 offset:11776
    ds_read_b64_tr_b16 v[152:153], v21 offset:9248
    ds_read_b64_tr_b16 v[154:155], v21 offset:11808
    ds_read_b64_tr_b16 v[156:157], v21 offset:9280
    ds_read_b64_tr_b16 v[158:159], v21 offset:11840
    ds_read_b64_tr_b16 v[160:161], v21 offset:9312
    ds_read_b64_tr_b16 v[162:163], v21 offset:11872
    ds_read_b64_tr_b16 v[164:165], v21 offset:9344
    ds_read_b64_tr_b16 v[166:167], v21 offset:11904
    ds_read_b128 v[168:171], v20 offset:9216
    ds_read_b128 v[172:175], v20 offset:10240
    ds_read_b128 v[176:179], v20 offset:11264
    ds_read_b128 v[180:183], v20 offset:12288
    s_waitcnt lgkmcnt(14)
    v_mfma_f32_16x16x32_bf16 v[32:35], v[112:115], v[132:135], v[32:35]
    s_add_u32 m0, s38, 0
    s_nop 0
    v_mfma_f32_16x16x32_bf16 v[36:39], v[116:119], v[132:135], v[36:39]
    buffer_load_dwordx4 v4, s[16:19], s35 offen lds
    s_add_u32 m0, s38, 1024
    v_mfma_f32_16x16x32_bf16 v[40:43], v[120:123], v[132:135], v[40:43]
    s_nop 0
    buffer_load_dwordx4 v5, s[16:19], s35 offen lds
    v_mfma_f32_16x16x32_bf16 v[44:47], v[124:127], v[132:135], v[44:47]
    s_add_u32 m0, s38, 2048
    s_nop 0
    v_mfma_f32_16x16x32_bf16 v[48:51], v[128:131], v[132:135], v[48:51]
    buffer_load_dwordx4 v6, s[16:19], s35 offen lds
    s_add_u32 m0, s38, 3072
    v_mfma_f32_16x16x32_bf16 v[52:55], v[112:115], v[136:139], v[52:55]
    s_nop 0
    buffer_load_dwordx4 v7, s[16:19], s35 offen lds
    v_mfma_f32_16x16x32_bf16 v[56:59], v[116:119], v[136:139], v[56:59]
    s_add_u32 m0, s38, 4096
    s_nop 0
    v_mfma_f32_16x16x32_bf16 v[60:63], v[120:123], v[136:139], v[60:63]
    buffer_load_dwordx4 v12, s[16:19], s36 offen lds
    s_add_u32 m0, s38, 5120
    v_mfma_f32_16x16x32_bf16 v[64:67], v[124:127], v[136:139], v[64:67]
    s_nop 0
    buffer_load_dwordx4 v13, s[16:19], s36 offen lds
    v_mfma_f32_16x16x32_bf16 v[68:71], v[128:131], v[136:139], v[68:71]
    s_add_u32 m0, s38, 6144
    s_nop 0
    v_mfma_f32_16x16x32_bf16 v[72:75], v[112:115], v[140:143], v[72:75]
    buffer_load_dwordx4 v14, s[16:19], s36 offen lds
    s_add_u32 m0, s38, 7168
    v_mfma_f32_16x16x32_bf16 v[76:79], v[116:119], v[140:143], v[76:79]
    s_nop 0
    buffer_load_dwordx4 v15, s[16:19], s36 offen lds
    v_mfma_f32_16x16x32_bf16 v[80:83], v[120:123], v[140:143], v[80:83]
    s_add_u32 m0, s38, 8192
    s_nop 0
    v_mfma_f32_16x16x32_bf16 v[84:87], v[124:127], v[140:143], v[84:87]
    buffer_load_dwordx4 v16, s[16:19], s36 offen lds
    s_add_u32 s35, s35, 4096
    v_mfma_f32_16x16x32_bf16 v[88:91], v[128:131], v[140:143], v[88:91]
    s_add_u32 s36, s36, 5120
    v_mfma_f32_16x16x32_bf16 v[92:95], v[112:115], v[144:147], v[92:95]
    v_mfma_f32_16x16x32_bf16 v[96:99], v[116:119], v[144:147], v[96:99]
    v_mfma_f32_16x16x32_bf16 v[100:103], v[120:123], v[144:147], v[100:103]
    v_mfma_f32_16x16x32_bf16 v[104:107], v[124:127], v[144:147], v[104:107]
    v_mfma_f32_16x16x32_bf16 v[108:111], v[128:131], v[144:147], v[108:111]
    s_waitcnt vmcnt(18)
    ds_read_b64_tr_b16 v[112:113], v21 offset:18432
    ds_read_b64_tr_b16 v[114:115], v21 offset:20992
    ds_read_b64_tr_b16 v[116:117], v21 offset:18464
    ds_read_b64_tr_b16 v[118:119], v21 offset:21024
    ds_read_b64_tr_b16 v[120:121], v21 offset:18496
    ds_read_b64_tr_b16 v[122:123], v21 offset:21056
    ds_read_b64_tr_b16 v[124:125], v21 offset:18528
    ds_read_b64_tr_b16 v[126:127], v21 offset:21088
    ds_read_b64_tr_b16 v[128:129], v21 offset:18560
    ds_read_b64_tr_b16 v[130:131], v21 offset:21120
    ds_read_b128 v[132:135], v20 offset:18432
    ds_read_b128 v[136:139], v20 offset:19456
    ds_read_b128 v[140:143], v20 offset:20480
    ds_read_b128 v[144:147], v20 offset:21504
    s_waitcnt lgkmcnt(14)
    v_mfma_f32_16x16x32_bf16 v[32:35], v[148:151], v[168:171], v[32:35]
    s_add_u32 m0, s38, 9216
    s_nop 0
    v_mfma_f32_16x16x32_bf16 v[36:39], v[152:155], v[168:171], v[36:39]
    buffer_load_dwordx4 v4, s[16:19], s35 offen lds
    s_add_u32 m0, s38, 10240
    v_mfma_f32_16x16x32_bf16 v[40:43], v[156:159], v[168:171], v[40:43]
    s_nop 0
    buffer_load_dwordx4 v5, s[16:19], s35 offen lds
    v_mfma_f32_16x16x32_bf16 v[44:47], v[160:163], v[168:171], v[44:47]
    s_add_u32 m0, s38, 11264
    s_nop 0
    v_mfma_f32_16x16x32_bf16 v[48:51], v[164:167], v[168:171], v[48:51]
    buffer_load_dwordx4 v6, s[16:19], s35 offen lds
    s_add_u32 m0, s38, 12288
    v_mfma_f32_16x16x32_bf16 v[52:55], v[148:151], v[172:175], v[52:55]
    s_nop 0
    buffer_load_dwordx4 v7, s[16:19], s35 offen lds
    v_mfma_f32_16x16x32_bf16 v[56:59], v[152:155], v[172:175], v[56:59]
    s_add_u32 m0, s38, 13312
    s_nop 0
    v_mfma_f32_16x16x32_bf16 v[60:63], v[156:159], v[172:175], v[60:63]
    buffer_load_dwordx4 v12, s[16:19], s36 offen lds
    s_add_u32 m0, s38, 14336
    v_mfma_f32_16x16x32_bf16 v[64:67], v[160:163], v[172:175], v[64:67]
    s_nop 0
    buffer_load_dwordx4 v13, s[16:19], s36 offen lds
    v_mfma_f32_16x16x32_bf16 v[68:71], v[164:167], v[172:175], v[68:71]
    s_add_u32 m0, s38, 15360
    s_nop 0
    v_mfma_f32_16x16x32_bf16 v[72:75], v[148:151], v[176:179], v[72:75]
    buffer_load_dwordx4 v14, s[16:19], s36 offen lds
    s_add_u32 m0, s38, 16384
    v_mfma_f32_16x16x32_bf16 v[76:79], v[152:155], v[176:179], v[76:79]
    s_nop 0
    buffer_load_dwordx4 v15, s[16:19], s36 offen lds
    v_mfma_f32_16x16x32_bf16 v[80:83], v[156:159], v[176:179], v[80:83]
    s_add_u32 m0, s38, 17408
    s_nop 0
    v_mfma_f32_16x16x32_bf16 v[84:87], v[160:163], v[176:179], v[84:87]
    buffer_load_dwordx4 v16, s[16:19], s36 offen lds
    s_add_u32 s35, s35, 4096
    v_mfma_f32_16x16x32_bf16 v[88:91], v[164:167], v[176:179], v[88:91]
    s_add_u32 s36, s36, 5120
    v_mfma_f32_16x16x32_bf16 v[92:95], v[148:151], v[180:183], v[92:95]
    v_mfma_f32_16x16x32_bf16 v[96:99], v[152:155], v[180:183], v[96:99]
    v_mfma_f32_16x16x32_bf16 v[100:103], v[156:159], v[180:183], v[100:103]
    v_mfma_f32_16x16x32_bf16 v[104:107], v[160:163], v[180:183], v[104:107]
    v_mfma_f32_16x16x32_bf16 v[108:111], v[164:167], v[180:183], v[108:111]
    s_waitcnt vmcnt(18)
    ds_read_b64_tr_b16 v[148:149], v21 offset:27648
    ds_read_b64_tr_b16 v[150:151], v21 offset:30208
    ds_read_b64_tr_b16 v[152:153], v21 offset:27680
    ds_read_b64_tr_b16 v[154:155], v21 offset:30240
    ds_read_b64_tr_b16 v[156:157], v21 offset:27712
    ds_read_b64_tr_b16 v[158:159], v21 offset:30272
    ds_read_b64_tr_b16 v[160:161], v21 offset:27744
    ds_read_b64_tr_b16 v[162:163], v21 offset:30304
    ds_read_b64_tr_b16 v[164:165], v21 offset:27776
    ds_read_b64_tr_b16 v[166:167], v21 offset:30336
    ds_read_b128 v[168:171], v20 offset:27648
    ds_read_b128 v[172:175], v20 offset:28672
    ds_read_b128 v[176:179], v20 offset:29696
    ds_read_b128 v[180:183], v20 offset:30720
    s_waitcnt lgkmcnt(14)
    v_mfma_f32_16x16x32_bf16 v[32:35], v[112:115], v[132:135], v[32:35]
    s_add_u32 m0, s38, 18432
    s_nop 0
    v_mfma_f32_16x16x32_bf16 v[36:39], v[116:119], v[132:135], v[36:39]
    buffer_load_dwordx4 v4, s[16:19], s35 offen lds
    s_add_u32 m0, s38, 19456
    v_mfma_f32_16x16x32_bf16 v[40:43], v[120:123], v[132:135], v[40:43]
    s_nop 0
    buffer_load_dwordx4 v5, s[16:19], s35 offen lds
    v_mfma_f32_16x16x32_bf16 v[44:47], v[124:127], v[132:135], v[44:47]
    s_add_u32 m0, s38, 20480
    s_nop 0
    v_mfma_f32_16x16x32_bf16 v[48:51], v[128:131], v[132:135], v[48:51]
    buffer_load_dwordx4 v6, s[16:19], s35 offen lds
    s_add_u32 m0, s38, 21504
    v_mfma_f32_16x16x32_bf16 v[52:55], v[112:115], v[136:139], v[52:55]
    s_nop 0
    buffer_load_dwordx4 v7, s[16:19], s35 offen lds
    v_mfma_f32_16x16x32_bf16 v[56:59], v[116:119], v[136:139], v[56:59]
    s_add_u32 m0, s38, 22528
    s_nop 0
    v_mfma_f32_16x16x32_bf16 v[60:63], v[120:123], v[136:139], v[60:63]
    buffer_load_dwordx4 v12, s[16:19], s36 offen lds
    s_add_u32 m0, s38, 23552
    v_mfma_f32_16x16x32_bf16 v[64:67], v[124:127], v[136:139], v[64:67]
    s_nop 0
    buffer_load_dwordx4 v13, s[16:19], s36 offen lds
    v_mfma_f32_16x16x32_bf16 v[68:71], v[128:131], v[136:139], v[68:71]
    s_add_u32 m0, s38, 24576
    s_nop 0
    v_mfma_f32_16x16x32_bf16 v[72:75], v[112:115], v[140:143], v[72:75]
    buffer_load_dwordx4 v14, s[16:19], s36 offen lds
    s_add_u32 m0, s38, 25600
    v_mfma_f32_16x16x32_bf16 v[76:79], v[116:119], v[140:143], v[76:79]
    s_nop 0
    buffer_load_dwordx4 v15, s[16:19], s36 offen lds
    v_mfma_f32_16x16x32_bf16 v[80:83], v[120:123], v[140:143], v[80:83]
    s_add_u32 m0, s38, 26624
    s_nop 0
    v_mfma_f32_16x16x32_bf16 v[84:87], v[124:127], v[140:143], v[84:87]
    buffer_load_dwordx4 v16, s[16:19], s36 offen lds
    s_add_u32 s35, s35, 4096
    v_mfma_f32_16x16x32_bf16 v[88:91], v[128:131], v[140:143], v[88:91]
    s_add_u32 s36, s36, 5120
    v_mfma_f32_16x16x32_bf16 v[92:95], v[112:115], v[144:147], v[92:95]
    v_mfma_f32_16x16x32_bf16 v[96:99], v[116:119], v[144:147], v[96:99]
    v_mfma_f32_16x16x32_bf16 v[100:103], v[120:123], v[144:147], v[100:103]
    v_mfma_f32_16x16x32_bf16 v[104:107], v[124:127], v[144:147], v[104:107]
    v_mfma_f32_16x16x32_bf16 v[108:111], v[128:131], v[144:147], v[108:111]
    s_waitcnt vmcnt(18)
    ds_read_b64_tr_b16 v[112:113], v21 offset:0
    ds_read_b64_tr_b16 v[114:115], v21 offset:2560
    ds_read_b64_tr_b16 v[116:117], v21 offset:32
    ds_read_b64_tr_b16 v[118:119], v21 offset:2592
    ds_read_b64_tr_b16 v[120:121], v21 offset:64
    ds_read_b64_tr_b16 v[122:123], v21 offset:2624
    ds_read_b64_tr_b16 v[124:125], v21 offset:96
    ds_read_b64_tr_b16 v[126:127], v21 offset:2656
    ds_read_b64_tr_b16 v[128:129], v21 offset:128
    ds_read_b64_tr_b16 v[130:131], v21 offset:2688
    ds_read_b128 v[132:135], v20 offset:0
    ds_read_b128 v[136:139], v20 offset:1024
    ds_read_b128 v[140:143], v20 offset:2048
    ds_read_b128 v[144:147], v20 offset:3072
    s_waitcnt lgkmcnt(14)
    v_mfma_f32_16x16x32_bf16 v[32:35], v[148:151], v[168:171], v[32:35]
    s_add_u32 m0, s38, 27648
    s_nop 0
    v_mfma_f32_16x16x32_bf16 v[36:39], v[152:155], v[168:171], v[36:39]
    buffer_load_dwordx4 v4, s[16:19], s35 offen lds
    s_add_u32 m0, s38, 28672
    v_mfma_f32_16x16x32_bf16 v[40:43], v[156:159], v[168:171], v[40:43]
    s_nop 0
    buffer_load_dwordx4 v5, s[16:19], s35 offen lds
    v_mfma_f32_16x16x32_bf16 v[44:47], v[160:163], v[168:171], v[44:47]
    s_add_u32 m0, s38, 29696
    s_nop 0
    v_mfma_f32_16x16x32_bf16 v[48:51], v[164:167], v[168:171], v[48:51]
    buffer_load_dwordx4 v6, s[16:19], s35 offen lds
    s_add_u32 m0, s38, 30720
    v_mfma_f32_16x16x32_bf16 v[52:55], v[148:151], v[172:175], v[52:55]
    s_nop 0
    buffer_load_dwordx4 v7, s[16:19], s35 offen lds
    v_mfma_f32_16x16x32_bf16 v[56:59], v[152:155], v[172:175], v[56:59]
    s_add_u32 m0, s38, 31744
    s_nop 0
    v_mfma_f32_16x16x32_bf16 v[60:63], v[156:159], v[172:175], v[60:63]
    buffer_load_dwordx4 v12, s[16:19], s36 offen lds
    s_add_u32 m0, s38, 32768
    v_mfma_f32_16x16x32_bf16 v[64:67], v[160:163], v[172:175], v[64:67]
    s_nop 0
    buffer_load_dwordx4 v13, s[16:19], s36 offen lds
    v_mfma_f32_16x16x32_bf16 v[68:71], v[164:167], v[172:175], v[68:71]
    s_add_u32 m0, s38, 33792
    s_nop 0
    v_mfma_f32_16x16x32_bf16 v[72:75], v[148:151], v[176:179], v[72:75]
    buffer_load_dwordx4 v14, s[16:19], s36 offen lds
    s_add_u32 m0, s38, 34816
    v_mfma_f32_16x16x32_bf16 v[76:79], v[152:155], v[176:179], v[76:79]
    s_nop 0
    buffer_load_dwordx4 v15, s[16:19], s36 offen lds
    v_mfma_f32_16x16x32_bf16 v[80:83], v[156:159], v[176:179], v[80:83]
    s_add_u32 m0, s38, 35840
    s_nop 0
    v_mfma_f32_16x16x32_bf16 v[84:87], v[160:163], v[176:179], v[84:87]
    buffer_load_dwordx4 v16, s[16:19], s36 offen lds
    s_add_u32 s35, s35, 4096
    v_mfma_f32_16x16x32_bf16 v[88:91], v[164:167], v[176:179], v[88:91]
    s_add_u32 s36, s36, 5120
    v_mfma_f32_16x16x32_bf16 v[92:95], v[148:151], v[180:183], v[92:95]
    v_mfma_f32_16x16x32_bf16 v[96:99], v[152:155], v[180:183], v[96:99]
    v_mfma_f32_16x16x32_bf16 v[100:103], v[156:159], v[180:183], v[100:103]
    v_mfma_f32_16x16x32_bf16 v[104:107], v[160:163], v[180:183], v[104:107]
    v_mfma_f32_16x16x32_bf16 v[108:111], v[164:167], v[180:183], v[108:111]
    s_waitcnt vmcnt(18)
    ds_read_b64_tr_b16 v[148:149], v21 offset:9216
    ds_read_b64_tr_b16 v[150:151], v21 offset:11776
    ds_read_b64_tr_b16 v[152:153], v21 offset:9248
    ds_read_b64_tr_b16 v[154:155], v21 offset:11808
    ds_read_b64_tr_b16 v[156:157], v21 offset:9280
    ds_read_b64_tr_b16 v[158:159], v21 offset:11840
    ds_read_b64_tr_b16 v[160:161], v21 offset:9312
    ds_read_b64_tr_b16 v[162:163], v21 offset:11872
    ds_read_b64_tr_b16 v[164:165], v21 offset:9344
    ds_read_b64_tr_b16 v[166:167], v21 offset:11904
    ds_read_b128 v[168:171], v20 offset:9216
    ds_read_b128 v[172:175], v20 offset:10240
    ds_read_b128 v[176:179], v20 offset:11264
    ds_read_b128 v[180:183], v20 offset:12288
    s_waitcnt lgkmcnt(14)
    v_mfma_f32_16x16x32_bf16 v[32:35], v[112:115], v[132:135], v[32:35]
    s_add_u32 m0, s38, 0
    s_nop 0
    v_mfma_f32_16x16x32_bf16 v[36:39], v[116:119], v[132:135], v[36:39]
    buffer_load_dwordx4 v4, s[16:19], s35 offen lds
    s_add_u32 m0, s38, 1024
    v_mfma_f32_16x16x32_bf16 v[40:43], v[120:123], v[132:135], v[40:43]
    s_nop 0
    buffer_load_dwordx4 v5, s[16:19], s35 offen lds
    v_mfma_f32_16x16x32_bf16 v[44:47], v[124:127], v[132:135], v[44:47]
    s_add_u32 m0, s38, 2048
    s_nop 0
    v_mfma_f32_16x16x32_bf16 v[48:51], v[128:131], v[132:135], v[48:51]
    buffer_load_dwordx4 v6, s[16:19], s35 offen lds
    s_add_u32 m0, s38, 3072
    v_mfma_f32_16x16x32_bf16 v[52:55], v[112:115], v[136:139], v[52:55]
    s_nop 0
    buffer_load_dwordx4 v7, s[16:19], s35 offen lds
    v_mfma_f32_16x16x32_bf16 v[56:59], v[116:119], v[136:139], v[56:59]
    s_add_u32 m0, s38, 4096
    s_nop 0
    v_mfma_f32_16x16x32_bf16 v[60:63], v[120:123], v[136:139], v[60:63]
    buffer_load_dwordx4 v12, s[16:19], s36 offen lds
    s_add_u32 m0, s38, 5120
    v_mfma_f32_16x16x32_bf16 v[64:67], v[124:127], v[136:139], v[64:67]
    s_nop 0
    buffer_load_dwordx4 v13, s[16:19], s36 offen lds
    v_mfma_f32_16x16x32_bf16 v[68:71], v[128:131], v[136:139], v[68:71]
    s_add_u32 m0, s38, 6144
    s_nop 0
    v_mfma_f32_16x16x32_bf16 v[72:75], v[112:115], v[140:143], v[72:75]
    buffer_load_dwordx4 v14, s[16:19], s36 offen lds
    s_add_u32 m0, s38, 7168
    v_mfma_f32_16x16x32_bf16 v[76:79], v[116:119], v[140:143], v[76:79]
    s_nop 0
    buffer_load_dwordx4 v15, s[16:19], s36 offen lds
    v_mfma_f32_16x16x32_bf16 v[80:83], v[120:123], v[140:143], v[80:83]
    s_add_u32 m0, s38, 8192
    s_nop 0
    v_mfma_f32_16x16x32_bf16 v[84:87], v[124:127], v[140:143], v[84:87]
    buffer_load_dwordx4 v16, s[16:19], s36 offen lds
    s_add_u32 s35, s35, 4096
    v_mfma_f32_16x16x32_bf16 v[88:91], v[128:131], v[140:143], v[88:91]
    s_add_u32 s36, s36, 5120
    v_mfma_f32_16x16x32_bf16 v[92:95], v[112:115], v[144:147], v[92:95]
    v_mfma_f32_16x16x32_bf16 v[96:99], v[116:119], v[144:147], v[96:99]
    v_mfma_f32_16x16x32_bf16 v[100:103], v[120:123], v[144:147], v[100:103]
    v_mfma_f32_16x16x32_bf16 v[104:107], v[124:127], v[144:147], v[104:107]
    v_mfma_f32_16x16x32_bf16 v[108:111], v[128:131], v[144:147], v[108:111]
    s_waitcnt vmcnt(18)
    ds_read_b64_tr_b16 v[112:113], v21 offset:18432
    ds_read_b64_tr_b16 v[114:115], v21 offset:20992
    ds_read_b64_tr_b16 v[116:117], v21 offset:18464
    ds_read_b64_tr_b16 v[118:119], v21 offset:21024
    ds_read_b64_tr_b16 v[120:121], v21 offset:18496
    ds_read_b64_tr_b16 v[122:123], v21 offset:21056
    ds_read_b64_tr_b16 v[124:125], v21 offset:18528
    ds_read_b64_tr_b16 v[126:127], v21 offset:21088
    ds_read_b64_tr_b16 v[128:129], v21 offset:18560
    ds_read_b64_tr_b16 v[130:131], v21 offset:21120
    ds_read_b128 v[132:135], v20 offset:18432
    ds_read_b128 v[136:139], v20 offset:19456
    ds_read_b128 v[140:143], v20 offset:20480
    ds_read_b128 v[144:147], v20 offset:21504
    s_waitcnt lgkmcnt(14)
    v_mfma_f32_16x16x32_bf16 v[32:35], v[148:151], v[168:171], v[32:35]
    v_mfma_f32_16x16x32_bf16 v[36:39], v[152:155], v[168:171], v[36:39]
    v_mfma_f32_16x16x32_bf16 v[40:43], v[156:159], v[168:171], v[40:43]
    v_mfma_f32_16x16x32_bf16 v[44:47], v[160:163], v[168:171], v[44:47]
    v_mfma_f32_16x16x32_bf16 v[48:51], v[164:167], v[168:171], v[48:51]
    v_mfma_f32_16x16x32_bf16 v[52:55], v[148:151], v[172:175], v[52:55]
    v_mfma_f32_16x16x32_bf16 v[56:59], v[152:155], v[172:175], v[56:59]
    v_mfma_f32_16x16x32_bf16 v[60:63], v[156:159], v[172:175], v[60:63]
    v_mfma_f32_16x16x32_bf16 v[64:67], v[160:163], v[172:175], v[64:67]
    v_mfma_f32_16x16x32_bf16 v[68:71], v[164:167], v[172:175], v[68:71]
    v_mfma_f32_16x16x32_bf16 v[72:75], v[148:151], v[176:179], v[72:75]
    v_mfma_f32_16x16x32_bf16 v[76:79], v[152:155], v[176:179], v[76:79]
    v_mfma_f32_16x16x32_bf16 v[80:83], v[156:159], v[176:179], v[80:83]
    v_mfma_f32_16x16x32_bf16 v[84:87], v[160:163], v[176:179], v[84:87]
    v_mfma_f32_16x16x32_bf16 v[88:91], v[164:167], v[176:179], v[88:91]
    v_mfma_f32_16x16x32_bf16 v[92:95], v[148:151], v[180:183], v[92:95]
    v_mfma_f32_16x16x32_bf16 v[96:99], v[152:155], v[180:183], v[96:99]
    v_mfma_f32_16x16x32_bf16 v[100:103], v[156:159], v[180:183], v[100:103]
    v_mfma_f32_16x16x32_bf16 v[104:107], v[160:163], v[180:183], v[104:107]
    v_mfma_f32_16x16x32_bf16 v[108:111], v[164:167], v[180:183], v[108:111]
    s_waitcnt vmcnt(9)
    ds_read_b64_tr_b16 v[148:149], v21 offset:27648
    ds_read_b64_tr_b16 v[150:151], v21 offset:30208
    ds_read_b64_tr_b16 v[152:153], v21 offset:27680
    ds_read_b64_tr_b16 v[154:155], v21 offset:30240
    ds_read_b64_tr_b16 v[156:157], v21 offset:27712
    ds_read_b64_tr_b16 v[158:159], v21 offset:30272
    ds_read_b64_tr_b16 v[160:161], v21 offset:27744
    ds_read_b64_tr_b16 v[162:163], v21 offset:30304
    ds_read_b64_tr_b16 v[164:165], v21 offset:27776
    ds_read_b64_tr_b16 v[166:167], v21 offset:30336
    ds_read_b128 v[168:171], v20 offset:27648
    ds_read_b128 v[172:175], v20 offset:28672
    ds_read_b128 v[176:179], v20 offset:29696
    ds_read_b128 v[180:183], v20 offset:30720
    s_waitcnt lgkmcnt(14)
    v_mfma_f32_16x16x32_bf16 v[32:35], v[112:115], v[132:135], v[32:35]
    v_mfma_f32_16x16x32_bf16 v[36:39], v[116:119], v[132:135], v[36:39]
    v_mfma_f32_16x16x32_bf16 v[40:43], v[120:123], v[132:135], v[40:43]
    v_mfma_f32_16x16x32_bf16 v[44:47], v[124:127], v[132:135], v[44:47]
    v_mfma_f32_16x16x32_bf16 v[48:51], v[128:131], v[132:135], v[48:51]
    v_mfma_f32_16x16x32_bf16 v[52:55], v[112:115], v[136:139], v[52:55]
    v_mfma_f32_16x16x32_bf16 v[56:59], v[116:119], v[136:139], v[56:59]
    v_mfma_f32_16x16x32_bf16 v[60:63], v[120:123], v[136:139], v[60:63]
    v_mfma_f32_16x16x32_bf16 v[64:67], v[124:127], v[136:139], v[64:67]
    v_mfma_f32_16x16x32_bf16 v[68:71], v[128:131], v[136:139], v[68:71]
    v_mfma_f32_16x16x32_bf16 v[72:75], v[112:115], v[140:143], v[72:75]
    v_mfma_f32_16x16x32_bf16 v[76:79], v[116:119], v[140:143], v[76:79]
    v_mfma_f32_16x16x32_bf16 v[80:83], v[120:123], v[140:143], v[80:83]
    v_mfma_f32_16x16x32_bf16 v[84:87], v[124:127], v[140:143], v[84:87]
    v_mfma_f32_16x16x32_bf16 v[88:91], v[128:131], v[140:143], v[88:91]
    v_mfma_f32_16x16x32_bf16 v[92:95], v[112:115], v[144:147], v[92:95]
    v_mfma_f32_16x16x32_bf16 v[96:99], v[116:119], v[144:147], v[96:99]
    v_mfma_f32_16x16x32_bf16 v[100:103], v[120:123], v[144:147], v[100:103]
    v_mfma_f32_16x16x32_bf16 v[104:107], v[124:127], v[144:147], v[104:107]
    v_mfma_f32_16x16x32_bf16 v[108:111], v[128:131], v[144:147], v[108:111]
    s_waitcnt vmcnt(0)
    ds_read_b64_tr_b16 v[112:113], v21 offset:0
    ds_read_b64_tr_b16 v[114:115], v21 offset:2560
    ds_read_b64_tr_b16 v[116:117], v21 offset:32
    ds_read_b64_tr_b16 v[118:119], v21 offset:2592
    ds_read_b64_tr_b16 v[120:121], v21 offset:64
    ds_read_b64_tr_b16 v[122:123], v21 offset:2624
    ds_read_b64_tr_b16 v[124:125], v21 offset:96
    ds_read_b64_tr_b16 v[126:127], v21 offset:2656
    ds_read_b64_tr_b16 v[128:129], v21 offset:128
    ds_read_b64_tr_b16 v[130:131], v21 offset:2688
    ds_read_b128 v[132:135], v20 offset:0
    ds_read_b128 v[136:139], v20 offset:1024
    ds_read_b128 v[140:143], v20 offset:2048
    ds_read_b128 v[144:147], v20 offset:3072
    s_waitcnt lgkmcnt(14)
    v_mfma_f32_16x16x32_bf16 v[32:35], v[148:151], v[168:171], v[32:35]
    v_mfma_f32_16x16x32_bf16 v[36:39], v[152:155], v[168:171], v[36:39]
    v_mfma_f32_16x16x32_bf16 v[40:43], v[156:159], v[168:171], v[40:43]
    v_mfma_f32_16x16x32_bf16 v[44:47], v[160:163], v[168:171], v[44:47]
    v_mfma_f32_16x16x32_bf16 v[48:51], v[164:167], v[168:171], v[48:51]
    v_mfma_f32_16x16x32_bf16 v[52:55], v[148:151], v[172:175], v[52:55]
    v_mfma_f32_16x16x32_bf16 v[56:59], v[152:155], v[172:175], v[56:59]
    v_mfma_f32_16x16x32_bf16 v[60:63], v[156:159], v[172:175], v[60:63]
    v_mfma_f32_16x16x32_bf16 v[64:67], v[160:163], v[172:175], v[64:67]
    v_mfma_f32_16x16x32_bf16 v[68:71], v[164:167], v[172:175], v[68:71]
    v_mfma_f32_16x16x32_bf16 v[72:75], v[148:151], v[176:179], v[72:75]
    v_mfma_f32_16x16x32_bf16 v[76:79], v[152:155], v[176:179], v[76:79]
    v_mfma_f32_16x16x32_bf16 v[80:83], v[156:159], v[176:179], v[80:83]
    v_mfma_f32_16x16x32_bf16 v[84:87], v[160:163], v[176:179], v[84:87]
    v_mfma_f32_16x16x32_bf16 v[88:91], v[164:167], v[176:179], v[88:91]
    v_mfma_f32_16x16x32_bf16 v[92:95], v[148:151], v[180:183], v[92:95]
    v_mfma_f32_16x16x32_bf16 v[96:99], v[152:155], v[180:183], v[96:99]
    v_mfma_f32_16x16x32_bf16 v[100:103], v[156:159], v[180:183], v[100:103]
    v_mfma_f32_16x16x32_bf16 v[104:107], v[160:163], v[180:183], v[104:107]
    v_mfma_f32_16x16x32_bf16 v[108:111], v[164:167], v[180:183], v[108:111]
    s_waitcnt lgkmcnt(0)
    v_mfma_f32_16x16x32_bf16 v[32:35], v[112:115], v[132:135], v[32:35]
    v_mfma_f32_16x16x32_bf16 v[36:39], v[116:119], v[132:135], v[36:39]
    v_mfma_f32_16x16x32_bf16 v[40:43], v[120:123], v[132:135], v[40:43]
    v_mfma_f32_16x16x32_bf16 v[44:47], v[124:127], v[132:135], v[44:47]
    v_mfma_f32_16x16x32_bf16 v[48:51], v[128:131], v[132:135], v[48:51]
    v_mfma_f32_16x16x32_bf16 v[52:55], v[112:115], v[136:139], v[52:55]
    v_mfma_f32_16x16x32_bf16 v[56:59], v[116:119], v[136:139], v[56:59]
    v_mfma_f32_16x16x32_bf16 v[60:63], v[120:123], v[136:139], v[60:63]
    v_mfma_f32_16x16x32_bf16 v[64:67], v[124:127], v[136:139], v[64:67]
    v_mfma_f32_16x16x32_bf16 v[68:71], v[128:131], v[136:139], v[68:71]
    v_mfma_f32_16x16x32_bf16 v[72:75], v[112:115], v[140:143], v[72:75]
    v_mfma_f32_16x16x32_bf16 v[76:79], v[116:119], v[140:143], v[76:79]
    v_mfma_f32_16x16x32_bf16 v[80:83], v[120:123], v[140:143], v[80:83]
    v_mfma_f32_16x16x32_bf16 v[84:87], v[124:127], v[140:143], v[84:87]
    v_mfma_f32_16x16x32_bf16 v[88:91], v[128:131], v[140:143], v[88:91]
    v_mfma_f32_16x16x32_bf16 v[92:95], v[112:115], v[144:147], v[92:95]
    v_mfma_f32_16x16x32_bf16 v[96:99], v[116:119], v[144:147], v[96:99]
    v_mfma_f32_16x16x32_bf16 v[100:103], v[120:123], v[144:147], v[100:103]
    v_mfma_f32_16x16x32_bf16 v[104:107], v[124:127], v[144:147], v[104:107]
    v_mfma_f32_16x16x32_bf16 v[108:111], v[128:131], v[144:147], v[108:111]
    s_mul_i32 s39, s33, 81920
    s_mul_i32 s40, s34, 160
    s_add_u32 s39, s39, s40
    v_add_u32 v9, 0, v0
    v_mul_u32_u24 v10, 3277, v9
    v_lshrrev_b32 v10, 16, v10
    v_mul_u32_u24 v11, 20, v10
    v_sub_u32 v11, v9, v11
    v_mul_u32_u24 v9, 336, v10
    v_lshl_add_u32 v184, v11, 4, v9
    v_mul_u32_u24 v10, 1280, v10
    v_lshl_add_u32 v190, v11, 3, v10
    buffer_load_dwordx2 v[196:197], v190, s[24:27], s39 offen
    v_add_u32 v9, 256, v0
    v_mul_u32_u24 v10, 3277, v9
    v_lshrrev_b32 v10, 16, v10
    v_mul_u32_u24 v11, 20, v10
    v_sub_u32 v11, v9, v11
    v_mul_u32_u24 v9, 336, v10
    v_lshl_add_u32 v185, v11, 4, v9
    v_mul_u32_u24 v10, 1280, v10
    v_lshl_add_u32 v191, v11, 3, v10
    buffer_load_dwordx2 v[198:199], v191, s[24:27], s39 offen
    v_add_u32 v9, 512, v0
    v_mul_u32_u24 v10, 3277, v9
    v_lshrrev_b32 v10, 16, v10
    v_mul_u32_u24 v11, 20, v10
    v_sub_u32 v11, v9, v11
    v_mul_u32_u24 v9, 336, v10
    v_lshl_add_u32 v186, v11, 4, v9
    v_mul_u32_u24 v10, 1280, v10
    v_lshl_add_u32 v192, v11, 3, v10
    buffer_load_dwordx2 v[200:201], v192, s[24:27], s39 offen
    v_add_u32 v9, 768, v0
    v_mul_u32_u24 v10, 3277, v9
    v_lshrrev_b32 v10, 16, v10
    v_mul_u32_u24 v11, 20, v10
    v_sub_u32 v11, v9, v11
    v_mul_u32_u24 v9, 336, v10
    v_lshl_add_u32 v187, v11, 4, v9
    v_mul_u32_u24 v10, 1280, v10
    v_lshl_add_u32 v193, v11, 3, v10
    buffer_load_dwordx2 v[202:203], v193, s[24:27], s39 offen
    v_add_u32 v9, 1024, v0
    v_mul_u32_u24 v10, 3277, v9
    v_lshrrev_b32 v10, 16, v10
    v_mul_u32_u24 v11, 20, v10
    v_sub_u32 v11, v9, v11
    v_mul_u32_u24 v9, 336, v10
    v_lshl_add_u32 v188, v11, 4, v9
    v_mul_u32_u24 v10, 1280, v10
    v_lshl_add_u32 v194, v11, 3, v10
    buffer_load_dwordx2 v[204:205], v194, s[24:27], s39 offen
    v_and_b32 v9, 15, v2
    v_mul_u32_u24 v9, 336, v9
    v_lshl_add_u32 v9, v3, 4, v9
    v_add_u32 v9, s38, v9
    ds_write_b128 v9, v[32:35] offset:0
    ds_write_b128 v9, v[36:39] offset:64
    ds_write_b128 v9, v[40:43] offset:128
    ds_write_b128 v9, v[44:47] offset:192
    ds_write_b128 v9, v[48:51] offset:256
    ds_write_b128 v9, v[52:55] offset:5376
    ds_write_b128 v9, v[56:59] offset:5440
    ds_write_b128 v9, v[60:63] offset:5504
    ds_write_b128 v9, v[64:67] offset:5568
    ds_write_b128 v9, v[68:71] offset:5632
    ds_write_b128 v9, v[72:75] offset:10752
    ds_write_b128 v9, v[76:79] offset:10816
    ds_write_b128 v9, v[80:83] offset:10880
    ds_write_b128 v9, v[84:87] offset:10944
    ds_write_b128 v9, v[88:91] offset:11008
    ds_write_b128 v9, v[92:95] offset:16128
    ds_write_b128 v9, v[96:99] offset:16192
    ds_write_b128 v9, v[100:103] offset:16256
    ds_write_b128 v9, v[104:107] offset:16320
    ds_write_b128 v9, v[108:111] offset:16384
    s_waitcnt lgkmcnt(0)
    s_barrier
    v_add_u32 v10, 73728, v184
    ds_read_b128 v[32:35], v184 offset:0
    ds_read_b128 v[36:39], v184 offset:36864
    ds_read_b128 v[40:43], v10 offset:0
    ds_read_b128 v[44:47], v10 offset:36864
    v_add_u32 v10, 73728, v185
    ds_read_b128 v[56:59], v185 offset:0
    ds_read_b128 v[60:63], v185 offset:36864
    ds_read_b128 v[64:67], v10 offset:0
    ds_read_b128 v[68:71], v10 offset:36864
    v_add_u32 v10, 73728, v186
    ds_read_b128 v[80:83], v186 offset:0
    ds_read_b128 v[84:87], v186 offset:36864
    ds_read_b128 v[88:91], v10 offset:0
    ds_read_b128 v[92:95], v10 offset:36864
    v_add_u32 v10, 73728, v187
    ds_read_b128 v[104:107], v187 offset:0
    ds_read_b128 v[108:111], v187 offset:36864
    ds_read_b128 v[112:115], v10 offset:0
    ds_read_b128 v[116:119], v10 offset:36864
    v_add_u32 v10, 73728, v188
    ds_read_b128 v[128:131], v188 offset:0
    ds_read_b128 v[132:135], v188 offset:36864
    ds_read_b128 v[136:139], v10 offset:0
    ds_read_b128 v[140:143], v10 offset:36864
    s_waitcnt vmcnt(4) lgkmcnt(15)
    v_pk_add_f32 v[32:33], v[32:33], v[36:37]
    v_pk_add_f32 v[40:41], v[40:41], v[44:45]
    v_pk_add_f32 v[34:35], v[34:35], v[38:39]
    v_pk_add_f32 v[42:43], v[42:43], v[46:47]
    v_lshlrev_b32 v36, 16, v196
    v_and_b32 v37, 0xffff0000, v196
    v_lshlrev_b32 v38, 16, v197
    v_and_b32 v39, 0xffff0000, v197
    v_pk_add_f32 v[32:33], v[32:33], v[40:41]
    v_pk_add_f32 v[34:35], v[34:35], v[42:43]
    v_pk_add_f32 v[32:33], v[32:33], v[36:37]
    v_pk_add_f32 v[34:35], v[34:35], v[38:39]
    v_cvt_pk_bf16_f32 v52, v32, v33
    v_cvt_pk_bf16_f32 v53, v34, v35
    buffer_store_dwordx2 v[52:53], v190, s[28:31], s39 offen
    s_waitcnt vmcnt(4) lgkmcnt(12)
    v_pk_add_f32 v[56:57], v[56:57], v[60:61]
    v_pk_add_f32 v[64:65], v[64:65], v[68:69]
    v_pk_add_f32 v[58:59], v[58:59], v[62:63]
    v_pk_add_f32 v[66:67], v[66:67], v[70:71]
    v_lshlrev_b32 v60, 16, v198
    v_and_b32 v61, 0xffff0000, v198
    v_lshlrev_b32 v62, 16, v199
    v_and_b32 v63, 0xffff0000, v199
    v_pk_add_f32 v[56:57], v[56:57], v[64:65]
    v_pk_add_f32 v[58:59], v[58:59], v[66:67]
    v_pk_add_f32 v[56:57], v[56:57], v[60:61]
    v_pk_add_f32 v[58:59], v[58:59], v[62:63]
    v_cvt_pk_bf16_f32 v76, v56, v57
    v_cvt_pk_bf16_f32 v77, v58, v59
    buffer_store_dwordx2 v[76:77], v191, s[28:31], s39 offen
    s_waitcnt vmcnt(4) lgkmcnt(8)
    v_pk_add_f32 v[80:81], v[80:81], v[84:85]
    v_pk_add_f32 v[88:89], v[88:89], v[92:93]
    v_pk_add_f32 v[82:83], v[82:83], v[86:87]
    v_pk_add_f32 v[90:91], v[90:91], v[94:95]
    v_lshlrev_b32 v84, 16, v200
    v_and_b32 v85, 0xffff0000, v200
    v_lshlrev_b32 v86, 16, v201
    v_and_b32 v87, 0xffff0000, v201
    v_pk_add_f32 v[80:81], v[80:81], v[88:89]
    v_pk_add_f32 v[82:83], v[82:83], v[90:91]
    v_pk_add_f32 v[80:81], v[80:81], v[84:85]
    v_pk_add_f32 v[82:83], v[82:83], v[86:87]
    v_cvt_pk_bf16_f32 v100, v80, v81
    v_cvt_pk_bf16_f32 v101, v82, v83
    buffer_store_dwordx2 v[100:101], v192, s[28:31], s39 offen
    s_waitcnt vmcnt(4) lgkmcnt(4)
    v_pk_add_f32 v[104:105], v[104:105], v[108:109]
    v_pk_add_f32 v[112:113], v[112:113], v[116:117]
    v_pk_add_f32 v[106:107], v[106:107], v[110:111]
    v_pk_add_f32 v[114:115], v[114:115], v[118:119]
    v_lshlrev_b32 v108, 16, v202
    v_and_b32 v109, 0xffff0000, v202
    v_lshlrev_b32 v110, 16, v203
    v_and_b32 v111, 0xffff0000, v203
    v_pk_add_f32 v[104:105], v[104:105], v[112:113]
    v_pk_add_f32 v[106:107], v[106:107], v[114:115]
    v_pk_add_f32 v[104:105], v[104:105], v[108:109]
    v_pk_add_f32 v[106:107], v[106:107], v[110:111]
    v_cvt_pk_bf16_f32 v124, v104, v105
    v_cvt_pk_bf16_f32 v125, v106, v107
    buffer_store_dwordx2 v[124:125], v193, s[28:31], s39 offen
    s_waitcnt vmcnt(4) lgkmcnt(0)
    v_pk_add_f32 v[128:129], v[128:129], v[132:133]
    v_pk_add_f32 v[136:137], v[136:137], v[140:141]
    v_pk_add_f32 v[130:131], v[130:131], v[134:135]
    v_pk_add_f32 v[138:139], v[138:139], v[142:143]
    v_lshlrev_b32 v132, 16, v204
    v_and_b32 v133, 0xffff0000, v204
    v_lshlrev_b32 v134, 16, v205
    v_and_b32 v135, 0xffff0000, v205
    v_pk_add_f32 v[128:129], v[128:129], v[136:137]
    v_pk_add_f32 v[130:131], v[130:131], v[138:139]
    v_pk_add_f32 v[128:129], v[128:129], v[132:133]
    v_pk_add_f32 v[130:131], v[130:131], v[134:135]
    v_cvt_pk_bf16_f32 v148, v128, v129
    v_cvt_pk_bf16_f32 v149, v130, v131
    buffer_store_dwordx2 v[148:149], v194, s[28:31], s39 offen
L_k2_end:
    s_endpgm
.section .rodata,"a"
.p2align 6
.amdhsa_kernel k1_kernel
  .amdhsa_next_free_vgpr 256
  .amdhsa_next_free_sgpr 102
  .amdhsa_accum_offset 256
  .amdhsa_group_segment_fixed_size 0
  .amdhsa_kernarg_size 88
  .amdhsa_user_sgpr_count 2
  .amdhsa_user_sgpr_kernarg_segment_ptr 1
  .amdhsa_system_sgpr_workgroup_id_x 1
.end_amdhsa_kernel
.p2align 6
.amdhsa_kernel k2_kernel
  .amdhsa_next_free_vgpr 208
  .amdhsa_next_free_sgpr 96
  .amdhsa_accum_offset 208
  .amdhsa_group_segment_fixed_size 0
  .amdhsa_kernarg_size 88
  .amdhsa_user_sgpr_count 2
  .amdhsa_user_sgpr_kernarg_segment_ptr 1
  .amdhsa_system_sgpr_workgroup_id_x 1
.end_amdhsa_kernel
```
